```python
import torch

def _softmax(x, axis=-1):
    return torch.softmax(x, dim=axis)
def _gelu(x):
    return torch.nn.functional.gelu(x, approximate="tanh")
def _silu(x):
    return torch.nn.functional.silu(x)
def _sigmoid(x):
    return torch.sigmoid(x)
def _layernorm(x, axis=-1, eps=1e-5):
    m = x.mean(dim=axis, keepdim=True)
    v = x.var(dim=axis, keepdim=True, unbiased=False)
    return (x - m) / torch.sqrt(v + eps)
def _scatter_add(tgt, idx, src, axis=0):
    return tgt.clone().index_add_(axis, idx, src)
def _segment_sum(src, seg, n):
    out = torch.zeros((n,) + src.shape[1:], dtype=src.dtype)
    return out.index_add_(0, seg, src)
def _pad(x, pw):
    flat = tuple(v for pair in reversed(pw) for v in pair)
    return torch.nn.functional.pad(x, flat)

kernel_name = 'standalone__mha_block_cached__near_ridge'

def setup_inputs():

    _w = (lambda a: (lambda t: t.to(torch.bfloat16) if t.is_floating_point() else t)(torch.as_tensor(a)))
    B, Sq, D = 8, 96, 512
    H, Sk, Dh = 32, 1024, 128
    return {
        "x": _w((lambda *s: torch.randn(*s, dtype=torch.bfloat16) * 0.8)(B, Sq, D)),
        "k_cache": _w((lambda *s: torch.randn(*s, dtype=torch.bfloat16) * 0.8)(B, H, Sk, Dh)),
        "v_cache": _w((lambda *s: torch.randn(*s, dtype=torch.bfloat16) * 0.05)(B, H, Sk, Dh)),
        "wq": _w((lambda *s: torch.randn(*s, dtype=torch.bfloat16) * 0.8)(D, H * Dh) * (D ** -0.5)),
        "wo": _w((lambda *s: torch.randn(*s, dtype=torch.bfloat16) * 0.05)(H * Dh, D) * ((H * Dh) ** -0.5)),
    }

def reference(x, k_cache, v_cache, wq, wo):
    B, Sq, D = x.shape
    H, Dh = 32, 128
    q = (lambda x, *d: x.permute(*d))((x @ wq).reshape(B, Sq, H, Dh), 0, 2, 1, 3)
    scores = torch.einsum("bhqd,bhkd->bhqk", q, k_cache) * (Dh ** -0.5)
    p = _softmax(scores, axis=-1)
    o = torch.einsum("bhqk,bhkd->bhqd", p, v_cache)
    return (lambda x, *d: x.permute(*d))(o, 0, 2, 1, 3).reshape(B, Sq, H * Dh) @ wo
```

```asm
; @launch grid=(256,1,1) block=(256,1,1) lds=163840
.amdgcn_target "amdgcn-amd-amdhsa--gfx950"
.text
.globl standalone__mha_block_cached__near_ridge_kernel
.p2align 8
.type standalone__mha_block_cached__near_ridge_kernel,@function
standalone__mha_block_cached__near_ridge_kernel:
    s_load_dwordx16 s[16:31], s[0:1], 0
    s_cmp_ge_u32 s2, 256
    s_cbranch_scc1 L_end
    s_getpc_b64 s[64:65]
L_pc:
    v_lshrrev_b32 v2, 6, v0
    v_and_b32 v1, 63, v0
    v_readfirstlane_b32 s3, v2
    v_lshlrev_b32 v25, 2, v0
    v_add_u32 v25, 159744, v25
    v_mov_b32 v26, 0
    ds_write_b32 v25, v26
    ds_write_b32 v25, v26 offset:1024
    s_bfe_u32 s9, s2, 0x20003
    s_and_b32 s4, s2, 7
    s_lshl_b32 s4, s4, 2
    s_add_u32 s4, s4, s9
    s_lshr_b32 s5, s2, 5
    s_lshr_b32 s6, s4, 2
    s_and_b32 s7, s4, 3
    s_lshl_b32 s8, s9, 1
    s_add_u32 s8, s8, s5
    v_lshrrev_b32 v2, 4, v1
    v_and_b32 v3, 15, v1
    s_mov_b32 s69, 0
    s_mov_b32 s81, 0
    s_cmp_eq_u32 s3, 3
    s_cbranch_scc1 L_loader
    s_waitcnt lgkmcnt(0)
    s_barrier
    s_branch L_compute
L_loader:
    s_mov_b32 s66, L_code_end-L_pc
    s_mov_b32 s67, 0x20000
    v_lshlrev_b32 v6, 7, v1
    s_lshl_b32 s14, s5, 13
    buffer_load_dword v31, v6, s[64:67], s14 offen
    v_lshlrev_b32 v4, 2, v2
    v_xor_b32 v4, v4, v3
    v_lshlrev_b32 v4, 4, v4
    v_lshl_or_b32 v16, v2, 13, v4
    v_add_u32 v17, 31744, v16
    v_add_u32 v18, 63488, v16
    v_add_u32 v19, 95232, v16
    v_lshrrev_b32 v6, 3, v1
    v_and_b32 v7, 7, v1
    v_xor_b32 v13, v7, v2
    v_lshlrev_b32 v13, 4, v13
    v_lshl_or_b32 v20, v6, 10, v13
    v_xor_b32 v21, 64, v20
    v_add_u32 v22, 14336, v20
    v_add_u32 v23, 21504, v21
    v_add_u32 v21, 7168, v21
    s_mul_i32 s9, s5, 98304
    s_lshl_b32 s14, s4, 8
    s_mov_b32 s42, 98304
    s_mov_b32 s43, 0x20000
    s_sub_u32 s46, 0x400000, s14
    s_mov_b32 s47, 0x20000
    s_waitcnt lgkmcnt(0)
    s_barrier
    s_add_u32 s40, s16, s9
    s_addc_u32 s41, s17, 0
    s_add_u32 s44, s22, s14
    s_addc_u32 s45, s23, 0
    s_add_u32 s15, s8, 0
    s_and_b32 s15, s15, 7
    s_lshl_b32 s75, s15, 19
    s_lshl_b32 s82, s15, 7
    s_mov_b32 m0, 90112
    s_add_u32 s68, s82, 0
    buffer_load_dwordx4 v20, s[40:43], s68 offen  lds
    buffer_load_dwordx4 v21, s[40:43], s68 offen offset:1024  lds
    buffer_load_dwordx4 v22, s[40:43], s68 offen offset:2048  lds
    buffer_load_dwordx4 v23, s[40:43], s68 offen offset:3072  lds
    s_mov_b32 m0, 94208
    s_add_u32 s68, s82, 32768
    buffer_load_dwordx4 v20, s[40:43], s68 offen  lds
    buffer_load_dwordx4 v21, s[40:43], s68 offen offset:1024  lds
    buffer_load_dwordx4 v22, s[40:43], s68 offen offset:2048  lds
    buffer_load_dwordx4 v23, s[40:43], s68 offen offset:3072  lds
    s_mov_b32 m0, 98304
    s_add_u32 s68, s82, 65536
    buffer_load_dwordx4 v20, s[40:43], s68 offen  lds
    buffer_load_dwordx4 v21, s[40:43], s68 offen offset:1024  lds
    buffer_load_dwordx4 v22, s[40:43], s68 offen offset:2048  lds
    buffer_load_dwordx4 v23, s[40:43], s68 offen offset:3072  lds
    s_mov_b32 m0, 73728
    s_add_u32 s68, s75, 0
    buffer_load_dwordx4 v16, s[44:47], s68 offen  lds
    buffer_load_dwordx4 v17, s[44:47], s68 offen offset:1024  lds
    buffer_load_dwordx4 v18, s[44:47], s68 offen offset:2048  lds
    buffer_load_dwordx4 v19, s[44:47], s68 offen offset:3072  lds
    s_mov_b32 m0, 77824
    s_add_u32 s68, s75, 131072
    buffer_load_dwordx4 v16, s[44:47], s68 offen  lds
    buffer_load_dwordx4 v17, s[44:47], s68 offen offset:1024  lds
    buffer_load_dwordx4 v18, s[44:47], s68 offen offset:2048  lds
    buffer_load_dwordx4 v19, s[44:47], s68 offen offset:3072  lds
    s_mov_b32 m0, 160512
    s_mov_b32 s68, L_table-L_pc+4
    buffer_load_dword off, s[64:67], s68 lds
    s_mov_b32 m0, 81920
    s_add_u32 s68, s75, 262144
    buffer_load_dwordx4 v16, s[44:47], s68 offen  lds
    buffer_load_dwordx4 v17, s[44:47], s68 offen offset:1024  lds
    buffer_load_dwordx4 v18, s[44:47], s68 offen offset:2048  lds
    buffer_load_dwordx4 v19, s[44:47], s68 offen offset:3072  lds
    s_mov_b32 m0, 86016
    s_add_u32 s68, s75, 393216
    buffer_load_dwordx4 v16, s[44:47], s68 offen  lds
    buffer_load_dwordx4 v17, s[44:47], s68 offen offset:1024  lds
    buffer_load_dwordx4 v18, s[44:47], s68 offen offset:2048  lds
    buffer_load_dwordx4 v19, s[44:47], s68 offen offset:3072  lds
    s_mov_b32 m0, 160512
    s_mov_b32 s68, L_table-L_pc+8
    buffer_load_dword off, s[64:67], s68 lds
    v_xor_b32 v5, v2, v3
    v_lshlrev_b32 v5, 4, v5
    v_lshl_or_b32 v8, v2, 8, v5
    v_xor_b32 v9, 64, v8
    v_xor_b32 v10, 0x80, v8
    v_xor_b32 v11, 0xc0, v8
    v_lshl_or_b32 v12, v2, 8, v4
    s_lshl_b32 s15, s5, 5
    s_add_u32 s15, s15, s4
    s_lshl_b32 s15, s15, 18
    s_add_u32 s32, s18, s15
    s_addc_u32 s33, s19, 0
    s_mov_b32 s34, 262144
    s_mov_b32 s35, 0x20000
    s_add_u32 s36, s20, s15
    s_addc_u32 s37, s21, 0
    s_mov_b32 s38, 262144
    s_mov_b32 s39, 0x20000
    s_mov_b32 s60, s30
    s_mov_b32 s61, s31
    s_mov_b32 s62, 33554432
    s_mov_b32 s63, 0x20000
    s_lshl_b32 s9, s5, 5
    s_add_u32 s9, s9, s4
    s_mul_i32 s70, s9, 24576
    s_lshl_b32 s9, s7, 8
    s_lshl_b32 s14, s6, 19
    s_add_u32 s52, s24, s14
    s_addc_u32 s53, s25, 0
    s_mov_b32 s54, 0x80000
    s_mov_b32 s55, 0x20000
    s_add_u32 s48, s52, s9
    s_addc_u32 s49, s53, 0
    s_sub_u32 s50, 0x80000, s9
    s_mov_b32 s51, 0x20000
    s_lshr_b32 s80, s2, 3
    s_lshl_b32 s80, s80, 14
    v_lshlrev_b32 v44, 7, v1
    v_lshl_or_b32 v40, v2, 10, v4
    v_add_u32 v41, 3072, v40
    v_add_u32 v42, 6144, v40
    v_add_u32 v43, 9216, v40
    v_min_u32 v13, 4, v1
    v_lshlrev_b32 v13, 8, v13
    v_add_u32 v24, 159744, v13
    s_mov_b32 s77, 0
    s_mov_b32 s76, 12582927
    s_call_b64 s[12:13], L_lrefresh
    s_add_u32 s15, s8, 1
    s_and_b32 s15, s15, 7
    s_lshl_b32 s75, s15, 19
    s_lshl_b32 s82, s15, 7
    s_mov_b32 m0, 118784
    s_add_u32 s68, s82, 0
    buffer_load_dwordx4 v20, s[40:43], s68 offen  lds
    buffer_load_dwordx4 v21, s[40:43], s68 offen offset:1024  lds
    buffer_load_dwordx4 v22, s[40:43], s68 offen offset:2048  lds
    buffer_load_dwordx4 v23, s[40:43], s68 offen offset:3072  lds
    s_mov_b32 m0, 122880
    s_add_u32 s68, s82, 32768
    buffer_load_dwordx4 v20, s[40:43], s68 offen  lds
    buffer_load_dwordx4 v21, s[40:43], s68 offen offset:1024  lds
    buffer_load_dwordx4 v22, s[40:43], s68 offen offset:2048  lds
    buffer_load_dwordx4 v23, s[40:43], s68 offen offset:3072  lds
    s_waitcnt vmcnt(38)
    s_mov_b32 m0, 126976
    s_add_u32 s68, s82, 65536
    buffer_load_dwordx4 v20, s[40:43], s68 offen  lds
    buffer_load_dwordx4 v21, s[40:43], s68 offen offset:1024  lds
    buffer_load_dwordx4 v22, s[40:43], s68 offen offset:2048  lds
    buffer_load_dwordx4 v23, s[40:43], s68 offen offset:3072  lds
    s_waitcnt vmcnt(38)
    s_mov_b32 m0, 102400
    s_add_u32 s68, s75, 0
    buffer_load_dwordx4 v16, s[44:47], s68 offen  lds
    buffer_load_dwordx4 v17, s[44:47], s68 offen offset:1024  lds
    buffer_load_dwordx4 v18, s[44:47], s68 offen offset:2048  lds
    buffer_load_dwordx4 v19, s[44:47], s68 offen offset:3072  lds
    s_waitcnt vmcnt(38)
    s_mov_b32 m0, 106496
    s_add_u32 s68, s75, 131072
    buffer_load_dwordx4 v16, s[44:47], s68 offen  lds
    buffer_load_dwordx4 v17, s[44:47], s68 offen offset:1024  lds
    buffer_load_dwordx4 v18, s[44:47], s68 offen offset:2048  lds
    buffer_load_dwordx4 v19, s[44:47], s68 offen offset:3072  lds
    s_mov_b32 m0, 160512
    s_mov_b32 s68, L_table-L_pc+12
    buffer_load_dword off, s[64:67], s68 lds
    s_waitcnt vmcnt(38)
    s_mov_b32 m0, 110592
    s_add_u32 s68, s75, 262144
    buffer_load_dwordx4 v16, s[44:47], s68 offen  lds
    buffer_load_dwordx4 v17, s[44:47], s68 offen offset:1024  lds
    buffer_load_dwordx4 v18, s[44:47], s68 offen offset:2048  lds
    buffer_load_dwordx4 v19, s[44:47], s68 offen offset:3072  lds
    s_waitcnt vmcnt(38)
    s_mov_b32 m0, 114688
    s_add_u32 s68, s75, 393216
    buffer_load_dwordx4 v16, s[44:47], s68 offen  lds
    buffer_load_dwordx4 v17, s[44:47], s68 offen offset:1024  lds
    buffer_load_dwordx4 v18, s[44:47], s68 offen offset:2048  lds
    buffer_load_dwordx4 v19, s[44:47], s68 offen offset:3072  lds
    s_mov_b32 m0, 160512
    s_mov_b32 s68, L_table-L_pc+16
    buffer_load_dword off, s[64:67], s68 lds
    s_waitcnt vmcnt(38)
    s_mov_b32 m0, 0
    s_mov_b32 s68, 0
    buffer_load_dwordx4 v8, s[32:35], s68 offen nt lds
    buffer_load_dwordx4 v9, s[32:35], s68 offen offset:1024 nt lds
    buffer_load_dwordx4 v10, s[32:35], s68 offen offset:2048 nt lds
    buffer_load_dwordx4 v11, s[32:35], s68 offen offset:3072 nt lds
    s_waitcnt vmcnt(38)
    s_mov_b32 m0, 4096
    s_mov_b32 s68, 4096
    buffer_load_dwordx4 v8, s[32:35], s68 offen nt lds
    buffer_load_dwordx4 v9, s[32:35], s68 offen offset:1024 nt lds
    buffer_load_dwordx4 v10, s[32:35], s68 offen offset:2048 nt lds
    buffer_load_dwordx4 v11, s[32:35], s68 offen offset:3072 nt lds
    s_waitcnt vmcnt(38)
    s_mov_b32 m0, 8192
    s_mov_b32 s68, 8192
    buffer_load_dwordx4 v8, s[32:35], s68 offen nt lds
    buffer_load_dwordx4 v9, s[32:35], s68 offen offset:1024 nt lds
    buffer_load_dwordx4 v10, s[32:35], s68 offen offset:2048 nt lds
    buffer_load_dwordx4 v11, s[32:35], s68 offen offset:3072 nt lds
    s_waitcnt vmcnt(38)
    s_mov_b32 m0, 12288
    s_mov_b32 s68, 12288
    buffer_load_dwordx4 v8, s[32:35], s68 offen nt lds
    buffer_load_dwordx4 v9, s[32:35], s68 offen offset:1024 nt lds
    buffer_load_dwordx4 v10, s[32:35], s68 offen offset:2048 nt lds
    buffer_load_dwordx4 v11, s[32:35], s68 offen offset:3072 nt lds
    s_waitcnt vmcnt(38)
    s_mov_b32 m0, 16384
    s_mov_b32 s68, 16384
    buffer_load_dwordx4 v8, s[32:35], s68 offen nt lds
    buffer_load_dwordx4 v9, s[32:35], s68 offen offset:1024 nt lds
    buffer_load_dwordx4 v10, s[32:35], s68 offen offset:2048 nt lds
    buffer_load_dwordx4 v11, s[32:35], s68 offen offset:3072 nt lds
    s_waitcnt vmcnt(38)
    s_mov_b32 m0, 20480
    s_mov_b32 s68, 20480
    buffer_load_dwordx4 v8, s[32:35], s68 offen nt lds
    buffer_load_dwordx4 v9, s[32:35], s68 offen offset:1024 nt lds
    buffer_load_dwordx4 v10, s[32:35], s68 offen offset:2048 nt lds
    buffer_load_dwordx4 v11, s[32:35], s68 offen offset:3072 nt lds
    s_add_u32 s15, s8, 2
    s_and_b32 s15, s15, 7
    s_lshl_b32 s75, s15, 19
    s_lshl_b32 s82, s15, 7
    s_waitcnt vmcnt(38)
    s_mov_b32 m0, 147456
    s_add_u32 s68, s82, 0
    buffer_load_dwordx4 v20, s[40:43], s68 offen  lds
    buffer_load_dwordx4 v21, s[40:43], s68 offen offset:1024  lds
    buffer_load_dwordx4 v22, s[40:43], s68 offen offset:2048  lds
    buffer_load_dwordx4 v23, s[40:43], s68 offen offset:3072  lds
    s_waitcnt vmcnt(38)
    s_mov_b32 m0, 151552
    s_add_u32 s68, s82, 32768
    buffer_load_dwordx4 v20, s[40:43], s68 offen  lds
    buffer_load_dwordx4 v21, s[40:43], s68 offen offset:1024  lds
    buffer_load_dwordx4 v22, s[40:43], s68 offen offset:2048  lds
    buffer_load_dwordx4 v23, s[40:43], s68 offen offset:3072  lds
    s_waitcnt vmcnt(38)
    s_mov_b32 m0, 155648
    s_add_u32 s68, s82, 65536
    buffer_load_dwordx4 v20, s[40:43], s68 offen  lds
    buffer_load_dwordx4 v21, s[40:43], s68 offen offset:1024  lds
    buffer_load_dwordx4 v22, s[40:43], s68 offen offset:2048  lds
    buffer_load_dwordx4 v23, s[40:43], s68 offen offset:3072  lds
    s_waitcnt vmcnt(38)
    s_mov_b32 m0, 131072
    s_add_u32 s68, s75, 0
    buffer_load_dwordx4 v16, s[44:47], s68 offen  lds
    buffer_load_dwordx4 v17, s[44:47], s68 offen offset:1024  lds
    buffer_load_dwordx4 v18, s[44:47], s68 offen offset:2048  lds
    buffer_load_dwordx4 v19, s[44:47], s68 offen offset:3072  lds
    s_waitcnt vmcnt(38)
    s_mov_b32 m0, 135168
    s_add_u32 s68, s75, 131072
    buffer_load_dwordx4 v16, s[44:47], s68 offen  lds
    buffer_load_dwordx4 v17, s[44:47], s68 offen offset:1024  lds
    buffer_load_dwordx4 v18, s[44:47], s68 offen offset:2048  lds
    buffer_load_dwordx4 v19, s[44:47], s68 offen offset:3072  lds
    s_mov_b32 m0, 160512
    s_mov_b32 s68, L_table-L_pc+20
    buffer_load_dword off, s[64:67], s68 lds
    s_waitcnt vmcnt(38)
    s_mov_b32 m0, 139264
    s_add_u32 s68, s75, 262144
    buffer_load_dwordx4 v16, s[44:47], s68 offen  lds
    buffer_load_dwordx4 v17, s[44:47], s68 offen offset:1024  lds
    buffer_load_dwordx4 v18, s[44:47], s68 offen offset:2048  lds
    buffer_load_dwordx4 v19, s[44:47], s68 offen offset:3072  lds
    s_waitcnt vmcnt(38)
    s_mov_b32 m0, 143360
    s_add_u32 s68, s75, 393216
    buffer_load_dwordx4 v16, s[44:47], s68 offen  lds
    buffer_load_dwordx4 v17, s[44:47], s68 offen offset:1024  lds
    buffer_load_dwordx4 v18, s[44:47], s68 offen offset:2048  lds
    buffer_load_dwordx4 v19, s[44:47], s68 offen offset:3072  lds
    s_mov_b32 m0, 160512
    s_mov_b32 s68, L_table-L_pc+24
    buffer_load_dword off, s[64:67], s68 lds
    s_getpc_b64 s[12:13]
    s_cmp_ge_u32 s69, 1
    s_cbranch_scc0 L_lrefresh
    s_add_u32 s15, s8, 3
    s_and_b32 s15, s15, 7
    s_lshl_b32 s75, s15, 19
    s_lshl_b32 s82, s15, 7
    s_waitcnt vmcnt(38)
    s_mov_b32 m0, 90112
    s_add_u32 s68, s82, 0
    buffer_load_dwordx4 v20, s[40:43], s68 offen  lds
    buffer_load_dwordx4 v21, s[40:43], s68 offen offset:1024  lds
    buffer_load_dwordx4 v22, s[40:43], s68 offen offset:2048  lds
    buffer_load_dwordx4 v23, s[40:43], s68 offen offset:3072  lds
    s_waitcnt vmcnt(38)
    s_mov_b32 m0, 94208
    s_add_u32 s68, s82, 32768
    buffer_load_dwordx4 v20, s[40:43], s68 offen  lds
    buffer_load_dwordx4 v21, s[40:43], s68 offen offset:1024  lds
    buffer_load_dwordx4 v22, s[40:43], s68 offen offset:2048  lds
    buffer_load_dwordx4 v23, s[40:43], s68 offen offset:3072  lds
    s_waitcnt vmcnt(38)
    s_mov_b32 m0, 98304
    s_add_u32 s68, s82, 65536
    buffer_load_dwordx4 v20, s[40:43], s68 offen  lds
    buffer_load_dwordx4 v21, s[40:43], s68 offen offset:1024  lds
    buffer_load_dwordx4 v22, s[40:43], s68 offen offset:2048  lds
    buffer_load_dwordx4 v23, s[40:43], s68 offen offset:3072  lds
    s_waitcnt vmcnt(38)
    s_mov_b32 m0, 73728
    s_add_u32 s68, s75, 0
    buffer_load_dwordx4 v16, s[44:47], s68 offen  lds
    buffer_load_dwordx4 v17, s[44:47], s68 offen offset:1024  lds
    buffer_load_dwordx4 v18, s[44:47], s68 offen offset:2048  lds
    buffer_load_dwordx4 v19, s[44:47], s68 offen offset:3072  lds
    s_waitcnt vmcnt(38)
    s_mov_b32 m0, 77824
    s_add_u32 s68, s75, 131072
    buffer_load_dwordx4 v16, s[44:47], s68 offen  lds
    buffer_load_dwordx4 v17, s[44:47], s68 offen offset:1024  lds
    buffer_load_dwordx4 v18, s[44:47], s68 offen offset:2048  lds
    buffer_load_dwordx4 v19, s[44:47], s68 offen offset:3072  lds
    s_mov_b32 m0, 160512
    s_mov_b32 s68, L_table-L_pc+28
    buffer_load_dword off, s[64:67], s68 lds
    s_waitcnt vmcnt(38)
    s_mov_b32 m0, 81920
    s_add_u32 s68, s75, 262144
    buffer_load_dwordx4 v16, s[44:47], s68 offen  lds
    buffer_load_dwordx4 v17, s[44:47], s68 offen offset:1024  lds
    buffer_load_dwordx4 v18, s[44:47], s68 offen offset:2048  lds
    buffer_load_dwordx4 v19, s[44:47], s68 offen offset:3072  lds
    s_waitcnt vmcnt(38)
    s_mov_b32 m0, 86016
    s_add_u32 s68, s75, 393216
    buffer_load_dwordx4 v16, s[44:47], s68 offen  lds
    buffer_load_dwordx4 v17, s[44:47], s68 offen offset:1024  lds
    buffer_load_dwordx4 v18, s[44:47], s68 offen offset:2048  lds
    buffer_load_dwordx4 v19, s[44:47], s68 offen offset:3072  lds
    s_mov_b32 m0, 160512
    s_mov_b32 s68, L_table-L_pc+32
    buffer_load_dword off, s[64:67], s68 lds
    s_waitcnt vmcnt(38)
    s_mov_b32 m0, 24576
    s_mov_b32 s68, 24576
    buffer_load_dwordx4 v8, s[32:35], s68 offen nt lds
    buffer_load_dwordx4 v9, s[32:35], s68 offen offset:1024 nt lds
    buffer_load_dwordx4 v10, s[32:35], s68 offen offset:2048 nt lds
    buffer_load_dwordx4 v11, s[32:35], s68 offen offset:3072 nt lds
    s_waitcnt vmcnt(38)
    s_mov_b32 m0, 28672
    s_mov_b32 s68, 28672
    buffer_load_dwordx4 v8, s[32:35], s68 offen nt lds
    buffer_load_dwordx4 v9, s[32:35], s68 offen offset:1024 nt lds
    buffer_load_dwordx4 v10, s[32:35], s68 offen offset:2048 nt lds
    buffer_load_dwordx4 v11, s[32:35], s68 offen offset:3072 nt lds
    s_waitcnt vmcnt(38)
    s_mov_b32 m0, 32768
    s_mov_b32 s68, 32768
    buffer_load_dwordx4 v8, s[32:35], s68 offen nt lds
    buffer_load_dwordx4 v9, s[32:35], s68 offen offset:1024 nt lds
    buffer_load_dwordx4 v10, s[32:35], s68 offen offset:2048 nt lds
    buffer_load_dwordx4 v11, s[32:35], s68 offen offset:3072 nt lds
    s_waitcnt vmcnt(38)
    s_mov_b32 m0, 36864
    s_mov_b32 s68, 36864
    buffer_load_dwordx4 v8, s[32:35], s68 offen nt lds
    buffer_load_dwordx4 v9, s[32:35], s68 offen offset:1024 nt lds
    buffer_load_dwordx4 v10, s[32:35], s68 offen offset:2048 nt lds
    buffer_load_dwordx4 v11, s[32:35], s68 offen offset:3072 nt lds
    s_waitcnt vmcnt(38)
    s_mov_b32 m0, 40960
    s_mov_b32 s68, 40960
    buffer_load_dwordx4 v8, s[32:35], s68 offen nt lds
    buffer_load_dwordx4 v9, s[32:35], s68 offen offset:1024 nt lds
    buffer_load_dwordx4 v10, s[32:35], s68 offen offset:2048 nt lds
    buffer_load_dwordx4 v11, s[32:35], s68 offen offset:3072 nt lds
    s_waitcnt vmcnt(38)
    s_mov_b32 m0, 45056
    s_mov_b32 s68, 45056
    buffer_load_dwordx4 v8, s[32:35], s68 offen nt lds
    buffer_load_dwordx4 v9, s[32:35], s68 offen offset:1024 nt lds
    buffer_load_dwordx4 v10, s[32:35], s68 offen offset:2048 nt lds
    buffer_load_dwordx4 v11, s[32:35], s68 offen offset:3072 nt lds
    s_getpc_b64 s[12:13]
    s_cmp_ge_u32 s69, 2
    s_cbranch_scc0 L_lrefresh
    s_add_u32 s15, s8, 4
    s_and_b32 s15, s15, 7
    s_lshl_b32 s75, s15, 19
    s_lshl_b32 s82, s15, 7
    s_waitcnt vmcnt(38)
    s_mov_b32 m0, 118784
    s_add_u32 s68, s82, 0
    buffer_load_dwordx4 v20, s[40:43], s68 offen  lds
    buffer_load_dwordx4 v21, s[40:43], s68 offen offset:1024  lds
    buffer_load_dwordx4 v22, s[40:43], s68 offen offset:2048  lds
    buffer_load_dwordx4 v23, s[40:43], s68 offen offset:3072  lds
    s_waitcnt vmcnt(38)
    s_mov_b32 m0, 122880
    s_add_u32 s68, s82, 32768
    buffer_load_dwordx4 v20, s[40:43], s68 offen  lds
    buffer_load_dwordx4 v21, s[40:43], s68 offen offset:1024  lds
    buffer_load_dwordx4 v22, s[40:43], s68 offen offset:2048  lds
    buffer_load_dwordx4 v23, s[40:43], s68 offen offset:3072  lds
    s_waitcnt vmcnt(38)
    s_mov_b32 m0, 126976
    s_add_u32 s68, s82, 65536
    buffer_load_dwordx4 v20, s[40:43], s68 offen  lds
    buffer_load_dwordx4 v21, s[40:43], s68 offen offset:1024  lds
    buffer_load_dwordx4 v22, s[40:43], s68 offen offset:2048  lds
    buffer_load_dwordx4 v23, s[40:43], s68 offen offset:3072  lds
    s_waitcnt vmcnt(38)
    s_mov_b32 m0, 102400
    s_add_u32 s68, s75, 0
    buffer_load_dwordx4 v16, s[44:47], s68 offen  lds
    buffer_load_dwordx4 v17, s[44:47], s68 offen offset:1024  lds
    buffer_load_dwordx4 v18, s[44:47], s68 offen offset:2048  lds
    buffer_load_dwordx4 v19, s[44:47], s68 offen offset:3072  lds
    s_waitcnt vmcnt(38)
    s_mov_b32 m0, 106496
    s_add_u32 s68, s75, 131072
    buffer_load_dwordx4 v16, s[44:47], s68 offen  lds
    buffer_load_dwordx4 v17, s[44:47], s68 offen offset:1024  lds
    buffer_load_dwordx4 v18, s[44:47], s68 offen offset:2048  lds
    buffer_load_dwordx4 v19, s[44:47], s68 offen offset:3072  lds
    s_mov_b32 m0, 160512
    s_mov_b32 s68, L_table-L_pc+36
    buffer_load_dword off, s[64:67], s68 lds
    s_waitcnt vmcnt(38)
    s_mov_b32 m0, 110592
    s_add_u32 s68, s75, 262144
    buffer_load_dwordx4 v16, s[44:47], s68 offen  lds
    buffer_load_dwordx4 v17, s[44:47], s68 offen offset:1024  lds
    buffer_load_dwordx4 v18, s[44:47], s68 offen offset:2048  lds
    buffer_load_dwordx4 v19, s[44:47], s68 offen offset:3072  lds
    s_waitcnt vmcnt(38)
    s_mov_b32 m0, 114688
    s_add_u32 s68, s75, 393216
    buffer_load_dwordx4 v16, s[44:47], s68 offen  lds
    buffer_load_dwordx4 v17, s[44:47], s68 offen offset:1024  lds
    buffer_load_dwordx4 v18, s[44:47], s68 offen offset:2048  lds
    buffer_load_dwordx4 v19, s[44:47], s68 offen offset:3072  lds
    s_mov_b32 m0, 160512
    s_mov_b32 s68, L_table-L_pc+40
    buffer_load_dword off, s[64:67], s68 lds
    s_getpc_b64 s[12:13]
    s_cmp_ge_u32 s69, 3
    s_cbranch_scc0 L_lrefresh
    s_add_u32 s15, s8, 5
    s_and_b32 s15, s15, 7
    s_lshl_b32 s75, s15, 19
    s_lshl_b32 s82, s15, 7
    s_waitcnt vmcnt(38)
    s_mov_b32 m0, 147456
    s_add_u32 s68, s82, 0
    buffer_load_dwordx4 v20, s[40:43], s68 offen  lds
    buffer_load_dwordx4 v21, s[40:43], s68 offen offset:1024  lds
    buffer_load_dwordx4 v22, s[40:43], s68 offen offset:2048  lds
    buffer_load_dwordx4 v23, s[40:43], s68 offen offset:3072  lds
    s_waitcnt vmcnt(38)
    s_mov_b32 m0, 151552
    s_add_u32 s68, s82, 32768
    buffer_load_dwordx4 v20, s[40:43], s68 offen  lds
    buffer_load_dwordx4 v21, s[40:43], s68 offen offset:1024  lds
    buffer_load_dwordx4 v22, s[40:43], s68 offen offset:2048  lds
    buffer_load_dwordx4 v23, s[40:43], s68 offen offset:3072  lds
    s_waitcnt vmcnt(38)
    s_mov_b32 m0, 155648
    s_add_u32 s68, s82, 65536
    buffer_load_dwordx4 v20, s[40:43], s68 offen  lds
    buffer_load_dwordx4 v21, s[40:43], s68 offen offset:1024  lds
    buffer_load_dwordx4 v22, s[40:43], s68 offen offset:2048  lds
    buffer_load_dwordx4 v23, s[40:43], s68 offen offset:3072  lds
    s_waitcnt vmcnt(38)
    s_mov_b32 m0, 131072
    s_add_u32 s68, s75, 0
    buffer_load_dwordx4 v16, s[44:47], s68 offen  lds
    buffer_load_dwordx4 v17, s[44:47], s68 offen offset:1024  lds
    buffer_load_dwordx4 v18, s[44:47], s68 offen offset:2048  lds
    buffer_load_dwordx4 v19, s[44:47], s68 offen offset:3072  lds
    s_waitcnt vmcnt(38)
    s_mov_b32 m0, 135168
    s_add_u32 s68, s75, 131072
    buffer_load_dwordx4 v16, s[44:47], s68 offen  lds
    buffer_load_dwordx4 v17, s[44:47], s68 offen offset:1024  lds
    buffer_load_dwordx4 v18, s[44:47], s68 offen offset:2048  lds
    buffer_load_dwordx4 v19, s[44:47], s68 offen offset:3072  lds
    s_mov_b32 m0, 160512
    s_mov_b32 s68, L_table-L_pc+44
    buffer_load_dword off, s[64:67], s68 lds
    s_waitcnt vmcnt(38)
    s_mov_b32 m0, 139264
    s_add_u32 s68, s75, 262144
    buffer_load_dwordx4 v16, s[44:47], s68 offen  lds
    buffer_load_dwordx4 v17, s[44:47], s68 offen offset:1024  lds
    buffer_load_dwordx4 v18, s[44:47], s68 offen offset:2048  lds
    buffer_load_dwordx4 v19, s[44:47], s68 offen offset:3072  lds
    s_waitcnt vmcnt(38)
    s_mov_b32 m0, 143360
    s_add_u32 s68, s75, 393216
    buffer_load_dwordx4 v16, s[44:47], s68 offen  lds
    buffer_load_dwordx4 v17, s[44:47], s68 offen offset:1024  lds
    buffer_load_dwordx4 v18, s[44:47], s68 offen offset:2048  lds
    buffer_load_dwordx4 v19, s[44:47], s68 offen offset:3072  lds
    s_mov_b32 m0, 160512
    s_mov_b32 s68, L_table-L_pc+48
    buffer_load_dword off, s[64:67], s68 lds
    s_waitcnt vmcnt(38)
    s_mov_b32 m0, 49152
    s_mov_b32 s68, 49152
    buffer_load_dwordx4 v8, s[32:35], s68 offen nt lds
    buffer_load_dwordx4 v9, s[32:35], s68 offen offset:1024 nt lds
    buffer_load_dwordx4 v10, s[32:35], s68 offen offset:2048 nt lds
    buffer_load_dwordx4 v11, s[32:35], s68 offen offset:3072 nt lds
    s_waitcnt vmcnt(38)
    s_mov_b32 m0, 53248
    s_mov_b32 s68, 53248
    buffer_load_dwordx4 v8, s[32:35], s68 offen nt lds
    buffer_load_dwordx4 v9, s[32:35], s68 offen offset:1024 nt lds
    buffer_load_dwordx4 v10, s[32:35], s68 offen offset:2048 nt lds
    buffer_load_dwordx4 v11, s[32:35], s68 offen offset:3072 nt lds
    s_waitcnt vmcnt(38)
    s_mov_b32 m0, 57344
    s_mov_b32 s68, 57344
    buffer_load_dwordx4 v8, s[32:35], s68 offen nt lds
    buffer_load_dwordx4 v9, s[32:35], s68 offen offset:1024 nt lds
    buffer_load_dwordx4 v10, s[32:35], s68 offen offset:2048 nt lds
    buffer_load_dwordx4 v11, s[32:35], s68 offen offset:3072 nt lds
    s_waitcnt vmcnt(38)
    s_mov_b32 m0, 61440
    s_mov_b32 s68, 61440
    buffer_load_dwordx4 v8, s[32:35], s68 offen nt lds
    buffer_load_dwordx4 v9, s[32:35], s68 offen offset:1024 nt lds
    buffer_load_dwordx4 v10, s[32:35], s68 offen offset:2048 nt lds
    buffer_load_dwordx4 v11, s[32:35], s68 offen offset:3072 nt lds
    s_waitcnt vmcnt(38)
    s_mov_b32 m0, 65536
    s_mov_b32 s68, 0
    buffer_load_dwordx4 v12, s[36:39], s68 offen nt lds
    buffer_load_dwordx4 v12, s[36:39], s68 offen offset:1024 nt lds
    buffer_load_dwordx4 v12, s[36:39], s68 offen offset:2048 nt lds
    buffer_load_dwordx4 v12, s[36:39], s68 offen offset:3072 nt lds
    s_waitcnt vmcnt(38)
    s_mov_b32 m0, 69632
    s_mov_b32 s68, 4096
    buffer_load_dwordx4 v12, s[36:39], s68 offen nt lds
    buffer_load_dwordx4 v12, s[36:39], s68 offen offset:1024 nt lds
    buffer_load_dwordx4 v12, s[36:39], s68 offen offset:2048 nt lds
    buffer_load_dwordx4 v12, s[36:39], s68 offen offset:3072 nt lds
    s_getpc_b64 s[12:13]
    s_cmp_ge_u32 s69, 4
    s_cbranch_scc0 L_lrefresh
    s_add_u32 s15, s8, 6
    s_and_b32 s15, s15, 7
    s_lshl_b32 s75, s15, 19
    s_lshl_b32 s82, s15, 7
    s_waitcnt vmcnt(38)
    s_mov_b32 m0, 90112
    s_add_u32 s68, s82, 0
    buffer_load_dwordx4 v20, s[40:43], s68 offen  lds
    buffer_load_dwordx4 v21, s[40:43], s68 offen offset:1024  lds
    buffer_load_dwordx4 v22, s[40:43], s68 offen offset:2048  lds
    buffer_load_dwordx4 v23, s[40:43], s68 offen offset:3072  lds
    s_waitcnt vmcnt(38)
    s_mov_b32 m0, 94208
    s_add_u32 s68, s82, 32768
    buffer_load_dwordx4 v20, s[40:43], s68 offen  lds
    buffer_load_dwordx4 v21, s[40:43], s68 offen offset:1024  lds
    buffer_load_dwordx4 v22, s[40:43], s68 offen offset:2048  lds
    buffer_load_dwordx4 v23, s[40:43], s68 offen offset:3072  lds
    s_waitcnt vmcnt(38)
    s_mov_b32 m0, 98304
    s_add_u32 s68, s82, 65536
    buffer_load_dwordx4 v20, s[40:43], s68 offen  lds
    buffer_load_dwordx4 v21, s[40:43], s68 offen offset:1024  lds
    buffer_load_dwordx4 v22, s[40:43], s68 offen offset:2048  lds
    buffer_load_dwordx4 v23, s[40:43], s68 offen offset:3072  lds
    s_waitcnt vmcnt(38)
    s_mov_b32 m0, 73728
    s_add_u32 s68, s75, 0
    buffer_load_dwordx4 v16, s[44:47], s68 offen  lds
    buffer_load_dwordx4 v17, s[44:47], s68 offen offset:1024  lds
    buffer_load_dwordx4 v18, s[44:47], s68 offen offset:2048  lds
    buffer_load_dwordx4 v19, s[44:47], s68 offen offset:3072  lds
    s_waitcnt vmcnt(38)
    s_mov_b32 m0, 77824
    s_add_u32 s68, s75, 131072
    buffer_load_dwordx4 v16, s[44:47], s68 offen  lds
    buffer_load_dwordx4 v17, s[44:47], s68 offen offset:1024  lds
    buffer_load_dwordx4 v18, s[44:47], s68 offen offset:2048  lds
    buffer_load_dwordx4 v19, s[44:47], s68 offen offset:3072  lds
    s_mov_b32 m0, 160512
    s_mov_b32 s68, L_table-L_pc+52
    buffer_load_dword off, s[64:67], s68 lds
    s_waitcnt vmcnt(38)
    s_mov_b32 m0, 81920
    s_add_u32 s68, s75, 262144
    buffer_load_dwordx4 v16, s[44:47], s68 offen  lds
    buffer_load_dwordx4 v17, s[44:47], s68 offen offset:1024  lds
    buffer_load_dwordx4 v18, s[44:47], s68 offen offset:2048  lds
    buffer_load_dwordx4 v19, s[44:47], s68 offen offset:3072  lds
    s_waitcnt vmcnt(38)
    s_mov_b32 m0, 86016
    s_add_u32 s68, s75, 393216
    buffer_load_dwordx4 v16, s[44:47], s68 offen  lds
    buffer_load_dwordx4 v17, s[44:47], s68 offen offset:1024  lds
    buffer_load_dwordx4 v18, s[44:47], s68 offen offset:2048  lds
    buffer_load_dwordx4 v19, s[44:47], s68 offen offset:3072  lds
    s_mov_b32 m0, 160512
    s_mov_b32 s68, L_table-L_pc+56
    buffer_load_dword off, s[64:67], s68 lds
    s_waitcnt vmcnt(38)
    s_mov_b32 m0, 0
    s_mov_b32 s68, 8192
    buffer_load_dwordx4 v12, s[36:39], s68 offen nt lds
    buffer_load_dwordx4 v12, s[36:39], s68 offen offset:1024 nt lds
    buffer_load_dwordx4 v12, s[36:39], s68 offen offset:2048 nt lds
    buffer_load_dwordx4 v12, s[36:39], s68 offen offset:3072 nt lds
    s_waitcnt vmcnt(38)
    s_mov_b32 m0, 4096
    s_mov_b32 s68, 12288
    buffer_load_dwordx4 v12, s[36:39], s68 offen nt lds
    buffer_load_dwordx4 v12, s[36:39], s68 offen offset:1024 nt lds
    buffer_load_dwordx4 v12, s[36:39], s68 offen offset:2048 nt lds
    buffer_load_dwordx4 v12, s[36:39], s68 offen offset:3072 nt lds
    s_waitcnt vmcnt(38)
    s_mov_b32 m0, 8192
    s_mov_b32 s68, 16384
    buffer_load_dwordx4 v12, s[36:39], s68 offen nt lds
    buffer_load_dwordx4 v12, s[36:39], s68 offen offset:1024 nt lds
    buffer_load_dwordx4 v12, s[36:39], s68 offen offset:2048 nt lds
    buffer_load_dwordx4 v12, s[36:39], s68 offen offset:3072 nt lds
    s_waitcnt vmcnt(38)
    s_mov_b32 m0, 12288
    s_mov_b32 s68, 20480
    buffer_load_dwordx4 v12, s[36:39], s68 offen nt lds
    buffer_load_dwordx4 v12, s[36:39], s68 offen offset:1024 nt lds
    buffer_load_dwordx4 v12, s[36:39], s68 offen offset:2048 nt lds
    buffer_load_dwordx4 v12, s[36:39], s68 offen offset:3072 nt lds
    s_waitcnt vmcnt(38)
    s_mov_b32 m0, 16384
    s_mov_b32 s68, 24576
    buffer_load_dwordx4 v12, s[36:39], s68 offen nt lds
    buffer_load_dwordx4 v12, s[36:39], s68 offen offset:1024 nt lds
    buffer_load_dwordx4 v12, s[36:39], s68 offen offset:2048 nt lds
    buffer_load_dwordx4 v12, s[36:39], s68 offen offset:3072 nt lds
    s_waitcnt vmcnt(38)
    s_mov_b32 m0, 20480
    s_mov_b32 s68, 28672
    buffer_load_dwordx4 v12, s[36:39], s68 offen nt lds
    buffer_load_dwordx4 v12, s[36:39], s68 offen offset:1024 nt lds
    buffer_load_dwordx4 v12, s[36:39], s68 offen offset:2048 nt lds
    buffer_load_dwordx4 v12, s[36:39], s68 offen offset:3072 nt lds
    s_getpc_b64 s[12:13]
    s_cmp_ge_u32 s69, 5
    s_cbranch_scc0 L_lrefresh
    s_add_u32 s15, s8, 7
    s_and_b32 s15, s15, 7
    s_lshl_b32 s75, s15, 19
    s_lshl_b32 s82, s15, 7
    s_waitcnt vmcnt(38)
    s_mov_b32 m0, 118784
    s_add_u32 s68, s82, 0
    buffer_load_dwordx4 v20, s[40:43], s68 offen  lds
    buffer_load_dwordx4 v21, s[40:43], s68 offen offset:1024  lds
    buffer_load_dwordx4 v22, s[40:43], s68 offen offset:2048  lds
    buffer_load_dwordx4 v23, s[40:43], s68 offen offset:3072  lds
    s_waitcnt vmcnt(38)
    s_mov_b32 m0, 122880
    s_add_u32 s68, s82, 32768
    buffer_load_dwordx4 v20, s[40:43], s68 offen  lds
    buffer_load_dwordx4 v21, s[40:43], s68 offen offset:1024  lds
    buffer_load_dwordx4 v22, s[40:43], s68 offen offset:2048  lds
    buffer_load_dwordx4 v23, s[40:43], s68 offen offset:3072  lds
    s_waitcnt vmcnt(38)
    s_mov_b32 m0, 126976
    s_add_u32 s68, s82, 65536
    buffer_load_dwordx4 v20, s[40:43], s68 offen  lds
    buffer_load_dwordx4 v21, s[40:43], s68 offen offset:1024  lds
    buffer_load_dwordx4 v22, s[40:43], s68 offen offset:2048  lds
    buffer_load_dwordx4 v23, s[40:43], s68 offen offset:3072  lds
    s_waitcnt vmcnt(38)
    s_mov_b32 m0, 102400
    s_add_u32 s68, s75, 0
    buffer_load_dwordx4 v16, s[44:47], s68 offen  lds
    buffer_load_dwordx4 v17, s[44:47], s68 offen offset:1024  lds
    buffer_load_dwordx4 v18, s[44:47], s68 offen offset:2048  lds
    buffer_load_dwordx4 v19, s[44:47], s68 offen offset:3072  lds
    s_waitcnt vmcnt(38)
    s_mov_b32 m0, 106496
    s_add_u32 s68, s75, 131072
    buffer_load_dwordx4 v16, s[44:47], s68 offen  lds
    buffer_load_dwordx4 v17, s[44:47], s68 offen offset:1024  lds
    buffer_load_dwordx4 v18, s[44:47], s68 offen offset:2048  lds
    buffer_load_dwordx4 v19, s[44:47], s68 offen offset:3072  lds
    s_mov_b32 m0, 160512
    s_mov_b32 s68, L_table-L_pc+60
    buffer_load_dword off, s[64:67], s68 lds
    s_waitcnt vmcnt(38)
    s_mov_b32 m0, 110592
    s_add_u32 s68, s75, 262144
    buffer_load_dwordx4 v16, s[44:47], s68 offen  lds
    buffer_load_dwordx4 v17, s[44:47], s68 offen offset:1024  lds
    buffer_load_dwordx4 v18, s[44:47], s68 offen offset:2048  lds
    buffer_load_dwordx4 v19, s[44:47], s68 offen offset:3072  lds
    s_waitcnt vmcnt(38)
    s_mov_b32 m0, 114688
    s_add_u32 s68, s75, 393216
    buffer_load_dwordx4 v16, s[44:47], s68 offen  lds
    buffer_load_dwordx4 v17, s[44:47], s68 offen offset:1024  lds
    buffer_load_dwordx4 v18, s[44:47], s68 offen offset:2048  lds
    buffer_load_dwordx4 v19, s[44:47], s68 offen offset:3072  lds
    s_mov_b32 m0, 160512
    s_mov_b32 s68, L_table-L_pc+64
    buffer_load_dword off, s[64:67], s68 lds
    s_waitcnt vmcnt(38)
    s_add_u32 s68, s80, 0
    buffer_load_dword v31, v44, s[52:55], s68 offen
    s_waitcnt vmcnt(38)
    s_add_u32 s68, s80, 8192
    buffer_load_dword v31, v44, s[52:55], s68 offen
    s_mov_b32 m0, 24576
    s_mov_b32 s68, 65536
    s_add_u32 s78, s77, 51
    s_lshr_b32 s74, s78, 4
    s_lshl_b32 s74, s74, 22
    s_and_b32 s78, s78, 15
    s_or_b32 s78, s78, s74
L_w1:
    s_getreg_b32 s74, hwreg(HW_REG_IB_STS)
    s_and_b32 s74, s74, s76
    s_cmp_gt_u32 s74, s78
    s_cbranch_scc1 L_w1
    buffer_load_dwordx4 v8, s[32:35], s68 offen nt lds
    buffer_load_dwordx4 v9, s[32:35], s68 offen offset:1024 nt lds
    buffer_load_dwordx4 v10, s[32:35], s68 offen offset:2048 nt lds
    buffer_load_dwordx4 v11, s[32:35], s68 offen offset:3072 nt lds
    ds_read_b32 v46, v24
    s_mov_b32 m0, 28672
    s_mov_b32 s68, 69632
L_w2:
    s_getreg_b32 s74, hwreg(HW_REG_IB_STS)
    s_and_b32 s74, s74, s76
    s_cmp_gt_u32 s74, s78
    s_cbranch_scc1 L_w2
    buffer_load_dwordx4 v8, s[32:35], s68 offen nt lds
    buffer_load_dwordx4 v9, s[32:35], s68 offen offset:1024 nt lds
    buffer_load_dwordx4 v10, s[32:35], s68 offen offset:2048 nt lds
    buffer_load_dwordx4 v11, s[32:35], s68 offen offset:3072 nt lds
    s_waitcnt lgkmcnt(0)
    v_readlane_b32 s15, v46, 0
    v_readlane_b32 s9, v46, 1
    v_readlane_b32 s14, v46, 2
    v_readlane_b32 s77, v46, 4
    s_min_u32 s15, s15, s9
    s_min_u32 s69, s15, s14
    s_mov_b32 m0, 160512
    s_mov_b32 s68, L_table-L_pc+68
    buffer_load_dword off, s[64:67], s68 lds
    s_getpc_b64 s[12:13]
    s_cmp_ge_u32 s69, 6
    s_cbranch_scc0 L_lrefresh
    s_mov_b32 m0, 131072
    s_mov_b32 s68, 73728
    s_add_u32 s78, s77, 52
    s_lshr_b32 s74, s78, 4
    s_lshl_b32 s74, s74, 22
    s_and_b32 s78, s78, 15
    s_or_b32 s78, s78, s74
L_w3:
    s_getreg_b32 s74, hwreg(HW_REG_IB_STS)
    s_and_b32 s74, s74, s76
    s_cmp_gt_u32 s74, s78
    s_cbranch_scc1 L_w3
    buffer_load_dwordx4 v8, s[32:35], s68 offen nt lds
    buffer_load_dwordx4 v9, s[32:35], s68 offen offset:1024 nt lds
    buffer_load_dwordx4 v10, s[32:35], s68 offen offset:2048 nt lds
    buffer_load_dwordx4 v11, s[32:35], s68 offen offset:3072 nt lds
    ds_read_b32 v46, v24
    s_mov_b32 m0, 135168
    s_mov_b32 s68, 77824
L_w4:
    s_getreg_b32 s74, hwreg(HW_REG_IB_STS)
    s_and_b32 s74, s74, s76
    s_cmp_gt_u32 s74, s78
    s_cbranch_scc1 L_w4
    buffer_load_dwordx4 v8, s[32:35], s68 offen nt lds
    buffer_load_dwordx4 v9, s[32:35], s68 offen offset:1024 nt lds
    buffer_load_dwordx4 v10, s[32:35], s68 offen offset:2048 nt lds
    buffer_load_dwordx4 v11, s[32:35], s68 offen offset:3072 nt lds
    s_waitcnt lgkmcnt(0)
    v_readlane_b32 s15, v46, 0
    v_readlane_b32 s9, v46, 1
    v_readlane_b32 s14, v46, 2
    v_readlane_b32 s77, v46, 4
    s_min_u32 s15, s15, s9
    s_min_u32 s69, s15, s14
    s_mov_b32 m0, 160512
    s_mov_b32 s68, L_table-L_pc+72
    buffer_load_dword off, s[64:67], s68 lds
    s_mov_b32 m0, 139264
    s_mov_b32 s68, 81920
    s_add_u32 s78, s77, 53
    s_lshr_b32 s74, s78, 4
    s_lshl_b32 s74, s74, 22
    s_and_b32 s78, s78, 15
    s_or_b32 s78, s78, s74
L_w5:
    s_getreg_b32 s74, hwreg(HW_REG_IB_STS)
    s_and_b32 s74, s74, s76
    s_cmp_gt_u32 s74, s78
    s_cbranch_scc1 L_w5
    buffer_load_dwordx4 v8, s[32:35], s68 offen nt lds
    buffer_load_dwordx4 v9, s[32:35], s68 offen offset:1024 nt lds
    buffer_load_dwordx4 v10, s[32:35], s68 offen offset:2048 nt lds
    buffer_load_dwordx4 v11, s[32:35], s68 offen offset:3072 nt lds
    ds_read_b32 v46, v24
    s_mov_b32 m0, 143360
    s_mov_b32 s68, 86016
    s_add_u32 s78, s77, 21
    s_lshr_b32 s74, s78, 4
    s_lshl_b32 s74, s74, 22
    s_and_b32 s78, s78, 15
    s_or_b32 s78, s78, s74
L_w6:
    s_getreg_b32 s74, hwreg(HW_REG_IB_STS)
    s_and_b32 s74, s74, s76
    s_cmp_gt_u32 s74, s78
    s_cbranch_scc1 L_w6
    buffer_load_dwordx4 v8, s[32:35], s68 offen nt lds
    buffer_load_dwordx4 v9, s[32:35], s68 offen offset:1024 nt lds
    buffer_load_dwordx4 v10, s[32:35], s68 offen offset:2048 nt lds
    buffer_load_dwordx4 v11, s[32:35], s68 offen offset:3072 nt lds
    s_waitcnt lgkmcnt(0)
    v_readlane_b32 s15, v46, 0
    v_readlane_b32 s9, v46, 1
    v_readlane_b32 s14, v46, 2
    v_readlane_b32 s77, v46, 4
    s_min_u32 s15, s15, s9
    s_min_u32 s69, s15, s14
    s_mov_b32 m0, 160512
    s_mov_b32 s68, L_table-L_pc+76
    buffer_load_dword off, s[64:67], s68 lds
    s_mov_b32 m0, 147456
    s_mov_b32 s68, 90112
    s_add_u32 s78, s77, 22
    s_lshr_b32 s74, s78, 4
    s_lshl_b32 s74, s74, 22
    s_and_b32 s78, s78, 15
    s_or_b32 s78, s78, s74
L_w7:
    s_getreg_b32 s74, hwreg(HW_REG_IB_STS)
    s_and_b32 s74, s74, s76
    s_cmp_gt_u32 s74, s78
    s_cbranch_scc1 L_w7
    buffer_load_dwordx4 v8, s[32:35], s68 offen nt lds
    buffer_load_dwordx4 v9, s[32:35], s68 offen offset:1024 nt lds
    buffer_load_dwordx4 v10, s[32:35], s68 offen offset:2048 nt lds
    buffer_load_dwordx4 v11, s[32:35], s68 offen offset:3072 nt lds
    ds_read_b32 v46, v24
    s_mov_b32 m0, 151552
    s_mov_b32 s68, 94208
L_w8:
    s_getreg_b32 s74, hwreg(HW_REG_IB_STS)
    s_and_b32 s74, s74, s76
    s_cmp_gt_u32 s74, s78
    s_cbranch_scc1 L_w8
    buffer_load_dwordx4 v8, s[32:35], s68 offen nt lds
    buffer_load_dwordx4 v9, s[32:35], s68 offen offset:1024 nt lds
    buffer_load_dwordx4 v10, s[32:35], s68 offen offset:2048 nt lds
    buffer_load_dwordx4 v11, s[32:35], s68 offen offset:3072 nt lds
    s_waitcnt lgkmcnt(0)
    v_readlane_b32 s15, v46, 0
    v_readlane_b32 s9, v46, 1
    v_readlane_b32 s14, v46, 2
    v_readlane_b32 s77, v46, 4
    s_min_u32 s15, s15, s9
    s_min_u32 s69, s15, s14
    s_mov_b32 m0, 160512
    s_mov_b32 s68, L_table-L_pc+80
    buffer_load_dword off, s[64:67], s68 lds
    s_getpc_b64 s[12:13]
    s_cmp_ge_u32 s69, 7
    s_cbranch_scc0 L_lrefresh
    s_mov_b32 m0, 73728
    s_mov_b32 s68, 32768
    s_add_u32 s78, s77, 22
    s_lshr_b32 s74, s78, 4
    s_lshl_b32 s74, s74, 22
    s_and_b32 s78, s78, 15
    s_or_b32 s78, s78, s74
L_w9:
    s_getreg_b32 s74, hwreg(HW_REG_IB_STS)
    s_and_b32 s74, s74, s76
    s_cmp_gt_u32 s74, s78
    s_cbranch_scc1 L_w9
    buffer_load_dwordx4 v12, s[36:39], s68 offen nt lds
    buffer_load_dwordx4 v12, s[36:39], s68 offen offset:1024 nt lds
    buffer_load_dwordx4 v12, s[36:39], s68 offen offset:2048 nt lds
    buffer_load_dwordx4 v12, s[36:39], s68 offen offset:3072 nt lds
    ds_read_b32 v46, v24
    s_mov_b32 m0, 77824
    s_mov_b32 s68, 36864
L_w10:
    s_getreg_b32 s74, hwreg(HW_REG_IB_STS)
    s_and_b32 s74, s74, s76
    s_cmp_gt_u32 s74, s78
    s_cbranch_scc1 L_w10
    buffer_load_dwordx4 v12, s[36:39], s68 offen nt lds
    buffer_load_dwordx4 v12, s[36:39], s68 offen offset:1024 nt lds
    buffer_load_dwordx4 v12, s[36:39], s68 offen offset:2048 nt lds
    buffer_load_dwordx4 v12, s[36:39], s68 offen offset:3072 nt lds
    s_waitcnt lgkmcnt(0)
    v_readlane_b32 s15, v46, 0
    v_readlane_b32 s9, v46, 1
    v_readlane_b32 s14, v46, 2
    v_readlane_b32 s77, v46, 4
    s_min_u32 s15, s15, s9
    s_min_u32 s69, s15, s14
    s_mov_b32 m0, 160512
    s_mov_b32 s68, L_table-L_pc+88
    buffer_load_dword off, s[64:67], s68 lds
    s_mov_b32 m0, 81920
    s_mov_b32 s68, 40960
    s_add_u32 s78, s77, 22
    s_lshr_b32 s74, s78, 4
    s_lshl_b32 s74, s74, 22
    s_and_b32 s78, s78, 15
    s_or_b32 s78, s78, s74
L_w11:
    s_getreg_b32 s74, hwreg(HW_REG_IB_STS)
    s_and_b32 s74, s74, s76
    s_cmp_gt_u32 s74, s78
    s_cbranch_scc1 L_w11
    buffer_load_dwordx4 v12, s[36:39], s68 offen nt lds
    buffer_load_dwordx4 v12, s[36:39], s68 offen offset:1024 nt lds
    buffer_load_dwordx4 v12, s[36:39], s68 offen offset:2048 nt lds
    buffer_load_dwordx4 v12, s[36:39], s68 offen offset:3072 nt lds
    ds_read_b32 v46, v24
    s_mov_b32 m0, 86016
    s_mov_b32 s68, 45056
L_w12:
    s_getreg_b32 s74, hwreg(HW_REG_IB_STS)
    s_and_b32 s74, s74, s76
    s_cmp_gt_u32 s74, s78
    s_cbranch_scc1 L_w12
    buffer_load_dwordx4 v12, s[36:39], s68 offen nt lds
    buffer_load_dwordx4 v12, s[36:39], s68 offen offset:1024 nt lds
    buffer_load_dwordx4 v12, s[36:39], s68 offen offset:2048 nt lds
    buffer_load_dwordx4 v12, s[36:39], s68 offen offset:3072 nt lds
    s_waitcnt lgkmcnt(0)
    v_readlane_b32 s15, v46, 0
    v_readlane_b32 s9, v46, 1
    v_readlane_b32 s14, v46, 2
    v_readlane_b32 s77, v46, 4
    s_min_u32 s15, s15, s9
    s_min_u32 s69, s15, s14
    s_mov_b32 m0, 160512
    s_mov_b32 s68, L_table-L_pc+92
    buffer_load_dword off, s[64:67], s68 lds
    s_mov_b32 m0, 90112
    s_mov_b32 s68, 49152
    s_add_u32 s78, s77, 22
    s_lshr_b32 s74, s78, 4
    s_lshl_b32 s74, s74, 22
    s_and_b32 s78, s78, 15
    s_or_b32 s78, s78, s74
L_w13:
    s_getreg_b32 s74, hwreg(HW_REG_IB_STS)
    s_and_b32 s74, s74, s76
    s_cmp_gt_u32 s74, s78
    s_cbranch_scc1 L_w13
    buffer_load_dwordx4 v12, s[36:39], s68 offen nt lds
    buffer_load_dwordx4 v12, s[36:39], s68 offen offset:1024 nt lds
    buffer_load_dwordx4 v12, s[36:39], s68 offen offset:2048 nt lds
    buffer_load_dwordx4 v12, s[36:39], s68 offen offset:3072 nt lds
    ds_read_b32 v46, v24
    s_mov_b32 m0, 94208
    s_mov_b32 s68, 53248
L_w14:
    s_getreg_b32 s74, hwreg(HW_REG_IB_STS)
    s_and_b32 s74, s74, s76
    s_cmp_gt_u32 s74, s78
    s_cbranch_scc1 L_w14
    buffer_load_dwordx4 v12, s[36:39], s68 offen nt lds
    buffer_load_dwordx4 v12, s[36:39], s68 offen offset:1024 nt lds
    buffer_load_dwordx4 v12, s[36:39], s68 offen offset:2048 nt lds
    buffer_load_dwordx4 v12, s[36:39], s68 offen offset:3072 nt lds
    s_waitcnt lgkmcnt(0)
    v_readlane_b32 s15, v46, 0
    v_readlane_b32 s9, v46, 1
    v_readlane_b32 s14, v46, 2
    v_readlane_b32 s77, v46, 4
    s_min_u32 s15, s15, s9
    s_min_u32 s69, s15, s14
    s_mov_b32 m0, 160512
    s_mov_b32 s68, L_table-L_pc+96
    buffer_load_dword off, s[64:67], s68 lds
    s_getpc_b64 s[12:13]
    s_cmp_ge_u32 s69, 8
    s_cbranch_scc0 L_lrefresh
    s_mov_b32 m0, 98304
    s_mov_b32 s68, 57344
    s_add_u32 s78, s77, 22
    s_lshr_b32 s74, s78, 4
    s_lshl_b32 s74, s74, 22
    s_and_b32 s78, s78, 15
    s_or_b32 s78, s78, s74
L_w15:
    s_getreg_b32 s74, hwreg(HW_REG_IB_STS)
    s_and_b32 s74, s74, s76
    s_cmp_gt_u32 s74, s78
    s_cbranch_scc1 L_w15
    buffer_load_dwordx4 v12, s[36:39], s68 offen nt lds
    buffer_load_dwordx4 v12, s[36:39], s68 offen offset:1024 nt lds
    buffer_load_dwordx4 v12, s[36:39], s68 offen offset:2048 nt lds
    buffer_load_dwordx4 v12, s[36:39], s68 offen offset:3072 nt lds
    ds_read_b32 v46, v24
    s_mov_b32 m0, 102400
    s_mov_b32 s68, 61440
L_w16:
    s_getreg_b32 s74, hwreg(HW_REG_IB_STS)
    s_and_b32 s74, s74, s76
    s_cmp_gt_u32 s74, s78
    s_cbranch_scc1 L_w16
    buffer_load_dwordx4 v12, s[36:39], s68 offen nt lds
    buffer_load_dwordx4 v12, s[36:39], s68 offen offset:1024 nt lds
    buffer_load_dwordx4 v12, s[36:39], s68 offen offset:2048 nt lds
    buffer_load_dwordx4 v12, s[36:39], s68 offen offset:3072 nt lds
    s_waitcnt lgkmcnt(0)
    v_readlane_b32 s15, v46, 0
    v_readlane_b32 s9, v46, 1
    v_readlane_b32 s14, v46, 2
    v_readlane_b32 s77, v46, 4
    s_min_u32 s15, s15, s9
    s_min_u32 s69, s15, s14
    s_mov_b32 m0, 160512
    s_mov_b32 s68, L_table-L_pc+100
    buffer_load_dword off, s[64:67], s68 lds
    s_mov_b32 m0, 106496
    s_mov_b32 s68, 98304
    s_add_u32 s78, s77, 20
    s_lshr_b32 s74, s78, 4
    s_lshl_b32 s74, s74, 22
    s_and_b32 s78, s78, 15
    s_or_b32 s78, s78, s74
L_w17:
    s_getreg_b32 s74, hwreg(HW_REG_IB_STS)
    s_and_b32 s74, s74, s76
    s_cmp_gt_u32 s74, s78
    s_cbranch_scc1 L_w17
    buffer_load_dwordx4 v8, s[32:35], s68 offen nt lds
    buffer_load_dwordx4 v9, s[32:35], s68 offen offset:1024 nt lds
    buffer_load_dwordx4 v10, s[32:35], s68 offen offset:2048 nt lds
    buffer_load_dwordx4 v11, s[32:35], s68 offen offset:3072 nt lds
    ds_read_b32 v46, v24
    s_mov_b32 m0, 110592
    s_mov_b32 s68, 102400
L_w18:
    s_getreg_b32 s74, hwreg(HW_REG_IB_STS)
    s_and_b32 s74, s74, s76
    s_cmp_gt_u32 s74, s78
    s_cbranch_scc1 L_w18
    buffer_load_dwordx4 v8, s[32:35], s68 offen nt lds
    buffer_load_dwordx4 v9, s[32:35], s68 offen offset:1024 nt lds
    buffer_load_dwordx4 v10, s[32:35], s68 offen offset:2048 nt lds
    buffer_load_dwordx4 v11, s[32:35], s68 offen offset:3072 nt lds
    s_waitcnt lgkmcnt(0)
    v_readlane_b32 s15, v46, 0
    v_readlane_b32 s9, v46, 1
    v_readlane_b32 s14, v46, 2
    v_readlane_b32 s77, v46, 4
    s_min_u32 s15, s15, s9
    s_min_u32 s69, s15, s14
    s_mov_b32 m0, 160512
    s_mov_b32 s68, L_table-L_pc+104
    buffer_load_dword off, s[64:67], s68 lds
    s_mov_b32 m0, 114688
    s_mov_b32 s68, 106496
    s_add_u32 s78, s77, 20
    s_lshr_b32 s74, s78, 4
    s_lshl_b32 s74, s74, 22
    s_and_b32 s78, s78, 15
    s_or_b32 s78, s78, s74
L_w19:
    s_getreg_b32 s74, hwreg(HW_REG_IB_STS)
    s_and_b32 s74, s74, s76
    s_cmp_gt_u32 s74, s78
    s_cbranch_scc1 L_w19
    buffer_load_dwordx4 v8, s[32:35], s68 offen nt lds
    buffer_load_dwordx4 v9, s[32:35], s68 offen offset:1024 nt lds
    buffer_load_dwordx4 v10, s[32:35], s68 offen offset:2048 nt lds
    buffer_load_dwordx4 v11, s[32:35], s68 offen offset:3072 nt lds
    ds_read_b32 v46, v24
    s_mov_b32 m0, 118784
    s_mov_b32 s68, 110592
L_w20:
    s_getreg_b32 s74, hwreg(HW_REG_IB_STS)
    s_and_b32 s74, s74, s76
    s_cmp_gt_u32 s74, s78
    s_cbranch_scc1 L_w20
    buffer_load_dwordx4 v8, s[32:35], s68 offen nt lds
    buffer_load_dwordx4 v9, s[32:35], s68 offen offset:1024 nt lds
    buffer_load_dwordx4 v10, s[32:35], s68 offen offset:2048 nt lds
    buffer_load_dwordx4 v11, s[32:35], s68 offen offset:3072 nt lds
    s_waitcnt lgkmcnt(0)
    v_readlane_b32 s15, v46, 0
    v_readlane_b32 s9, v46, 1
    v_readlane_b32 s14, v46, 2
    v_readlane_b32 s77, v46, 4
    s_min_u32 s15, s15, s9
    s_min_u32 s69, s15, s14
    s_mov_b32 m0, 160512
    s_mov_b32 s68, L_table-L_pc+112
    buffer_load_dword off, s[64:67], s68 lds
    s_mov_b32 m0, 122880
    s_mov_b32 s68, 114688
    s_add_u32 s78, s77, 20
    s_lshr_b32 s74, s78, 4
    s_lshl_b32 s74, s74, 22
    s_and_b32 s78, s78, 15
    s_or_b32 s78, s78, s74
L_w21:
    s_getreg_b32 s74, hwreg(HW_REG_IB_STS)
    s_and_b32 s74, s74, s76
    s_cmp_gt_u32 s74, s78
    s_cbranch_scc1 L_w21
    buffer_load_dwordx4 v8, s[32:35], s68 offen nt lds
    buffer_load_dwordx4 v9, s[32:35], s68 offen offset:1024 nt lds
    buffer_load_dwordx4 v10, s[32:35], s68 offen offset:2048 nt lds
    buffer_load_dwordx4 v11, s[32:35], s68 offen offset:3072 nt lds
    ds_read_b32 v46, v24
    s_mov_b32 m0, 126976
    s_mov_b32 s68, 118784
L_w22:
    s_getreg_b32 s74, hwreg(HW_REG_IB_STS)
    s_and_b32 s74, s74, s76
    s_cmp_gt_u32 s74, s78
    s_cbranch_scc1 L_w22
    buffer_load_dwordx4 v8, s[32:35], s68 offen nt lds
    buffer_load_dwordx4 v9, s[32:35], s68 offen offset:1024 nt lds
    buffer_load_dwordx4 v10, s[32:35], s68 offen offset:2048 nt lds
    buffer_load_dwordx4 v11, s[32:35], s68 offen offset:3072 nt lds
    s_waitcnt lgkmcnt(0)
    v_readlane_b32 s15, v46, 0
    v_readlane_b32 s9, v46, 1
    v_readlane_b32 s14, v46, 2
    v_readlane_b32 s77, v46, 4
    s_min_u32 s15, s15, s9
    s_min_u32 s69, s15, s14
    s_mov_b32 m0, 160512
    s_mov_b32 s68, L_table-L_pc+116
    buffer_load_dword off, s[64:67], s68 lds
    s_getpc_b64 s[12:13]
    s_cmp_ge_u32 s69, 10
    s_cbranch_scc0 L_lrefresh
    s_mov_b32 m0, 32768
    s_mov_b32 s68, 122880
    s_add_u32 s78, s77, 20
    s_lshr_b32 s74, s78, 4
    s_lshl_b32 s74, s74, 22
    s_and_b32 s78, s78, 15
    s_or_b32 s78, s78, s74
L_w23:
    s_getreg_b32 s74, hwreg(HW_REG_IB_STS)
    s_and_b32 s74, s74, s76
    s_cmp_gt_u32 s74, s78
    s_cbranch_scc1 L_w23
    buffer_load_dwordx4 v8, s[32:35], s68 offen nt lds
    buffer_load_dwordx4 v9, s[32:35], s68 offen offset:1024 nt lds
    buffer_load_dwordx4 v10, s[32:35], s68 offen offset:2048 nt lds
    buffer_load_dwordx4 v11, s[32:35], s68 offen offset:3072 nt lds
    ds_read_b32 v46, v24
    s_mov_b32 m0, 36864
    s_mov_b32 s68, 126976
L_w24:
    s_getreg_b32 s74, hwreg(HW_REG_IB_STS)
    s_and_b32 s74, s74, s76
    s_cmp_gt_u32 s74, s78
    s_cbranch_scc1 L_w24
    buffer_load_dwordx4 v8, s[32:35], s68 offen nt lds
    buffer_load_dwordx4 v9, s[32:35], s68 offen offset:1024 nt lds
    buffer_load_dwordx4 v10, s[32:35], s68 offen offset:2048 nt lds
    buffer_load_dwordx4 v11, s[32:35], s68 offen offset:3072 nt lds
    s_waitcnt lgkmcnt(0)
    v_readlane_b32 s15, v46, 0
    v_readlane_b32 s9, v46, 1
    v_readlane_b32 s14, v46, 2
    v_readlane_b32 s77, v46, 4
    s_min_u32 s15, s15, s9
    s_min_u32 s69, s15, s14
    s_mov_b32 m0, 160512
    s_mov_b32 s68, L_table-L_pc+120
    buffer_load_dword off, s[64:67], s68 lds
    s_mov_b32 m0, 40960
    s_mov_b32 s68, 65536
    s_add_u32 s78, s77, 20
    s_lshr_b32 s74, s78, 4
    s_lshl_b32 s74, s74, 22
    s_and_b32 s78, s78, 15
    s_or_b32 s78, s78, s74
L_w25:
    s_getreg_b32 s74, hwreg(HW_REG_IB_STS)
    s_and_b32 s74, s74, s76
    s_cmp_gt_u32 s74, s78
    s_cbranch_scc1 L_w25
    buffer_load_dwordx4 v12, s[36:39], s68 offen nt lds
    buffer_load_dwordx4 v12, s[36:39], s68 offen offset:1024 nt lds
    buffer_load_dwordx4 v12, s[36:39], s68 offen offset:2048 nt lds
    buffer_load_dwordx4 v12, s[36:39], s68 offen offset:3072 nt lds
    ds_read_b32 v46, v24
    s_mov_b32 m0, 45056
    s_mov_b32 s68, 69632
L_w26:
    s_getreg_b32 s74, hwreg(HW_REG_IB_STS)
    s_and_b32 s74, s74, s76
    s_cmp_gt_u32 s74, s78
    s_cbranch_scc1 L_w26
    buffer_load_dwordx4 v12, s[36:39], s68 offen nt lds
    buffer_load_dwordx4 v12, s[36:39], s68 offen offset:1024 nt lds
    buffer_load_dwordx4 v12, s[36:39], s68 offen offset:2048 nt lds
    buffer_load_dwordx4 v12, s[36:39], s68 offen offset:3072 nt lds
    s_waitcnt lgkmcnt(0)
    v_readlane_b32 s15, v46, 0
    v_readlane_b32 s9, v46, 1
    v_readlane_b32 s14, v46, 2
    v_readlane_b32 s77, v46, 4
    s_min_u32 s15, s15, s9
    s_min_u32 s69, s15, s14
    s_mov_b32 m0, 160512
    s_mov_b32 s68, L_table-L_pc+124
    buffer_load_dword off, s[64:67], s68 lds
    s_getpc_b64 s[12:13]
    s_cmp_ge_u32 s69, 11
    s_cbranch_scc0 L_lrefresh
    s_mov_b32 m0, 49152
    s_mov_b32 s68, 73728
    s_add_u32 s78, s77, 20
    s_lshr_b32 s74, s78, 4
    s_lshl_b32 s74, s74, 22
    s_and_b32 s78, s78, 15
    s_or_b32 s78, s78, s74
L_w27:
    s_getreg_b32 s74, hwreg(HW_REG_IB_STS)
    s_and_b32 s74, s74, s76
    s_cmp_gt_u32 s74, s78
    s_cbranch_scc1 L_w27
    buffer_load_dwordx4 v12, s[36:39], s68 offen nt lds
    buffer_load_dwordx4 v12, s[36:39], s68 offen offset:1024 nt lds
    buffer_load_dwordx4 v12, s[36:39], s68 offen offset:2048 nt lds
    buffer_load_dwordx4 v12, s[36:39], s68 offen offset:3072 nt lds
    ds_read_b32 v46, v24
    s_mov_b32 m0, 53248
    s_mov_b32 s68, 77824
L_w28:
    s_getreg_b32 s74, hwreg(HW_REG_IB_STS)
    s_and_b32 s74, s74, s76
    s_cmp_gt_u32 s74, s78
    s_cbranch_scc1 L_w28
    buffer_load_dwordx4 v12, s[36:39], s68 offen nt lds
    buffer_load_dwordx4 v12, s[36:39], s68 offen offset:1024 nt lds
    buffer_load_dwordx4 v12, s[36:39], s68 offen offset:2048 nt lds
    buffer_load_dwordx4 v12, s[36:39], s68 offen offset:3072 nt lds
    s_waitcnt lgkmcnt(0)
    v_readlane_b32 s15, v46, 0
    v_readlane_b32 s9, v46, 1
    v_readlane_b32 s14, v46, 2
    v_readlane_b32 s77, v46, 4
    s_min_u32 s15, s15, s9
    s_min_u32 s69, s15, s14
    s_mov_b32 m0, 160512
    s_mov_b32 s68, L_table-L_pc+128
    buffer_load_dword off, s[64:67], s68 lds
    s_mov_b32 m0, 57344
    s_mov_b32 s68, 81920
    s_add_u32 s78, s77, 20
    s_lshr_b32 s74, s78, 4
    s_lshl_b32 s74, s74, 22
    s_and_b32 s78, s78, 15
    s_or_b32 s78, s78, s74
L_w29:
    s_getreg_b32 s74, hwreg(HW_REG_IB_STS)
    s_and_b32 s74, s74, s76
    s_cmp_gt_u32 s74, s78
    s_cbranch_scc1 L_w29
    buffer_load_dwordx4 v12, s[36:39], s68 offen nt lds
    buffer_load_dwordx4 v12, s[36:39], s68 offen offset:1024 nt lds
    buffer_load_dwordx4 v12, s[36:39], s68 offen offset:2048 nt lds
    buffer_load_dwordx4 v12, s[36:39], s68 offen offset:3072 nt lds
    ds_read_b32 v46, v24
    s_mov_b32 m0, 61440
    s_mov_b32 s68, 86016
L_w30:
    s_getreg_b32 s74, hwreg(HW_REG_IB_STS)
    s_and_b32 s74, s74, s76
    s_cmp_gt_u32 s74, s78
    s_cbranch_scc1 L_w30
    buffer_load_dwordx4 v12, s[36:39], s68 offen nt lds
    buffer_load_dwordx4 v12, s[36:39], s68 offen offset:1024 nt lds
    buffer_load_dwordx4 v12, s[36:39], s68 offen offset:2048 nt lds
    buffer_load_dwordx4 v12, s[36:39], s68 offen offset:3072 nt lds
    s_waitcnt lgkmcnt(0)
    v_readlane_b32 s15, v46, 0
    v_readlane_b32 s9, v46, 1
    v_readlane_b32 s14, v46, 2
    v_readlane_b32 s77, v46, 4
    s_min_u32 s15, s15, s9
    s_min_u32 s69, s15, s14
    s_mov_b32 m0, 160512
    s_mov_b32 s68, L_table-L_pc+136
    buffer_load_dword off, s[64:67], s68 lds
    s_getpc_b64 s[12:13]
    s_cmp_ge_u32 s69, 12
    s_cbranch_scc0 L_lrefresh
    s_mov_b32 m0, 0
    s_mov_b32 s68, 90112
    s_add_u32 s78, s77, 20
    s_lshr_b32 s74, s78, 4
    s_lshl_b32 s74, s74, 22
    s_and_b32 s78, s78, 15
    s_or_b32 s78, s78, s74
L_w31:
    s_getreg_b32 s74, hwreg(HW_REG_IB_STS)
    s_and_b32 s74, s74, s76
    s_cmp_gt_u32 s74, s78
    s_cbranch_scc1 L_w31
    buffer_load_dwordx4 v12, s[36:39], s68 offen nt lds
    buffer_load_dwordx4 v12, s[36:39], s68 offen offset:1024 nt lds
    buffer_load_dwordx4 v12, s[36:39], s68 offen offset:2048 nt lds
    buffer_load_dwordx4 v12, s[36:39], s68 offen offset:3072 nt lds
    ds_read_b32 v46, v24
    s_mov_b32 m0, 4096
    s_mov_b32 s68, 94208
L_w32:
    s_getreg_b32 s74, hwreg(HW_REG_IB_STS)
    s_and_b32 s74, s74, s76
    s_cmp_gt_u32 s74, s78
    s_cbranch_scc1 L_w32
    buffer_load_dwordx4 v12, s[36:39], s68 offen nt lds
    buffer_load_dwordx4 v12, s[36:39], s68 offen offset:1024 nt lds
    buffer_load_dwordx4 v12, s[36:39], s68 offen offset:2048 nt lds
    buffer_load_dwordx4 v12, s[36:39], s68 offen offset:3072 nt lds
    s_waitcnt lgkmcnt(0)
    v_readlane_b32 s15, v46, 0
    v_readlane_b32 s9, v46, 1
    v_readlane_b32 s14, v46, 2
    v_readlane_b32 s77, v46, 4
    s_min_u32 s15, s15, s9
    s_min_u32 s69, s15, s14
    s_mov_b32 m0, 160512
    s_mov_b32 s68, L_table-L_pc+140
    buffer_load_dword off, s[64:67], s68 lds
    s_mov_b32 m0, 65536
    s_mov_b32 s68, 131072
    s_add_u32 s78, s77, 20
    s_lshr_b32 s74, s78, 4
    s_lshl_b32 s74, s74, 22
    s_and_b32 s78, s78, 15
    s_or_b32 s78, s78, s74
L_w33:
    s_getreg_b32 s74, hwreg(HW_REG_IB_STS)
    s_and_b32 s74, s74, s76
    s_cmp_gt_u32 s74, s78
    s_cbranch_scc1 L_w33
    buffer_load_dwordx4 v8, s[32:35], s68 offen nt lds
    buffer_load_dwordx4 v9, s[32:35], s68 offen offset:1024 nt lds
    buffer_load_dwordx4 v10, s[32:35], s68 offen offset:2048 nt lds
    buffer_load_dwordx4 v11, s[32:35], s68 offen offset:3072 nt lds
    ds_read_b32 v46, v24
    s_mov_b32 m0, 69632
    s_mov_b32 s68, 135168
L_w34:
    s_getreg_b32 s74, hwreg(HW_REG_IB_STS)
    s_and_b32 s74, s74, s76
    s_cmp_gt_u32 s74, s78
    s_cbranch_scc1 L_w34
    buffer_load_dwordx4 v8, s[32:35], s68 offen nt lds
    buffer_load_dwordx4 v9, s[32:35], s68 offen offset:1024 nt lds
    buffer_load_dwordx4 v10, s[32:35], s68 offen offset:2048 nt lds
    buffer_load_dwordx4 v11, s[32:35], s68 offen offset:3072 nt lds
    s_waitcnt lgkmcnt(0)
    v_readlane_b32 s15, v46, 0
    v_readlane_b32 s9, v46, 1
    v_readlane_b32 s14, v46, 2
    v_readlane_b32 s77, v46, 4
    s_min_u32 s15, s15, s9
    s_min_u32 s69, s15, s14
    s_mov_b32 m0, 160512
    s_mov_b32 s68, L_table-L_pc+144
    buffer_load_dword off, s[64:67], s68 lds
    s_getpc_b64 s[12:13]
    s_cmp_ge_u32 s69, 13
    s_cbranch_scc0 L_lrefresh
    s_mov_b32 m0, 8192
    s_mov_b32 s68, 139264
    s_add_u32 s78, s77, 20
    s_lshr_b32 s74, s78, 4
    s_lshl_b32 s74, s74, 22
    s_and_b32 s78, s78, 15
    s_or_b32 s78, s78, s74
L_w35:
    s_getreg_b32 s74, hwreg(HW_REG_IB_STS)
    s_and_b32 s74, s74, s76
    s_cmp_gt_u32 s74, s78
    s_cbranch_scc1 L_w35
    buffer_load_dwordx4 v8, s[32:35], s68 offen nt lds
    buffer_load_dwordx4 v9, s[32:35], s68 offen offset:1024 nt lds
    buffer_load_dwordx4 v10, s[32:35], s68 offen offset:2048 nt lds
    buffer_load_dwordx4 v11, s[32:35], s68 offen offset:3072 nt lds
    ds_read_b32 v46, v24
    s_mov_b32 m0, 12288
    s_mov_b32 s68, 143360
L_w36:
    s_getreg_b32 s74, hwreg(HW_REG_IB_STS)
    s_and_b32 s74, s74, s76
    s_cmp_gt_u32 s74, s78
    s_cbranch_scc1 L_w36
    buffer_load_dwordx4 v8, s[32:35], s68 offen nt lds
    buffer_load_dwordx4 v9, s[32:35], s68 offen offset:1024 nt lds
    buffer_load_dwordx4 v10, s[32:35], s68 offen offset:2048 nt lds
    buffer_load_dwordx4 v11, s[32:35], s68 offen offset:3072 nt lds
    s_waitcnt lgkmcnt(0)
    v_readlane_b32 s15, v46, 0
    v_readlane_b32 s9, v46, 1
    v_readlane_b32 s14, v46, 2
    v_readlane_b32 s77, v46, 4
    s_min_u32 s15, s15, s9
    s_min_u32 s69, s15, s14
    s_mov_b32 m0, 160512
    s_mov_b32 s68, L_table-L_pc+148
    buffer_load_dword off, s[64:67], s68 lds
    s_mov_b32 m0, 16384
    s_mov_b32 s68, 147456
    s_add_u32 s78, s77, 20
    s_lshr_b32 s74, s78, 4
    s_lshl_b32 s74, s74, 22
    s_and_b32 s78, s78, 15
    s_or_b32 s78, s78, s74
L_w37:
    s_getreg_b32 s74, hwreg(HW_REG_IB_STS)
    s_and_b32 s74, s74, s76
    s_cmp_gt_u32 s74, s78
    s_cbranch_scc1 L_w37
    buffer_load_dwordx4 v8, s[32:35], s68 offen nt lds
    buffer_load_dwordx4 v9, s[32:35], s68 offen offset:1024 nt lds
    buffer_load_dwordx4 v10, s[32:35], s68 offen offset:2048 nt lds
    buffer_load_dwordx4 v11, s[32:35], s68 offen offset:3072 nt lds
    ds_read_b32 v46, v24
    s_mov_b32 m0, 20480
    s_mov_b32 s68, 151552
L_w38:
    s_getreg_b32 s74, hwreg(HW_REG_IB_STS)
    s_and_b32 s74, s74, s76
    s_cmp_gt_u32 s74, s78
    s_cbranch_scc1 L_w38
    buffer_load_dwordx4 v8, s[32:35], s68 offen nt lds
    buffer_load_dwordx4 v9, s[32:35], s68 offen offset:1024 nt lds
    buffer_load_dwordx4 v10, s[32:35], s68 offen offset:2048 nt lds
    buffer_load_dwordx4 v11, s[32:35], s68 offen offset:3072 nt lds
    s_waitcnt lgkmcnt(0)
    v_readlane_b32 s15, v46, 0
    v_readlane_b32 s9, v46, 1
    v_readlane_b32 s14, v46, 2
    v_readlane_b32 s77, v46, 4
    s_min_u32 s15, s15, s9
    s_min_u32 s69, s15, s14
    s_mov_b32 m0, 160512
    s_mov_b32 s68, L_table-L_pc+152
    buffer_load_dword off, s[64:67], s68 lds
    s_getpc_b64 s[12:13]
    s_cmp_ge_u32 s69, 14
    s_cbranch_scc0 L_lrefresh
    s_mov_b32 m0, 24576
    s_mov_b32 s68, 155648
    s_add_u32 s78, s77, 20
    s_lshr_b32 s74, s78, 4
    s_lshl_b32 s74, s74, 22
    s_and_b32 s78, s78, 15
    s_or_b32 s78, s78, s74
L_w39:
    s_getreg_b32 s74, hwreg(HW_REG_IB_STS)
    s_and_b32 s74, s74, s76
    s_cmp_gt_u32 s74, s78
    s_cbranch_scc1 L_w39
    buffer_load_dwordx4 v8, s[32:35], s68 offen nt lds
    buffer_load_dwordx4 v9, s[32:35], s68 offen offset:1024 nt lds
    buffer_load_dwordx4 v10, s[32:35], s68 offen offset:2048 nt lds
    buffer_load_dwordx4 v11, s[32:35], s68 offen offset:3072 nt lds
    ds_read_b32 v46, v24
    s_mov_b32 m0, 28672
    s_mov_b32 s68, 159744
L_w40:
    s_getreg_b32 s74, hwreg(HW_REG_IB_STS)
    s_and_b32 s74, s74, s76
    s_cmp_gt_u32 s74, s78
    s_cbranch_scc1 L_w40
    buffer_load_dwordx4 v8, s[32:35], s68 offen nt lds
    buffer_load_dwordx4 v9, s[32:35], s68 offen offset:1024 nt lds
    buffer_load_dwordx4 v10, s[32:35], s68 offen offset:2048 nt lds
    buffer_load_dwordx4 v11, s[32:35], s68 offen offset:3072 nt lds
    s_waitcnt lgkmcnt(0)
    v_readlane_b32 s15, v46, 0
    v_readlane_b32 s9, v46, 1
    v_readlane_b32 s14, v46, 2
    v_readlane_b32 s77, v46, 4
    s_min_u32 s15, s15, s9
    s_min_u32 s69, s15, s14
    s_mov_b32 m0, 160512
    s_mov_b32 s68, L_table-L_pc+160
    buffer_load_dword off, s[64:67], s68 lds
    s_mov_b32 m0, 131072
    s_mov_b32 s68, 98304
    s_add_u32 s78, s77, 20
    s_lshr_b32 s74, s78, 4
    s_lshl_b32 s74, s74, 22
    s_and_b32 s78, s78, 15
    s_or_b32 s78, s78, s74
L_w41:
    s_getreg_b32 s74, hwreg(HW_REG_IB_STS)
    s_and_b32 s74, s74, s76
    s_cmp_gt_u32 s74, s78
    s_cbranch_scc1 L_w41
    buffer_load_dwordx4 v12, s[36:39], s68 offen nt lds
    buffer_load_dwordx4 v12, s[36:39], s68 offen offset:1024 nt lds
    buffer_load_dwordx4 v12, s[36:39], s68 offen offset:2048 nt lds
    buffer_load_dwordx4 v12, s[36:39], s68 offen offset:3072 nt lds
    ds_read_b32 v46, v24
    s_mov_b32 m0, 135168
    s_mov_b32 s68, 102400
L_w42:
    s_getreg_b32 s74, hwreg(HW_REG_IB_STS)
    s_and_b32 s74, s74, s76
    s_cmp_gt_u32 s74, s78
    s_cbranch_scc1 L_w42
    buffer_load_dwordx4 v12, s[36:39], s68 offen nt lds
    buffer_load_dwordx4 v12, s[36:39], s68 offen offset:1024 nt lds
    buffer_load_dwordx4 v12, s[36:39], s68 offen offset:2048 nt lds
    buffer_load_dwordx4 v12, s[36:39], s68 offen offset:3072 nt lds
    s_waitcnt lgkmcnt(0)
    v_readlane_b32 s15, v46, 0
    v_readlane_b32 s9, v46, 1
    v_readlane_b32 s14, v46, 2
    v_readlane_b32 s77, v46, 4
    s_min_u32 s15, s15, s9
    s_min_u32 s69, s15, s14
    s_mov_b32 m0, 160512
    s_mov_b32 s68, L_table-L_pc+164
    buffer_load_dword off, s[64:67], s68 lds
    s_getpc_b64 s[12:13]
    s_cmp_ge_u32 s69, 15
    s_cbranch_scc0 L_lrefresh
    s_mov_b32 m0, 139264
    s_mov_b32 s68, 106496
    s_add_u32 s78, s77, 20
    s_lshr_b32 s74, s78, 4
    s_lshl_b32 s74, s74, 22
    s_and_b32 s78, s78, 15
    s_or_b32 s78, s78, s74
L_w43:
    s_getreg_b32 s74, hwreg(HW_REG_IB_STS)
    s_and_b32 s74, s74, s76
    s_cmp_gt_u32 s74, s78
    s_cbranch_scc1 L_w43
    buffer_load_dwordx4 v12, s[36:39], s68 offen nt lds
    buffer_load_dwordx4 v12, s[36:39], s68 offen offset:1024 nt lds
    buffer_load_dwordx4 v12, s[36:39], s68 offen offset:2048 nt lds
    buffer_load_dwordx4 v12, s[36:39], s68 offen offset:3072 nt lds
    ds_read_b32 v46, v24
    s_mov_b32 m0, 143360
    s_mov_b32 s68, 110592
L_w44:
    s_getreg_b32 s74, hwreg(HW_REG_IB_STS)
    s_and_b32 s74, s74, s76
    s_cmp_gt_u32 s74, s78
    s_cbranch_scc1 L_w44
    buffer_load_dwordx4 v12, s[36:39], s68 offen nt lds
    buffer_load_dwordx4 v12, s[36:39], s68 offen offset:1024 nt lds
    buffer_load_dwordx4 v12, s[36:39], s68 offen offset:2048 nt lds
    buffer_load_dwordx4 v12, s[36:39], s68 offen offset:3072 nt lds
    s_waitcnt lgkmcnt(0)
    v_readlane_b32 s15, v46, 0
    v_readlane_b32 s9, v46, 1
    v_readlane_b32 s14, v46, 2
    v_readlane_b32 s77, v46, 4
    s_min_u32 s15, s15, s9
    s_min_u32 s69, s15, s14
    s_mov_b32 m0, 160512
    s_mov_b32 s68, L_table-L_pc+168
    buffer_load_dword off, s[64:67], s68 lds
    s_mov_b32 m0, 147456
    s_mov_b32 s68, 114688
    s_add_u32 s78, s77, 20
    s_lshr_b32 s74, s78, 4
    s_lshl_b32 s74, s74, 22
    s_and_b32 s78, s78, 15
    s_or_b32 s78, s78, s74
L_w45:
    s_getreg_b32 s74, hwreg(HW_REG_IB_STS)
    s_and_b32 s74, s74, s76
    s_cmp_gt_u32 s74, s78
    s_cbranch_scc1 L_w45
    buffer_load_dwordx4 v12, s[36:39], s68 offen nt lds
    buffer_load_dwordx4 v12, s[36:39], s68 offen offset:1024 nt lds
    buffer_load_dwordx4 v12, s[36:39], s68 offen offset:2048 nt lds
    buffer_load_dwordx4 v12, s[36:39], s68 offen offset:3072 nt lds
    ds_read_b32 v46, v24
    s_mov_b32 m0, 151552
    s_mov_b32 s68, 118784
L_w46:
    s_getreg_b32 s74, hwreg(HW_REG_IB_STS)
    s_and_b32 s74, s74, s76
    s_cmp_gt_u32 s74, s78
    s_cbranch_scc1 L_w46
    buffer_load_dwordx4 v12, s[36:39], s68 offen nt lds
    buffer_load_dwordx4 v12, s[36:39], s68 offen offset:1024 nt lds
    buffer_load_dwordx4 v12, s[36:39], s68 offen offset:2048 nt lds
    buffer_load_dwordx4 v12, s[36:39], s68 offen offset:3072 nt lds
    s_waitcnt lgkmcnt(0)
    v_readlane_b32 s15, v46, 0
    v_readlane_b32 s9, v46, 1
    v_readlane_b32 s14, v46, 2
    v_readlane_b32 s77, v46, 4
    s_min_u32 s15, s15, s9
    s_min_u32 s69, s15, s14
    s_mov_b32 m0, 160512
    s_mov_b32 s68, L_table-L_pc+172
    buffer_load_dword off, s[64:67], s68 lds
    s_getpc_b64 s[12:13]
    s_cmp_ge_u32 s69, 16
    s_cbranch_scc0 L_lrefresh
    s_mov_b32 m0, 73728
    s_mov_b32 s68, 122880
    s_add_u32 s78, s77, 20
    s_lshr_b32 s74, s78, 4
    s_lshl_b32 s74, s74, 22
    s_and_b32 s78, s78, 15
    s_or_b32 s78, s78, s74
L_w47:
    s_getreg_b32 s74, hwreg(HW_REG_IB_STS)
    s_and_b32 s74, s74, s76
    s_cmp_gt_u32 s74, s78
    s_cbranch_scc1 L_w47
    buffer_load_dwordx4 v12, s[36:39], s68 offen nt lds
    buffer_load_dwordx4 v12, s[36:39], s68 offen offset:1024 nt lds
    buffer_load_dwordx4 v12, s[36:39], s68 offen offset:2048 nt lds
    buffer_load_dwordx4 v12, s[36:39], s68 offen offset:3072 nt lds
    ds_read_b32 v46, v24
    s_mov_b32 m0, 77824
    s_mov_b32 s68, 126976
L_w48:
    s_getreg_b32 s74, hwreg(HW_REG_IB_STS)
    s_and_b32 s74, s74, s76
    s_cmp_gt_u32 s74, s78
    s_cbranch_scc1 L_w48
    buffer_load_dwordx4 v12, s[36:39], s68 offen nt lds
    buffer_load_dwordx4 v12, s[36:39], s68 offen offset:1024 nt lds
    buffer_load_dwordx4 v12, s[36:39], s68 offen offset:2048 nt lds
    buffer_load_dwordx4 v12, s[36:39], s68 offen offset:3072 nt lds
    s_waitcnt lgkmcnt(0)
    v_readlane_b32 s15, v46, 0
    v_readlane_b32 s9, v46, 1
    v_readlane_b32 s14, v46, 2
    v_readlane_b32 s77, v46, 4
    s_min_u32 s15, s15, s9
    s_min_u32 s69, s15, s14
    s_mov_b32 m0, 160512
    s_mov_b32 s68, L_table-L_pc+176
    buffer_load_dword off, s[64:67], s68 lds
    s_mov_b32 m0, 81920
    s_mov_b32 s68, 163840
    s_add_u32 s78, s77, 20
    s_lshr_b32 s74, s78, 4
    s_lshl_b32 s74, s74, 22
    s_and_b32 s78, s78, 15
    s_or_b32 s78, s78, s74
L_w49:
    s_getreg_b32 s74, hwreg(HW_REG_IB_STS)
    s_and_b32 s74, s74, s76
    s_cmp_gt_u32 s74, s78
    s_cbranch_scc1 L_w49
    buffer_load_dwordx4 v8, s[32:35], s68 offen nt lds
    buffer_load_dwordx4 v9, s[32:35], s68 offen offset:1024 nt lds
    buffer_load_dwordx4 v10, s[32:35], s68 offen offset:2048 nt lds
    buffer_load_dwordx4 v11, s[32:35], s68 offen offset:3072 nt lds
    ds_read_b32 v46, v24
    s_mov_b32 m0, 86016
    s_mov_b32 s68, 167936
L_w50:
    s_getreg_b32 s74, hwreg(HW_REG_IB_STS)
    s_and_b32 s74, s74, s76
    s_cmp_gt_u32 s74, s78
    s_cbranch_scc1 L_w50
    buffer_load_dwordx4 v8, s[32:35], s68 offen nt lds
    buffer_load_dwordx4 v9, s[32:35], s68 offen offset:1024 nt lds
    buffer_load_dwordx4 v10, s[32:35], s68 offen offset:2048 nt lds
    buffer_load_dwordx4 v11, s[32:35], s68 offen offset:3072 nt lds
    s_waitcnt lgkmcnt(0)
    v_readlane_b32 s15, v46, 0
    v_readlane_b32 s9, v46, 1
    v_readlane_b32 s14, v46, 2
    v_readlane_b32 s77, v46, 4
    s_min_u32 s15, s15, s9
    s_min_u32 s69, s15, s14
    s_mov_b32 m0, 160512
    s_mov_b32 s68, L_table-L_pc+184
    buffer_load_dword off, s[64:67], s68 lds
    s_getpc_b64 s[12:13]
    s_cmp_ge_u32 s69, 17
    s_cbranch_scc0 L_lrefresh
    s_xor_b32 s15, s7, 0
    s_lshl_b32 s75, s15, 17
    s_add_u32 s75, s75, 0
    s_add_u32 s82, s75, 16384
    s_mov_b32 m0, 98304
    s_mov_b32 s68, 172032
    s_add_u32 s78, s77, 20
    s_lshr_b32 s74, s78, 4
    s_lshl_b32 s74, s74, 22
    s_and_b32 s78, s78, 15
    s_or_b32 s78, s78, s74
L_w51:
    s_getreg_b32 s74, hwreg(HW_REG_IB_STS)
    s_and_b32 s74, s74, s76
    s_cmp_gt_u32 s74, s78
    s_cbranch_scc1 L_w51
    buffer_load_dwordx4 v8, s[32:35], s68 offen nt lds
    buffer_load_dwordx4 v9, s[32:35], s68 offen offset:1024 nt lds
    buffer_load_dwordx4 v10, s[32:35], s68 offen offset:2048 nt lds
    buffer_load_dwordx4 v11, s[32:35], s68 offen offset:3072 nt lds
    ds_read_b32 v46, v24
    s_waitcnt vmcnt(41)
    s_mov_b32 m0, 90112
    s_nop 0
    buffer_load_dwordx4 v40, s[48:51], s75 offen  lds
    s_mov_b32 m0, 102400
    s_mov_b32 s68, 176128
L_w52:
    s_getreg_b32 s74, hwreg(HW_REG_IB_STS)
    s_and_b32 s74, s74, s76
    s_cmp_gt_u32 s74, s78
    s_cbranch_scc1 L_w52
    buffer_load_dwordx4 v8, s[32:35], s68 offen nt lds
    buffer_load_dwordx4 v9, s[32:35], s68 offen offset:1024 nt lds
    buffer_load_dwordx4 v10, s[32:35], s68 offen offset:2048 nt lds
    buffer_load_dwordx4 v11, s[32:35], s68 offen offset:3072 nt lds
    s_waitcnt lgkmcnt(0)
    v_readlane_b32 s15, v46, 0
    v_readlane_b32 s9, v46, 1
    v_readlane_b32 s14, v46, 2
    v_readlane_b32 s77, v46, 4
    s_min_u32 s15, s15, s9
    s_min_u32 s69, s15, s14
    s_waitcnt vmcnt(41)
    s_mov_b32 m0, 90112
    s_nop 0
    buffer_load_dwordx4 v41, s[48:51], s75 offen offset:1024  lds
    s_mov_b32 m0, 160512
    s_mov_b32 s68, L_table-L_pc+188
    buffer_load_dword off, s[64:67], s68 lds
    s_getpc_b64 s[12:13]
    s_cmp_ge_u32 s69, 18
    s_cbranch_scc0 L_lrefresh
    s_mov_b32 m0, 106496
    s_mov_b32 s68, 180224
    s_add_u32 s78, s77, 22
    s_lshr_b32 s74, s78, 4
    s_lshl_b32 s74, s74, 22
    s_and_b32 s78, s78, 15
    s_or_b32 s78, s78, s74
L_w53:
    s_getreg_b32 s74, hwreg(HW_REG_IB_STS)
    s_and_b32 s74, s74, s76
    s_cmp_gt_u32 s74, s78
    s_cbranch_scc1 L_w53
    buffer_load_dwordx4 v8, s[32:35], s68 offen nt lds
    buffer_load_dwordx4 v9, s[32:35], s68 offen offset:1024 nt lds
    buffer_load_dwordx4 v10, s[32:35], s68 offen offset:2048 nt lds
    buffer_load_dwordx4 v11, s[32:35], s68 offen offset:3072 nt lds
    ds_read_b32 v46, v24
    s_waitcnt vmcnt(40)
    s_mov_b32 m0, 90112
    s_nop 0
    buffer_load_dwordx4 v42, s[48:51], s75 offen offset:2048  lds
    buffer_load_dwordx4 v43, s[48:51], s75 offen offset:3072  lds
    s_mov_b32 m0, 110592
    s_mov_b32 s68, 184320
L_w54:
    s_getreg_b32 s74, hwreg(HW_REG_IB_STS)
    s_and_b32 s74, s74, s76
    s_cmp_gt_u32 s74, s78
    s_cbranch_scc1 L_w54
    buffer_load_dwordx4 v8, s[32:35], s68 offen nt lds
    buffer_load_dwordx4 v9, s[32:35], s68 offen offset:1024 nt lds
    buffer_load_dwordx4 v10, s[32:35], s68 offen offset:2048 nt lds
    buffer_load_dwordx4 v11, s[32:35], s68 offen offset:3072 nt lds
    s_waitcnt lgkmcnt(0)
    v_readlane_b32 s15, v46, 0
    v_readlane_b32 s9, v46, 1
    v_readlane_b32 s14, v46, 2
    v_readlane_b32 s77, v46, 4
    s_min_u32 s15, s15, s9
    s_min_u32 s69, s15, s14
    s_waitcnt vmcnt(41)
    s_mov_b32 m0, 94208
    s_nop 0
    buffer_load_dwordx4 v40, s[48:51], s82 offen  lds
    s_mov_b32 m0, 160512
    s_mov_b32 s68, L_table-L_pc+192
    buffer_load_dword off, s[64:67], s68 lds
    s_mov_b32 m0, 114688
    s_mov_b32 s68, 188416
    s_add_u32 s78, s77, 25
    s_lshr_b32 s74, s78, 4
    s_lshl_b32 s74, s74, 22
    s_and_b32 s78, s78, 15
    s_or_b32 s78, s78, s74
L_w55:
    s_getreg_b32 s74, hwreg(HW_REG_IB_STS)
    s_and_b32 s74, s74, s76
    s_cmp_gt_u32 s74, s78
    s_cbranch_scc1 L_w55
    buffer_load_dwordx4 v8, s[32:35], s68 offen nt lds
    buffer_load_dwordx4 v9, s[32:35], s68 offen offset:1024 nt lds
    buffer_load_dwordx4 v10, s[32:35], s68 offen offset:2048 nt lds
    buffer_load_dwordx4 v11, s[32:35], s68 offen offset:3072 nt lds
    ds_read_b32 v46, v24
    s_waitcnt vmcnt(41)
    s_mov_b32 m0, 94208
    s_nop 0
    buffer_load_dwordx4 v41, s[48:51], s82 offen offset:1024  lds
    s_mov_b32 m0, 118784
    s_mov_b32 s68, 192512
L_w56:
    s_getreg_b32 s74, hwreg(HW_REG_IB_STS)
    s_and_b32 s74, s74, s76
    s_cmp_gt_u32 s74, s78
    s_cbranch_scc1 L_w56
    buffer_load_dwordx4 v8, s[32:35], s68 offen nt lds
    buffer_load_dwordx4 v9, s[32:35], s68 offen offset:1024 nt lds
    buffer_load_dwordx4 v10, s[32:35], s68 offen offset:2048 nt lds
    buffer_load_dwordx4 v11, s[32:35], s68 offen offset:3072 nt lds
    s_waitcnt lgkmcnt(0)
    v_readlane_b32 s15, v46, 0
    v_readlane_b32 s9, v46, 1
    v_readlane_b32 s14, v46, 2
    v_readlane_b32 s77, v46, 4
    s_min_u32 s15, s15, s9
    s_min_u32 s69, s15, s14
    s_waitcnt vmcnt(40)
    s_mov_b32 m0, 94208
    s_nop 0
    buffer_load_dwordx4 v42, s[48:51], s82 offen offset:2048  lds
    buffer_load_dwordx4 v43, s[48:51], s82 offen offset:3072  lds
    s_mov_b32 m0, 160512
    s_mov_b32 s68, L_table-L_pc+196
    buffer_load_dword off, s[64:67], s68 lds
    s_getpc_b64 s[12:13]
    s_cmp_ge_u32 s69, 19
    s_cbranch_scc0 L_lrefresh
    s_xor_b32 s15, s7, 0
    s_lshl_b32 s75, s15, 17
    s_add_u32 s75, s75, 32768
    s_add_u32 s82, s75, 16384
    s_mov_b32 m0, 122880
    s_mov_b32 s68, 131072
    s_add_u32 s78, s77, 27
    s_lshr_b32 s74, s78, 4
    s_lshl_b32 s74, s74, 22
    s_and_b32 s78, s78, 15
    s_or_b32 s78, s78, s74
L_w57:
    s_getreg_b32 s74, hwreg(HW_REG_IB_STS)
    s_and_b32 s74, s74, s76
    s_cmp_gt_u32 s74, s78
    s_cbranch_scc1 L_w57
    buffer_load_dwordx4 v12, s[36:39], s68 offen nt lds
    buffer_load_dwordx4 v12, s[36:39], s68 offen offset:1024 nt lds
    buffer_load_dwordx4 v12, s[36:39], s68 offen offset:2048 nt lds
    buffer_load_dwordx4 v12, s[36:39], s68 offen offset:3072 nt lds
    ds_read_b32 v46, v24
    s_waitcnt vmcnt(41)
    s_mov_b32 m0, 32768
    s_nop 0
    buffer_load_dwordx4 v40, s[48:51], s75 offen  lds
    s_mov_b32 m0, 126976
    s_mov_b32 s68, 135168
L_w58:
    s_getreg_b32 s74, hwreg(HW_REG_IB_STS)
    s_and_b32 s74, s74, s76
    s_cmp_gt_u32 s74, s78
    s_cbranch_scc1 L_w58
    buffer_load_dwordx4 v12, s[36:39], s68 offen nt lds
    buffer_load_dwordx4 v12, s[36:39], s68 offen offset:1024 nt lds
    buffer_load_dwordx4 v12, s[36:39], s68 offen offset:2048 nt lds
    buffer_load_dwordx4 v12, s[36:39], s68 offen offset:3072 nt lds
    s_waitcnt lgkmcnt(0)
    v_readlane_b32 s15, v46, 0
    v_readlane_b32 s9, v46, 1
    v_readlane_b32 s14, v46, 2
    v_readlane_b32 s77, v46, 4
    s_min_u32 s15, s15, s9
    s_min_u32 s69, s15, s14
    s_waitcnt vmcnt(41)
    s_mov_b32 m0, 32768
    s_nop 0
    buffer_load_dwordx4 v41, s[48:51], s75 offen offset:1024  lds
    s_mov_b32 m0, 160512
    s_mov_b32 s68, L_table-L_pc+200
    buffer_load_dword off, s[64:67], s68 lds
    s_getpc_b64 s[12:13]
    s_cmp_ge_u32 s69, 20
    s_cbranch_scc0 L_lrefresh
    s_mov_b32 m0, 40960
    s_mov_b32 s68, 139264
    s_add_u32 s78, s77, 26
    s_lshr_b32 s74, s78, 4
    s_lshl_b32 s74, s74, 22
    s_and_b32 s78, s78, 15
    s_or_b32 s78, s78, s74
L_w59:
    s_getreg_b32 s74, hwreg(HW_REG_IB_STS)
    s_and_b32 s74, s74, s76
    s_cmp_gt_u32 s74, s78
    s_cbranch_scc1 L_w59
    buffer_load_dwordx4 v12, s[36:39], s68 offen nt lds
    buffer_load_dwordx4 v12, s[36:39], s68 offen offset:1024 nt lds
    buffer_load_dwordx4 v12, s[36:39], s68 offen offset:2048 nt lds
    buffer_load_dwordx4 v12, s[36:39], s68 offen offset:3072 nt lds
    ds_read_b32 v46, v24
    s_waitcnt vmcnt(40)
    s_mov_b32 m0, 32768
    s_nop 0
    buffer_load_dwordx4 v42, s[48:51], s75 offen offset:2048  lds
    buffer_load_dwordx4 v43, s[48:51], s75 offen offset:3072  lds
    s_mov_b32 m0, 45056
    s_mov_b32 s68, 143360
L_w60:
    s_getreg_b32 s74, hwreg(HW_REG_IB_STS)
    s_and_b32 s74, s74, s76
    s_cmp_gt_u32 s74, s78
    s_cbranch_scc1 L_w60
    buffer_load_dwordx4 v12, s[36:39], s68 offen nt lds
    buffer_load_dwordx4 v12, s[36:39], s68 offen offset:1024 nt lds
    buffer_load_dwordx4 v12, s[36:39], s68 offen offset:2048 nt lds
    buffer_load_dwordx4 v12, s[36:39], s68 offen offset:3072 nt lds
    s_waitcnt lgkmcnt(0)
    v_readlane_b32 s15, v46, 0
    v_readlane_b32 s9, v46, 1
    v_readlane_b32 s14, v46, 2
    v_readlane_b32 s77, v46, 4
    s_min_u32 s15, s15, s9
    s_min_u32 s69, s15, s14
    s_waitcnt vmcnt(41)
    s_mov_b32 m0, 36864
    s_nop 0
    buffer_load_dwordx4 v40, s[48:51], s82 offen  lds
    s_mov_b32 m0, 160512
    s_mov_b32 s68, L_table-L_pc+208
    buffer_load_dword off, s[64:67], s68 lds
    s_mov_b32 m0, 49152
    s_mov_b32 s68, 147456
    s_add_u32 s78, s77, 27
    s_lshr_b32 s74, s78, 4
    s_lshl_b32 s74, s74, 22
    s_and_b32 s78, s78, 15
    s_or_b32 s78, s78, s74
L_w61:
    s_getreg_b32 s74, hwreg(HW_REG_IB_STS)
    s_and_b32 s74, s74, s76
    s_cmp_gt_u32 s74, s78
    s_cbranch_scc1 L_w61
    buffer_load_dwordx4 v12, s[36:39], s68 offen nt lds
    buffer_load_dwordx4 v12, s[36:39], s68 offen offset:1024 nt lds
    buffer_load_dwordx4 v12, s[36:39], s68 offen offset:2048 nt lds
    buffer_load_dwordx4 v12, s[36:39], s68 offen offset:3072 nt lds
    ds_read_b32 v46, v24
    s_waitcnt vmcnt(41)
    s_mov_b32 m0, 36864
    s_nop 0
    buffer_load_dwordx4 v41, s[48:51], s82 offen offset:1024  lds
    s_mov_b32 m0, 53248
    s_mov_b32 s68, 151552
    s_add_u32 s78, s77, 25
    s_lshr_b32 s74, s78, 4
    s_lshl_b32 s74, s74, 22
    s_and_b32 s78, s78, 15
    s_or_b32 s78, s78, s74
L_w62:
    s_getreg_b32 s74, hwreg(HW_REG_IB_STS)
    s_and_b32 s74, s74, s76
    s_cmp_gt_u32 s74, s78
    s_cbranch_scc1 L_w62
    buffer_load_dwordx4 v12, s[36:39], s68 offen nt lds
    buffer_load_dwordx4 v12, s[36:39], s68 offen offset:1024 nt lds
    buffer_load_dwordx4 v12, s[36:39], s68 offen offset:2048 nt lds
    buffer_load_dwordx4 v12, s[36:39], s68 offen offset:3072 nt lds
    s_waitcnt lgkmcnt(0)
    v_readlane_b32 s15, v46, 0
    v_readlane_b32 s9, v46, 1
    v_readlane_b32 s14, v46, 2
    v_readlane_b32 s77, v46, 4
    s_min_u32 s15, s15, s9
    s_min_u32 s69, s15, s14
    s_waitcnt vmcnt(40)
    s_mov_b32 m0, 36864
    s_nop 0
    buffer_load_dwordx4 v42, s[48:51], s82 offen offset:2048  lds
    buffer_load_dwordx4 v43, s[48:51], s82 offen offset:3072  lds
    s_mov_b32 m0, 160512
    s_mov_b32 s68, L_table-L_pc+212
    buffer_load_dword off, s[64:67], s68 lds
    s_getpc_b64 s[12:13]
    s_cmp_ge_u32 s69, 21
    s_cbranch_scc0 L_lrefresh
    s_xor_b32 s15, s7, 0
    s_lshl_b32 s75, s15, 17
    s_add_u32 s75, s75, 65536
    s_add_u32 s82, s75, 16384
    s_mov_b32 m0, 57344
    s_mov_b32 s68, 155648
    s_add_u32 s78, s77, 27
    s_lshr_b32 s74, s78, 4
    s_lshl_b32 s74, s74, 22
    s_and_b32 s78, s78, 15
    s_or_b32 s78, s78, s74
L_w63:
    s_getreg_b32 s74, hwreg(HW_REG_IB_STS)
    s_and_b32 s74, s74, s76
    s_cmp_gt_u32 s74, s78
    s_cbranch_scc1 L_w63
    buffer_load_dwordx4 v12, s[36:39], s68 offen nt lds
    buffer_load_dwordx4 v12, s[36:39], s68 offen offset:1024 nt lds
    buffer_load_dwordx4 v12, s[36:39], s68 offen offset:2048 nt lds
    buffer_load_dwordx4 v12, s[36:39], s68 offen offset:3072 nt lds
    ds_read_b32 v46, v24
    s_waitcnt vmcnt(41)
    s_mov_b32 m0, 0
    s_nop 0
    buffer_load_dwordx4 v40, s[48:51], s75 offen  lds
    s_mov_b32 m0, 61440
    s_mov_b32 s68, 159744
L_w64:
    s_getreg_b32 s74, hwreg(HW_REG_IB_STS)
    s_and_b32 s74, s74, s76
    s_cmp_gt_u32 s74, s78
    s_cbranch_scc1 L_w64
    buffer_load_dwordx4 v12, s[36:39], s68 offen nt lds
    buffer_load_dwordx4 v12, s[36:39], s68 offen offset:1024 nt lds
    buffer_load_dwordx4 v12, s[36:39], s68 offen offset:2048 nt lds
    buffer_load_dwordx4 v12, s[36:39], s68 offen offset:3072 nt lds
    s_waitcnt lgkmcnt(0)
    v_readlane_b32 s15, v46, 0
    v_readlane_b32 s9, v46, 1
    v_readlane_b32 s14, v46, 2
    v_readlane_b32 s77, v46, 4
    s_min_u32 s15, s15, s9
    s_min_u32 s69, s15, s14
    s_waitcnt vmcnt(41)
    s_mov_b32 m0, 0
    s_nop 0
    buffer_load_dwordx4 v41, s[48:51], s75 offen offset:1024  lds
    s_mov_b32 m0, 160512
    s_mov_b32 s68, L_table-L_pc+216
    buffer_load_dword off, s[64:67], s68 lds
    s_getpc_b64 s[12:13]
    s_cmp_ge_u32 s69, 22
    s_cbranch_scc0 L_lrefresh
    s_mov_b32 m0, 8192
    s_mov_b32 s68, 196608
    s_add_u32 s78, s77, 26
    s_lshr_b32 s74, s78, 4
    s_lshl_b32 s74, s74, 22
    s_and_b32 s78, s78, 15
    s_or_b32 s78, s78, s74
L_w65:
    s_getreg_b32 s74, hwreg(HW_REG_IB_STS)
    s_and_b32 s74, s74, s76
    s_cmp_gt_u32 s74, s78
    s_cbranch_scc1 L_w65
    buffer_load_dwordx4 v8, s[32:35], s68 offen nt lds
    buffer_load_dwordx4 v9, s[32:35], s68 offen offset:1024 nt lds
    buffer_load_dwordx4 v10, s[32:35], s68 offen offset:2048 nt lds
    buffer_load_dwordx4 v11, s[32:35], s68 offen offset:3072 nt lds
    ds_read_b32 v46, v24
    s_waitcnt vmcnt(40)
    s_mov_b32 m0, 0
    s_nop 0
    buffer_load_dwordx4 v42, s[48:51], s75 offen offset:2048  lds
    buffer_load_dwordx4 v43, s[48:51], s75 offen offset:3072  lds
    s_mov_b32 m0, 12288
    s_mov_b32 s68, 200704
L_w66:
    s_getreg_b32 s74, hwreg(HW_REG_IB_STS)
    s_and_b32 s74, s74, s76
    s_cmp_gt_u32 s74, s78
    s_cbranch_scc1 L_w66
    buffer_load_dwordx4 v8, s[32:35], s68 offen nt lds
    buffer_load_dwordx4 v9, s[32:35], s68 offen offset:1024 nt lds
    buffer_load_dwordx4 v10, s[32:35], s68 offen offset:2048 nt lds
    buffer_load_dwordx4 v11, s[32:35], s68 offen offset:3072 nt lds
    s_waitcnt lgkmcnt(0)
    v_readlane_b32 s15, v46, 0
    v_readlane_b32 s9, v46, 1
    v_readlane_b32 s14, v46, 2
    v_readlane_b32 s77, v46, 4
    s_min_u32 s15, s15, s9
    s_min_u32 s69, s15, s14
    s_waitcnt vmcnt(41)
    s_mov_b32 m0, 4096
    s_nop 0
    buffer_load_dwordx4 v40, s[48:51], s82 offen  lds
    s_mov_b32 m0, 160512
    s_mov_b32 s68, L_table-L_pc+220
    buffer_load_dword off, s[64:67], s68 lds
    s_mov_b32 m0, 65536
    s_mov_b32 s68, 204800
    s_add_u32 s78, s77, 27
    s_lshr_b32 s74, s78, 4
    s_lshl_b32 s74, s74, 22
    s_and_b32 s78, s78, 15
    s_or_b32 s78, s78, s74
L_w67:
    s_getreg_b32 s74, hwreg(HW_REG_IB_STS)
    s_and_b32 s74, s74, s76
    s_cmp_gt_u32 s74, s78
    s_cbranch_scc1 L_w67
    buffer_load_dwordx4 v8, s[32:35], s68 offen nt lds
    buffer_load_dwordx4 v9, s[32:35], s68 offen offset:1024 nt lds
    buffer_load_dwordx4 v10, s[32:35], s68 offen offset:2048 nt lds
    buffer_load_dwordx4 v11, s[32:35], s68 offen offset:3072 nt lds
    ds_read_b32 v46, v24
    s_waitcnt vmcnt(41)
    s_mov_b32 m0, 4096
    s_nop 0
    buffer_load_dwordx4 v41, s[48:51], s82 offen offset:1024  lds
    s_mov_b32 m0, 69632
    s_mov_b32 s68, 208896
    s_add_u32 s78, s77, 25
    s_lshr_b32 s74, s78, 4
    s_lshl_b32 s74, s74, 22
    s_and_b32 s78, s78, 15
    s_or_b32 s78, s78, s74
L_w68:
    s_getreg_b32 s74, hwreg(HW_REG_IB_STS)
    s_and_b32 s74, s74, s76
    s_cmp_gt_u32 s74, s78
    s_cbranch_scc1 L_w68
    buffer_load_dwordx4 v8, s[32:35], s68 offen nt lds
    buffer_load_dwordx4 v9, s[32:35], s68 offen offset:1024 nt lds
    buffer_load_dwordx4 v10, s[32:35], s68 offen offset:2048 nt lds
    buffer_load_dwordx4 v11, s[32:35], s68 offen offset:3072 nt lds
    s_waitcnt lgkmcnt(0)
    v_readlane_b32 s15, v46, 0
    v_readlane_b32 s9, v46, 1
    v_readlane_b32 s14, v46, 2
    v_readlane_b32 s77, v46, 4
    s_min_u32 s15, s15, s9
    s_min_u32 s69, s15, s14
    s_waitcnt vmcnt(40)
    s_mov_b32 m0, 4096
    s_nop 0
    buffer_load_dwordx4 v42, s[48:51], s82 offen offset:2048  lds
    buffer_load_dwordx4 v43, s[48:51], s82 offen offset:3072  lds
    s_mov_b32 m0, 160512
    s_mov_b32 s68, L_table-L_pc+224
    buffer_load_dword off, s[64:67], s68 lds
    s_getpc_b64 s[12:13]
    s_cmp_ge_u32 s69, 23
    s_cbranch_scc0 L_lrefresh
    s_xor_b32 s15, s7, 0
    s_lshl_b32 s75, s15, 17
    s_add_u32 s75, s75, 98304
    s_add_u32 s82, s75, 16384
    s_mov_b32 m0, 24576
    s_mov_b32 s68, 212992
    s_add_u32 s78, s77, 27
    s_lshr_b32 s74, s78, 4
    s_lshl_b32 s74, s74, 22
    s_and_b32 s78, s78, 15
    s_or_b32 s78, s78, s74
L_w69:
    s_getreg_b32 s74, hwreg(HW_REG_IB_STS)
    s_and_b32 s74, s74, s76
    s_cmp_gt_u32 s74, s78
    s_cbranch_scc1 L_w69
    buffer_load_dwordx4 v8, s[32:35], s68 offen nt lds
    buffer_load_dwordx4 v9, s[32:35], s68 offen offset:1024 nt lds
    buffer_load_dwordx4 v10, s[32:35], s68 offen offset:2048 nt lds
    buffer_load_dwordx4 v11, s[32:35], s68 offen offset:3072 nt lds
    ds_read_b32 v46, v24
    s_waitcnt vmcnt(41)
    s_mov_b32 m0, 16384
    s_nop 0
    buffer_load_dwordx4 v40, s[48:51], s75 offen  lds
    s_mov_b32 m0, 28672
    s_mov_b32 s68, 217088
L_w70:
    s_getreg_b32 s74, hwreg(HW_REG_IB_STS)
    s_and_b32 s74, s74, s76
    s_cmp_gt_u32 s74, s78
    s_cbranch_scc1 L_w70
    buffer_load_dwordx4 v8, s[32:35], s68 offen nt lds
    buffer_load_dwordx4 v9, s[32:35], s68 offen offset:1024 nt lds
    buffer_load_dwordx4 v10, s[32:35], s68 offen offset:2048 nt lds
    buffer_load_dwordx4 v11, s[32:35], s68 offen offset:3072 nt lds
    s_waitcnt lgkmcnt(0)
    v_readlane_b32 s15, v46, 0
    v_readlane_b32 s9, v46, 1
    v_readlane_b32 s14, v46, 2
    v_readlane_b32 s77, v46, 4
    s_min_u32 s15, s15, s9
    s_min_u32 s69, s15, s14
    s_waitcnt vmcnt(41)
    s_mov_b32 m0, 16384
    s_nop 0
    buffer_load_dwordx4 v41, s[48:51], s75 offen offset:1024  lds
    s_mov_b32 m0, 160512
    s_mov_b32 s68, L_table-L_pc+232
    buffer_load_dword off, s[64:67], s68 lds
    s_getpc_b64 s[12:13]
    s_cmp_ge_u32 s69, 24
    s_cbranch_scc0 L_lrefresh
    s_mov_b32 m0, 131072
    s_mov_b32 s68, 221184
    s_add_u32 s78, s77, 26
    s_lshr_b32 s74, s78, 4
    s_lshl_b32 s74, s74, 22
    s_and_b32 s78, s78, 15
    s_or_b32 s78, s78, s74
L_w71:
    s_getreg_b32 s74, hwreg(HW_REG_IB_STS)
    s_and_b32 s74, s74, s76
    s_cmp_gt_u32 s74, s78
    s_cbranch_scc1 L_w71
    buffer_load_dwordx4 v8, s[32:35], s68 offen nt lds
    buffer_load_dwordx4 v9, s[32:35], s68 offen offset:1024 nt lds
    buffer_load_dwordx4 v10, s[32:35], s68 offen offset:2048 nt lds
    buffer_load_dwordx4 v11, s[32:35], s68 offen offset:3072 nt lds
    ds_read_b32 v46, v24
    s_waitcnt vmcnt(40)
    s_mov_b32 m0, 16384
    s_nop 0
    buffer_load_dwordx4 v42, s[48:51], s75 offen offset:2048  lds
    buffer_load_dwordx4 v43, s[48:51], s75 offen offset:3072  lds
    s_mov_b32 m0, 135168
    s_mov_b32 s68, 225280
L_w72:
    s_getreg_b32 s74, hwreg(HW_REG_IB_STS)
    s_and_b32 s74, s74, s76
    s_cmp_gt_u32 s74, s78
    s_cbranch_scc1 L_w72
    buffer_load_dwordx4 v8, s[32:35], s68 offen nt lds
    buffer_load_dwordx4 v9, s[32:35], s68 offen offset:1024 nt lds
    buffer_load_dwordx4 v10, s[32:35], s68 offen offset:2048 nt lds
    buffer_load_dwordx4 v11, s[32:35], s68 offen offset:3072 nt lds
    s_waitcnt lgkmcnt(0)
    v_readlane_b32 s15, v46, 0
    v_readlane_b32 s9, v46, 1
    v_readlane_b32 s14, v46, 2
    v_readlane_b32 s77, v46, 4
    s_min_u32 s15, s15, s9
    s_min_u32 s69, s15, s14
    s_waitcnt vmcnt(41)
    s_mov_b32 m0, 20480
    s_nop 0
    buffer_load_dwordx4 v40, s[48:51], s82 offen  lds
    s_mov_b32 m0, 160512
    s_mov_b32 s68, L_table-L_pc+236
    buffer_load_dword off, s[64:67], s68 lds
    s_mov_b32 m0, 139264
    s_mov_b32 s68, 163840
    s_add_u32 s78, s77, 27
    s_lshr_b32 s74, s78, 4
    s_lshl_b32 s74, s74, 22
    s_and_b32 s78, s78, 15
    s_or_b32 s78, s78, s74
L_w73:
    s_getreg_b32 s74, hwreg(HW_REG_IB_STS)
    s_and_b32 s74, s74, s76
    s_cmp_gt_u32 s74, s78
    s_cbranch_scc1 L_w73
    buffer_load_dwordx4 v12, s[36:39], s68 offen nt lds
    buffer_load_dwordx4 v12, s[36:39], s68 offen offset:1024 nt lds
    buffer_load_dwordx4 v12, s[36:39], s68 offen offset:2048 nt lds
    buffer_load_dwordx4 v12, s[36:39], s68 offen offset:3072 nt lds
    ds_read_b32 v46, v24
    s_waitcnt vmcnt(41)
    s_mov_b32 m0, 20480
    s_nop 0
    buffer_load_dwordx4 v41, s[48:51], s82 offen offset:1024  lds
    s_mov_b32 m0, 143360
    s_mov_b32 s68, 167936
    s_add_u32 s78, s77, 25
    s_lshr_b32 s74, s78, 4
    s_lshl_b32 s74, s74, 22
    s_and_b32 s78, s78, 15
    s_or_b32 s78, s78, s74
L_w74:
    s_getreg_b32 s74, hwreg(HW_REG_IB_STS)
    s_and_b32 s74, s74, s76
    s_cmp_gt_u32 s74, s78
    s_cbranch_scc1 L_w74
    buffer_load_dwordx4 v12, s[36:39], s68 offen nt lds
    buffer_load_dwordx4 v12, s[36:39], s68 offen offset:1024 nt lds
    buffer_load_dwordx4 v12, s[36:39], s68 offen offset:2048 nt lds
    buffer_load_dwordx4 v12, s[36:39], s68 offen offset:3072 nt lds
    s_waitcnt lgkmcnt(0)
    v_readlane_b32 s15, v46, 0
    v_readlane_b32 s9, v46, 1
    v_readlane_b32 s14, v46, 2
    v_readlane_b32 s77, v46, 4
    s_min_u32 s15, s15, s9
    s_min_u32 s69, s15, s14
    s_waitcnt vmcnt(40)
    s_mov_b32 m0, 20480
    s_nop 0
    buffer_load_dwordx4 v42, s[48:51], s82 offen offset:2048  lds
    buffer_load_dwordx4 v43, s[48:51], s82 offen offset:3072  lds
    s_mov_b32 m0, 160512
    s_mov_b32 s68, L_table-L_pc+240
    buffer_load_dword off, s[64:67], s68 lds
    s_getpc_b64 s[12:13]
    s_cmp_ge_u32 s69, 25
    s_cbranch_scc0 L_lrefresh
    s_xor_b32 s15, s7, 1
    s_lshl_b32 s75, s15, 17
    s_add_u32 s75, s75, 0
    s_add_u32 s82, s75, 16384
    s_mov_b32 m0, 147456
    s_mov_b32 s68, 172032
    s_add_u32 s78, s77, 27
    s_lshr_b32 s74, s78, 4
    s_lshl_b32 s74, s74, 22
    s_and_b32 s78, s78, 15
    s_or_b32 s78, s78, s74
L_w75:
    s_getreg_b32 s74, hwreg(HW_REG_IB_STS)
    s_and_b32 s74, s74, s76
    s_cmp_gt_u32 s74, s78
    s_cbranch_scc1 L_w75
    buffer_load_dwordx4 v12, s[36:39], s68 offen nt lds
    buffer_load_dwordx4 v12, s[36:39], s68 offen offset:1024 nt lds
    buffer_load_dwordx4 v12, s[36:39], s68 offen offset:2048 nt lds
    buffer_load_dwordx4 v12, s[36:39], s68 offen offset:3072 nt lds
    ds_read_b32 v46, v24
    s_waitcnt vmcnt(41)
    s_mov_b32 m0, 73728
    s_nop 0
    buffer_load_dwordx4 v40, s[48:51], s75 offen  lds
    s_mov_b32 m0, 151552
    s_mov_b32 s68, 176128
L_w76:
    s_getreg_b32 s74, hwreg(HW_REG_IB_STS)
    s_and_b32 s74, s74, s76
    s_cmp_gt_u32 s74, s78
    s_cbranch_scc1 L_w76
    buffer_load_dwordx4 v12, s[36:39], s68 offen nt lds
    buffer_load_dwordx4 v12, s[36:39], s68 offen offset:1024 nt lds
    buffer_load_dwordx4 v12, s[36:39], s68 offen offset:2048 nt lds
    buffer_load_dwordx4 v12, s[36:39], s68 offen offset:3072 nt lds
    s_waitcnt lgkmcnt(0)
    v_readlane_b32 s15, v46, 0
    v_readlane_b32 s9, v46, 1
    v_readlane_b32 s14, v46, 2
    v_readlane_b32 s77, v46, 4
    s_min_u32 s15, s15, s9
    s_min_u32 s69, s15, s14
    s_waitcnt vmcnt(41)
    s_mov_b32 m0, 73728
    s_nop 0
    buffer_load_dwordx4 v41, s[48:51], s75 offen offset:1024  lds
    s_mov_b32 m0, 160512
    s_mov_b32 s68, L_table-L_pc+244
    buffer_load_dword off, s[64:67], s68 lds
    s_getpc_b64 s[12:13]
    s_cmp_ge_u32 s69, 26
    s_cbranch_scc0 L_lrefresh
    s_mov_b32 m0, 81920
    s_mov_b32 s68, 180224
    s_add_u32 s78, s77, 26
    s_lshr_b32 s74, s78, 4
    s_lshl_b32 s74, s74, 22
    s_and_b32 s78, s78, 15
    s_or_b32 s78, s78, s74
L_w77:
    s_getreg_b32 s74, hwreg(HW_REG_IB_STS)
    s_and_b32 s74, s74, s76
    s_cmp_gt_u32 s74, s78
    s_cbranch_scc1 L_w77
    buffer_load_dwordx4 v12, s[36:39], s68 offen nt lds
    buffer_load_dwordx4 v12, s[36:39], s68 offen offset:1024 nt lds
    buffer_load_dwordx4 v12, s[36:39], s68 offen offset:2048 nt lds
    buffer_load_dwordx4 v12, s[36:39], s68 offen offset:3072 nt lds
    ds_read_b32 v46, v24
    s_waitcnt vmcnt(40)
    s_mov_b32 m0, 73728
    s_nop 0
    buffer_load_dwordx4 v42, s[48:51], s75 offen offset:2048  lds
    buffer_load_dwordx4 v43, s[48:51], s75 offen offset:3072  lds
    s_mov_b32 m0, 86016
    s_mov_b32 s68, 184320
L_w78:
    s_getreg_b32 s74, hwreg(HW_REG_IB_STS)
    s_and_b32 s74, s74, s76
    s_cmp_gt_u32 s74, s78
    s_cbranch_scc1 L_w78
    buffer_load_dwordx4 v12, s[36:39], s68 offen nt lds
    buffer_load_dwordx4 v12, s[36:39], s68 offen offset:1024 nt lds
    buffer_load_dwordx4 v12, s[36:39], s68 offen offset:2048 nt lds
    buffer_load_dwordx4 v12, s[36:39], s68 offen offset:3072 nt lds
    s_waitcnt lgkmcnt(0)
    v_readlane_b32 s15, v46, 0
    v_readlane_b32 s9, v46, 1
    v_readlane_b32 s14, v46, 2
    v_readlane_b32 s77, v46, 4
    s_min_u32 s15, s15, s9
    s_min_u32 s69, s15, s14
    s_waitcnt vmcnt(41)
    s_mov_b32 m0, 77824
    s_nop 0
    buffer_load_dwordx4 v40, s[48:51], s82 offen  lds
    s_mov_b32 m0, 160512
    s_mov_b32 s68, L_table-L_pc+248
    buffer_load_dword off, s[64:67], s68 lds
    s_mov_b32 m0, 98304
    s_mov_b32 s68, 188416
    s_add_u32 s78, s77, 27
    s_lshr_b32 s74, s78, 4
    s_lshl_b32 s74, s74, 22
    s_and_b32 s78, s78, 15
    s_or_b32 s78, s78, s74
L_w79:
    s_getreg_b32 s74, hwreg(HW_REG_IB_STS)
    s_and_b32 s74, s74, s76
    s_cmp_gt_u32 s74, s78
    s_cbranch_scc1 L_w79
    buffer_load_dwordx4 v12, s[36:39], s68 offen nt lds
    buffer_load_dwordx4 v12, s[36:39], s68 offen offset:1024 nt lds
    buffer_load_dwordx4 v12, s[36:39], s68 offen offset:2048 nt lds
    buffer_load_dwordx4 v12, s[36:39], s68 offen offset:3072 nt lds
    ds_read_b32 v46, v24
    s_waitcnt vmcnt(41)
    s_mov_b32 m0, 77824
    s_nop 0
    buffer_load_dwordx4 v41, s[48:51], s82 offen offset:1024  lds
    s_mov_b32 m0, 102400
    s_mov_b32 s68, 192512
    s_add_u32 s78, s77, 25
    s_lshr_b32 s74, s78, 4
    s_lshl_b32 s74, s74, 22
    s_and_b32 s78, s78, 15
    s_or_b32 s78, s78, s74
L_w80:
    s_getreg_b32 s74, hwreg(HW_REG_IB_STS)
    s_and_b32 s74, s74, s76
    s_cmp_gt_u32 s74, s78
    s_cbranch_scc1 L_w80
    buffer_load_dwordx4 v12, s[36:39], s68 offen nt lds
    buffer_load_dwordx4 v12, s[36:39], s68 offen offset:1024 nt lds
    buffer_load_dwordx4 v12, s[36:39], s68 offen offset:2048 nt lds
    buffer_load_dwordx4 v12, s[36:39], s68 offen offset:3072 nt lds
    s_waitcnt lgkmcnt(0)
    v_readlane_b32 s15, v46, 0
    v_readlane_b32 s9, v46, 1
    v_readlane_b32 s14, v46, 2
    v_readlane_b32 s77, v46, 4
    s_min_u32 s15, s15, s9
    s_min_u32 s69, s15, s14
    s_waitcnt vmcnt(40)
    s_mov_b32 m0, 77824
    s_nop 0
    buffer_load_dwordx4 v42, s[48:51], s82 offen offset:2048  lds
    buffer_load_dwordx4 v43, s[48:51], s82 offen offset:3072  lds
    s_mov_b32 m0, 160512
    s_mov_b32 s68, L_table-L_pc+256
    buffer_load_dword off, s[64:67], s68 lds
    s_getpc_b64 s[12:13]
    s_cmp_ge_u32 s69, 27
    s_cbranch_scc0 L_lrefresh
    s_xor_b32 s15, s7, 1
    s_lshl_b32 s75, s15, 17
    s_add_u32 s75, s75, 32768
    s_add_u32 s82, s75, 16384
    s_mov_b32 m0, 114688
    s_mov_b32 s68, 229376
    s_add_u32 s78, s77, 27
    s_lshr_b32 s74, s78, 4
    s_lshl_b32 s74, s74, 22
    s_and_b32 s78, s78, 15
    s_or_b32 s78, s78, s74
L_w81:
    s_getreg_b32 s74, hwreg(HW_REG_IB_STS)
    s_and_b32 s74, s74, s76
    s_cmp_gt_u32 s74, s78
    s_cbranch_scc1 L_w81
    buffer_load_dwordx4 v8, s[32:35], s68 offen nt lds
    buffer_load_dwordx4 v9, s[32:35], s68 offen offset:1024 nt lds
    buffer_load_dwordx4 v10, s[32:35], s68 offen offset:2048 nt lds
    buffer_load_dwordx4 v11, s[32:35], s68 offen offset:3072 nt lds
    ds_read_b32 v46, v24
    s_waitcnt vmcnt(41)
    s_mov_b32 m0, 106496
    s_nop 0
    buffer_load_dwordx4 v40, s[48:51], s75 offen  lds
    s_mov_b32 m0, 118784
    s_mov_b32 s68, 233472
L_w82:
    s_getreg_b32 s74, hwreg(HW_REG_IB_STS)
    s_and_b32 s74, s74, s76
    s_cmp_gt_u32 s74, s78
    s_cbranch_scc1 L_w82
    buffer_load_dwordx4 v8, s[32:35], s68 offen nt lds
    buffer_load_dwordx4 v9, s[32:35], s68 offen offset:1024 nt lds
    buffer_load_dwordx4 v10, s[32:35], s68 offen offset:2048 nt lds
    buffer_load_dwordx4 v11, s[32:35], s68 offen offset:3072 nt lds
    s_waitcnt lgkmcnt(0)
    v_readlane_b32 s15, v46, 0
    v_readlane_b32 s9, v46, 1
    v_readlane_b32 s14, v46, 2
    v_readlane_b32 s77, v46, 4
    s_min_u32 s15, s15, s9
    s_min_u32 s69, s15, s14
    s_waitcnt vmcnt(41)
    s_mov_b32 m0, 106496
    s_nop 0
    buffer_load_dwordx4 v41, s[48:51], s75 offen offset:1024  lds
    s_mov_b32 m0, 160512
    s_mov_b32 s68, L_table-L_pc+260
    buffer_load_dword off, s[64:67], s68 lds
    s_getpc_b64 s[12:13]
    s_cmp_ge_u32 s69, 28
    s_cbranch_scc0 L_lrefresh
    s_mov_b32 m0, 40960
    s_mov_b32 s68, 237568
    s_add_u32 s78, s77, 26
    s_lshr_b32 s74, s78, 4
    s_lshl_b32 s74, s74, 22
    s_and_b32 s78, s78, 15
    s_or_b32 s78, s78, s74
L_w83:
    s_getreg_b32 s74, hwreg(HW_REG_IB_STS)
    s_and_b32 s74, s74, s76
    s_cmp_gt_u32 s74, s78
    s_cbranch_scc1 L_w83
    buffer_load_dwordx4 v8, s[32:35], s68 offen nt lds
    buffer_load_dwordx4 v9, s[32:35], s68 offen offset:1024 nt lds
    buffer_load_dwordx4 v10, s[32:35], s68 offen offset:2048 nt lds
    buffer_load_dwordx4 v11, s[32:35], s68 offen offset:3072 nt lds
    ds_read_b32 v46, v24
    s_waitcnt vmcnt(40)
    s_mov_b32 m0, 106496
    s_nop 0
    buffer_load_dwordx4 v42, s[48:51], s75 offen offset:2048  lds
    buffer_load_dwordx4 v43, s[48:51], s75 offen offset:3072  lds
    s_mov_b32 m0, 45056
    s_mov_b32 s68, 241664
L_w84:
    s_getreg_b32 s74, hwreg(HW_REG_IB_STS)
    s_and_b32 s74, s74, s76
    s_cmp_gt_u32 s74, s78
    s_cbranch_scc1 L_w84
    buffer_load_dwordx4 v8, s[32:35], s68 offen nt lds
    buffer_load_dwordx4 v9, s[32:35], s68 offen offset:1024 nt lds
    buffer_load_dwordx4 v10, s[32:35], s68 offen offset:2048 nt lds
    buffer_load_dwordx4 v11, s[32:35], s68 offen offset:3072 nt lds
    s_waitcnt lgkmcnt(0)
    v_readlane_b32 s15, v46, 0
    v_readlane_b32 s9, v46, 1
    v_readlane_b32 s14, v46, 2
    v_readlane_b32 s77, v46, 4
    s_min_u32 s15, s15, s9
    s_min_u32 s69, s15, s14
    s_waitcnt vmcnt(41)
    s_mov_b32 m0, 110592
    s_nop 0
    buffer_load_dwordx4 v40, s[48:51], s82 offen  lds
    s_mov_b32 m0, 160512
    s_mov_b32 s68, L_table-L_pc+264
    buffer_load_dword off, s[64:67], s68 lds
    s_mov_b32 m0, 122880
    s_mov_b32 s68, 245760
    s_add_u32 s78, s77, 27
    s_lshr_b32 s74, s78, 4
    s_lshl_b32 s74, s74, 22
    s_and_b32 s78, s78, 15
    s_or_b32 s78, s78, s74
L_w85:
    s_getreg_b32 s74, hwreg(HW_REG_IB_STS)
    s_and_b32 s74, s74, s76
    s_cmp_gt_u32 s74, s78
    s_cbranch_scc1 L_w85
    buffer_load_dwordx4 v8, s[32:35], s68 offen nt lds
    buffer_load_dwordx4 v9, s[32:35], s68 offen offset:1024 nt lds
    buffer_load_dwordx4 v10, s[32:35], s68 offen offset:2048 nt lds
    buffer_load_dwordx4 v11, s[32:35], s68 offen offset:3072 nt lds
    ds_read_b32 v46, v24
    s_waitcnt vmcnt(41)
    s_mov_b32 m0, 110592
    s_nop 0
    buffer_load_dwordx4 v41, s[48:51], s82 offen offset:1024  lds
    s_mov_b32 m0, 126976
    s_mov_b32 s68, 249856
    s_add_u32 s78, s77, 25
    s_lshr_b32 s74, s78, 4
    s_lshl_b32 s74, s74, 22
    s_and_b32 s78, s78, 15
    s_or_b32 s78, s78, s74
L_w86:
    s_getreg_b32 s74, hwreg(HW_REG_IB_STS)
    s_and_b32 s74, s74, s76
    s_cmp_gt_u32 s74, s78
    s_cbranch_scc1 L_w86
    buffer_load_dwordx4 v8, s[32:35], s68 offen nt lds
    buffer_load_dwordx4 v9, s[32:35], s68 offen offset:1024 nt lds
    buffer_load_dwordx4 v10, s[32:35], s68 offen offset:2048 nt lds
    buffer_load_dwordx4 v11, s[32:35], s68 offen offset:3072 nt lds
    s_waitcnt lgkmcnt(0)
    v_readlane_b32 s15, v46, 0
    v_readlane_b32 s9, v46, 1
    v_readlane_b32 s14, v46, 2
    v_readlane_b32 s77, v46, 4
    s_min_u32 s15, s15, s9
    s_min_u32 s69, s15, s14
    s_waitcnt vmcnt(40)
    s_mov_b32 m0, 110592
    s_nop 0
    buffer_load_dwordx4 v42, s[48:51], s82 offen offset:2048  lds
    buffer_load_dwordx4 v43, s[48:51], s82 offen offset:3072  lds
    s_mov_b32 m0, 160512
    s_mov_b32 s68, L_table-L_pc+268
    buffer_load_dword off, s[64:67], s68 lds
    s_getpc_b64 s[12:13]
    s_cmp_ge_u32 s69, 29
    s_cbranch_scc0 L_lrefresh
    s_xor_b32 s15, s7, 1
    s_lshl_b32 s75, s15, 17
    s_add_u32 s75, s75, 65536
    s_add_u32 s82, s75, 16384
    s_mov_b32 m0, 57344
    s_mov_b32 s68, 253952
    s_add_u32 s78, s77, 27
    s_lshr_b32 s74, s78, 4
    s_lshl_b32 s74, s74, 22
    s_and_b32 s78, s78, 15
    s_or_b32 s78, s78, s74
L_w87:
    s_getreg_b32 s74, hwreg(HW_REG_IB_STS)
    s_and_b32 s74, s74, s76
    s_cmp_gt_u32 s74, s78
    s_cbranch_scc1 L_w87
    buffer_load_dwordx4 v8, s[32:35], s68 offen nt lds
    buffer_load_dwordx4 v9, s[32:35], s68 offen offset:1024 nt lds
    buffer_load_dwordx4 v10, s[32:35], s68 offen offset:2048 nt lds
    buffer_load_dwordx4 v11, s[32:35], s68 offen offset:3072 nt lds
    ds_read_b32 v46, v24
    s_waitcnt vmcnt(41)
    s_mov_b32 m0, 49152
    s_nop 0
    buffer_load_dwordx4 v40, s[48:51], s75 offen  lds
    s_mov_b32 m0, 61440
    s_mov_b32 s68, 258048
L_w88:
    s_getreg_b32 s74, hwreg(HW_REG_IB_STS)
    s_and_b32 s74, s74, s76
    s_cmp_gt_u32 s74, s78
    s_cbranch_scc1 L_w88
    buffer_load_dwordx4 v8, s[32:35], s68 offen nt lds
    buffer_load_dwordx4 v9, s[32:35], s68 offen offset:1024 nt lds
    buffer_load_dwordx4 v10, s[32:35], s68 offen offset:2048 nt lds
    buffer_load_dwordx4 v11, s[32:35], s68 offen offset:3072 nt lds
    s_waitcnt lgkmcnt(0)
    v_readlane_b32 s15, v46, 0
    v_readlane_b32 s9, v46, 1
    v_readlane_b32 s14, v46, 2
    v_readlane_b32 s77, v46, 4
    s_min_u32 s15, s15, s9
    s_min_u32 s69, s15, s14
    s_waitcnt vmcnt(41)
    s_mov_b32 m0, 49152
    s_nop 0
    buffer_load_dwordx4 v41, s[48:51], s75 offen offset:1024  lds
    s_mov_b32 m0, 160512
    s_mov_b32 s68, L_table-L_pc+272
    buffer_load_dword off, s[64:67], s68 lds
    s_getpc_b64 s[12:13]
    s_cmp_ge_u32 s69, 30
    s_cbranch_scc0 L_lrefresh
    s_mov_b32 m0, 8192
    s_mov_b32 s68, 196608
    s_add_u32 s78, s77, 26
    s_lshr_b32 s74, s78, 4
    s_lshl_b32 s74, s74, 22
    s_and_b32 s78, s78, 15
    s_or_b32 s78, s78, s74
L_w89:
    s_getreg_b32 s74, hwreg(HW_REG_IB_STS)
    s_and_b32 s74, s74, s76
    s_cmp_gt_u32 s74, s78
    s_cbranch_scc1 L_w89
    buffer_load_dwordx4 v12, s[36:39], s68 offen nt lds
    buffer_load_dwordx4 v12, s[36:39], s68 offen offset:1024 nt lds
    buffer_load_dwordx4 v12, s[36:39], s68 offen offset:2048 nt lds
    buffer_load_dwordx4 v12, s[36:39], s68 offen offset:3072 nt lds
    ds_read_b32 v46, v24
    s_waitcnt vmcnt(40)
    s_mov_b32 m0, 49152
    s_nop 0
    buffer_load_dwordx4 v42, s[48:51], s75 offen offset:2048  lds
    buffer_load_dwordx4 v43, s[48:51], s75 offen offset:3072  lds
    s_mov_b32 m0, 12288
    s_mov_b32 s68, 200704
L_w90:
    s_getreg_b32 s74, hwreg(HW_REG_IB_STS)
    s_and_b32 s74, s74, s76
    s_cmp_gt_u32 s74, s78
    s_cbranch_scc1 L_w90
    buffer_load_dwordx4 v12, s[36:39], s68 offen nt lds
    buffer_load_dwordx4 v12, s[36:39], s68 offen offset:1024 nt lds
    buffer_load_dwordx4 v12, s[36:39], s68 offen offset:2048 nt lds
    buffer_load_dwordx4 v12, s[36:39], s68 offen offset:3072 nt lds
    s_waitcnt lgkmcnt(0)
    v_readlane_b32 s15, v46, 0
    v_readlane_b32 s9, v46, 1
    v_readlane_b32 s14, v46, 2
    v_readlane_b32 s77, v46, 4
    s_min_u32 s15, s15, s9
    s_min_u32 s69, s15, s14
    s_waitcnt vmcnt(41)
    s_mov_b32 m0, 53248
    s_nop 0
    buffer_load_dwordx4 v40, s[48:51], s82 offen  lds
    s_mov_b32 m0, 160512
    s_mov_b32 s68, L_table-L_pc+276
    buffer_load_dword off, s[64:67], s68 lds
    s_getpc_b64 s[12:13]
    s_cmp_ge_u32 s69, 31
    s_cbranch_scc0 L_lrefresh
    s_mov_b32 m0, 65536
    s_mov_b32 s68, 204800
    s_add_u32 s78, s77, 27
    s_lshr_b32 s74, s78, 4
    s_lshl_b32 s74, s74, 22
    s_and_b32 s78, s78, 15
    s_or_b32 s78, s78, s74
L_w91:
    s_getreg_b32 s74, hwreg(HW_REG_IB_STS)
    s_and_b32 s74, s74, s76
    s_cmp_gt_u32 s74, s78
    s_cbranch_scc1 L_w91
    buffer_load_dwordx4 v12, s[36:39], s68 offen nt lds
    buffer_load_dwordx4 v12, s[36:39], s68 offen offset:1024 nt lds
    buffer_load_dwordx4 v12, s[36:39], s68 offen offset:2048 nt lds
    buffer_load_dwordx4 v12, s[36:39], s68 offen offset:3072 nt lds
    ds_read_b32 v46, v24
    s_waitcnt vmcnt(41)
    s_mov_b32 m0, 53248
    s_nop 0
    buffer_load_dwordx4 v41, s[48:51], s82 offen offset:1024  lds
    s_mov_b32 m0, 69632
    s_mov_b32 s68, 208896
    s_add_u32 s78, s77, 25
    s_lshr_b32 s74, s78, 4
    s_lshl_b32 s74, s74, 22
    s_and_b32 s78, s78, 15
    s_or_b32 s78, s78, s74
L_w92:
    s_getreg_b32 s74, hwreg(HW_REG_IB_STS)
    s_and_b32 s74, s74, s76
    s_cmp_gt_u32 s74, s78
    s_cbranch_scc1 L_w92
    buffer_load_dwordx4 v12, s[36:39], s68 offen nt lds
    buffer_load_dwordx4 v12, s[36:39], s68 offen offset:1024 nt lds
    buffer_load_dwordx4 v12, s[36:39], s68 offen offset:2048 nt lds
    buffer_load_dwordx4 v12, s[36:39], s68 offen offset:3072 nt lds
    s_waitcnt lgkmcnt(0)
    v_readlane_b32 s15, v46, 0
    v_readlane_b32 s9, v46, 1
    v_readlane_b32 s14, v46, 2
    v_readlane_b32 s77, v46, 4
    s_min_u32 s15, s15, s9
    s_min_u32 s69, s15, s14
    s_waitcnt vmcnt(40)
    s_mov_b32 m0, 53248
    s_nop 0
    buffer_load_dwordx4 v42, s[48:51], s82 offen offset:2048  lds
    buffer_load_dwordx4 v43, s[48:51], s82 offen offset:3072  lds
    s_mov_b32 m0, 160512
    s_mov_b32 s68, L_table-L_pc+280
    buffer_load_dword off, s[64:67], s68 lds
    s_getpc_b64 s[12:13]
    s_cmp_ge_u32 s69, 32
    s_cbranch_scc0 L_lrefresh
    s_xor_b32 s15, s7, 1
    s_lshl_b32 s75, s15, 17
    s_add_u32 s75, s75, 98304
    s_add_u32 s82, s75, 16384
    s_getpc_b64 s[12:13]
    s_cmp_ge_u32 s69, 33
    s_cbranch_scc0 L_lrefresh
    s_mov_b32 m0, 131072
    s_mov_b32 s68, 212992
    s_add_u32 s78, s77, 27
    s_lshr_b32 s74, s78, 4
    s_lshl_b32 s74, s74, 22
    s_and_b32 s78, s78, 15
    s_or_b32 s78, s78, s74
L_w93:
    s_getreg_b32 s74, hwreg(HW_REG_IB_STS)
    s_and_b32 s74, s74, s76
    s_cmp_gt_u32 s74, s78
    s_cbranch_scc1 L_w93
    buffer_load_dwordx4 v12, s[36:39], s68 offen nt lds
    buffer_load_dwordx4 v12, s[36:39], s68 offen offset:1024 nt lds
    buffer_load_dwordx4 v12, s[36:39], s68 offen offset:2048 nt lds
    buffer_load_dwordx4 v12, s[36:39], s68 offen offset:3072 nt lds
    ds_read_b32 v46, v24
    s_waitcnt vmcnt(41)
    s_mov_b32 m0, 24576
    s_nop 0
    buffer_load_dwordx4 v40, s[48:51], s75 offen  lds
    s_mov_b32 m0, 135168
    s_mov_b32 s68, 217088
L_w94:
    s_getreg_b32 s74, hwreg(HW_REG_IB_STS)
    s_and_b32 s74, s74, s76
    s_cmp_gt_u32 s74, s78
    s_cbranch_scc1 L_w94
    buffer_load_dwordx4 v12, s[36:39], s68 offen nt lds
    buffer_load_dwordx4 v12, s[36:39], s68 offen offset:1024 nt lds
    buffer_load_dwordx4 v12, s[36:39], s68 offen offset:2048 nt lds
    buffer_load_dwordx4 v12, s[36:39], s68 offen offset:3072 nt lds
    s_waitcnt lgkmcnt(0)
    v_readlane_b32 s15, v46, 0
    v_readlane_b32 s9, v46, 1
    v_readlane_b32 s14, v46, 2
    v_readlane_b32 s77, v46, 4
    s_min_u32 s15, s15, s9
    s_min_u32 s69, s15, s14
    s_waitcnt vmcnt(41)
    s_mov_b32 m0, 24576
    s_nop 0
    buffer_load_dwordx4 v41, s[48:51], s75 offen offset:1024  lds
    s_mov_b32 m0, 160512
    s_mov_b32 s68, L_table-L_pc+284
    buffer_load_dword off, s[64:67], s68 lds
    s_getpc_b64 s[12:13]
    s_cmp_ge_u32 s69, 34
    s_cbranch_scc0 L_lrefresh
    s_mov_b32 m0, 139264
    s_mov_b32 s68, 221184
    s_add_u32 s78, s77, 26
    s_lshr_b32 s74, s78, 4
    s_lshl_b32 s74, s74, 22
    s_and_b32 s78, s78, 15
    s_or_b32 s78, s78, s74
L_w95:
    s_getreg_b32 s74, hwreg(HW_REG_IB_STS)
    s_and_b32 s74, s74, s76
    s_cmp_gt_u32 s74, s78
    s_cbranch_scc1 L_w95
    buffer_load_dwordx4 v12, s[36:39], s68 offen nt lds
    buffer_load_dwordx4 v12, s[36:39], s68 offen offset:1024 nt lds
    buffer_load_dwordx4 v12, s[36:39], s68 offen offset:2048 nt lds
    buffer_load_dwordx4 v12, s[36:39], s68 offen offset:3072 nt lds
    ds_read_b32 v46, v24
    s_waitcnt vmcnt(40)
    s_mov_b32 m0, 24576
    s_nop 0
    buffer_load_dwordx4 v42, s[48:51], s75 offen offset:2048  lds
    buffer_load_dwordx4 v43, s[48:51], s75 offen offset:3072  lds
    s_mov_b32 m0, 143360
    s_mov_b32 s68, 225280
L_w96:
    s_getreg_b32 s74, hwreg(HW_REG_IB_STS)
    s_and_b32 s74, s74, s76
    s_cmp_gt_u32 s74, s78
    s_cbranch_scc1 L_w96
    buffer_load_dwordx4 v12, s[36:39], s68 offen nt lds
    buffer_load_dwordx4 v12, s[36:39], s68 offen offset:1024 nt lds
    buffer_load_dwordx4 v12, s[36:39], s68 offen offset:2048 nt lds
    buffer_load_dwordx4 v12, s[36:39], s68 offen offset:3072 nt lds
    s_waitcnt lgkmcnt(0)
    v_readlane_b32 s15, v46, 0
    v_readlane_b32 s9, v46, 1
    v_readlane_b32 s14, v46, 2
    v_readlane_b32 s77, v46, 4
    s_min_u32 s15, s15, s9
    s_min_u32 s69, s15, s14
    s_waitcnt vmcnt(41)
    s_mov_b32 m0, 28672
    s_nop 0
    buffer_load_dwordx4 v40, s[48:51], s82 offen  lds
    s_mov_b32 m0, 160512
    s_mov_b32 s68, L_table-L_pc+288
    buffer_load_dword off, s[64:67], s68 lds
    s_getpc_b64 s[12:13]
    s_cmp_ge_u32 s69, 35
    s_cbranch_scc0 L_lrefresh
    s_mov_b32 m0, 147456
    s_mov_b32 s68, 229376
    s_add_u32 s78, s77, 27
    s_lshr_b32 s74, s78, 4
    s_lshl_b32 s74, s74, 22
    s_and_b32 s78, s78, 15
    s_or_b32 s78, s78, s74
L_w97:
    s_getreg_b32 s74, hwreg(HW_REG_IB_STS)
    s_and_b32 s74, s74, s76
    s_cmp_gt_u32 s74, s78
    s_cbranch_scc1 L_w97
    buffer_load_dwordx4 v12, s[36:39], s68 offen nt lds
    buffer_load_dwordx4 v12, s[36:39], s68 offen offset:1024 nt lds
    buffer_load_dwordx4 v12, s[36:39], s68 offen offset:2048 nt lds
    buffer_load_dwordx4 v12, s[36:39], s68 offen offset:3072 nt lds
    ds_read_b32 v46, v24
    s_waitcnt vmcnt(41)
    s_mov_b32 m0, 28672
    s_nop 0
    buffer_load_dwordx4 v41, s[48:51], s82 offen offset:1024  lds
    s_mov_b32 m0, 151552
    s_mov_b32 s68, 233472
    s_add_u32 s78, s77, 25
    s_lshr_b32 s74, s78, 4
    s_lshl_b32 s74, s74, 22
    s_and_b32 s78, s78, 15
    s_or_b32 s78, s78, s74
L_w98:
    s_getreg_b32 s74, hwreg(HW_REG_IB_STS)
    s_and_b32 s74, s74, s76
    s_cmp_gt_u32 s74, s78
    s_cbranch_scc1 L_w98
    buffer_load_dwordx4 v12, s[36:39], s68 offen nt lds
    buffer_load_dwordx4 v12, s[36:39], s68 offen offset:1024 nt lds
    buffer_load_dwordx4 v12, s[36:39], s68 offen offset:2048 nt lds
    buffer_load_dwordx4 v12, s[36:39], s68 offen offset:3072 nt lds
    s_waitcnt lgkmcnt(0)
    v_readlane_b32 s15, v46, 0
    v_readlane_b32 s9, v46, 1
    v_readlane_b32 s14, v46, 2
    v_readlane_b32 s77, v46, 4
    s_min_u32 s15, s15, s9
    s_min_u32 s69, s15, s14
    s_waitcnt vmcnt(40)
    s_mov_b32 m0, 28672
    s_nop 0
    buffer_load_dwordx4 v42, s[48:51], s82 offen offset:2048  lds
    buffer_load_dwordx4 v43, s[48:51], s82 offen offset:3072  lds
    s_mov_b32 m0, 160512
    s_mov_b32 s68, L_table-L_pc+292
    buffer_load_dword off, s[64:67], s68 lds
    s_getpc_b64 s[12:13]
    s_cmp_ge_u32 s69, 36
    s_cbranch_scc0 L_lrefresh
    s_xor_b32 s15, s7, 2
    s_lshl_b32 s75, s15, 17
    s_add_u32 s75, s75, 0
    s_add_u32 s82, s75, 16384
    s_getpc_b64 s[12:13]
    s_cmp_ge_u32 s69, 37
    s_cbranch_scc0 L_lrefresh
    s_mov_b32 m0, 98304
    s_mov_b32 s68, 237568
    s_add_u32 s78, s77, 27
    s_lshr_b32 s74, s78, 4
    s_lshl_b32 s74, s74, 22
    s_and_b32 s78, s78, 15
    s_or_b32 s78, s78, s74
L_w99:
    s_getreg_b32 s74, hwreg(HW_REG_IB_STS)
    s_and_b32 s74, s74, s76
    s_cmp_gt_u32 s74, s78
    s_cbranch_scc1 L_w99
    buffer_load_dwordx4 v12, s[36:39], s68 offen nt lds
    buffer_load_dwordx4 v12, s[36:39], s68 offen offset:1024 nt lds
    buffer_load_dwordx4 v12, s[36:39], s68 offen offset:2048 nt lds
    buffer_load_dwordx4 v12, s[36:39], s68 offen offset:3072 nt lds
    ds_read_b32 v46, v24
    s_waitcnt vmcnt(41)
    s_mov_b32 m0, 81920
    s_nop 0
    buffer_load_dwordx4 v40, s[48:51], s75 offen  lds
    s_mov_b32 m0, 102400
    s_mov_b32 s68, 241664
L_w100:
    s_getreg_b32 s74, hwreg(HW_REG_IB_STS)
    s_and_b32 s74, s74, s76
    s_cmp_gt_u32 s74, s78
    s_cbranch_scc1 L_w100
    buffer_load_dwordx4 v12, s[36:39], s68 offen nt lds
    buffer_load_dwordx4 v12, s[36:39], s68 offen offset:1024 nt lds
    buffer_load_dwordx4 v12, s[36:39], s68 offen offset:2048 nt lds
    buffer_load_dwordx4 v12, s[36:39], s68 offen offset:3072 nt lds
    s_waitcnt lgkmcnt(0)
    v_readlane_b32 s15, v46, 0
    v_readlane_b32 s9, v46, 1
    v_readlane_b32 s14, v46, 2
    v_readlane_b32 s77, v46, 4
    s_min_u32 s15, s15, s9
    s_min_u32 s69, s15, s14
    s_waitcnt vmcnt(41)
    s_mov_b32 m0, 81920
    s_nop 0
    buffer_load_dwordx4 v41, s[48:51], s75 offen offset:1024  lds
    s_mov_b32 m0, 160512
    s_mov_b32 s68, L_table-L_pc+296
    buffer_load_dword off, s[64:67], s68 lds
    s_getpc_b64 s[12:13]
    s_cmp_ge_u32 s69, 38
    s_cbranch_scc0 L_lrefresh
    s_mov_b32 m0, 114688
    s_mov_b32 s68, 245760
    s_add_u32 s78, s77, 54
    s_lshr_b32 s74, s78, 4
    s_lshl_b32 s74, s74, 22
    s_and_b32 s78, s78, 15
    s_or_b32 s78, s78, s74
L_w101:
    s_getreg_b32 s74, hwreg(HW_REG_IB_STS)
    s_and_b32 s74, s74, s76
    s_cmp_gt_u32 s74, s78
    s_cbranch_scc1 L_w101
    buffer_load_dwordx4 v12, s[36:39], s68 offen nt lds
    buffer_load_dwordx4 v12, s[36:39], s68 offen offset:1024 nt lds
    buffer_load_dwordx4 v12, s[36:39], s68 offen offset:2048 nt lds
    buffer_load_dwordx4 v12, s[36:39], s68 offen offset:3072 nt lds
    ds_read_b32 v46, v24
    s_waitcnt vmcnt(40)
    s_mov_b32 m0, 81920
    s_nop 0
    buffer_load_dwordx4 v42, s[48:51], s75 offen offset:2048  lds
    buffer_load_dwordx4 v43, s[48:51], s75 offen offset:3072  lds
    s_mov_b32 m0, 118784
    s_mov_b32 s68, 249856
L_w102:
    s_getreg_b32 s74, hwreg(HW_REG_IB_STS)
    s_and_b32 s74, s74, s76
    s_cmp_gt_u32 s74, s78
    s_cbranch_scc1 L_w102
    buffer_load_dwordx4 v12, s[36:39], s68 offen nt lds
    buffer_load_dwordx4 v12, s[36:39], s68 offen offset:1024 nt lds
    buffer_load_dwordx4 v12, s[36:39], s68 offen offset:2048 nt lds
    buffer_load_dwordx4 v12, s[36:39], s68 offen offset:3072 nt lds
    s_waitcnt lgkmcnt(0)
    v_readlane_b32 s15, v46, 0
    v_readlane_b32 s9, v46, 1
    v_readlane_b32 s14, v46, 2
    v_readlane_b32 s77, v46, 4
    s_min_u32 s15, s15, s9
    s_min_u32 s69, s15, s14
    s_waitcnt vmcnt(41)
    s_mov_b32 m0, 86016
    s_nop 0
    buffer_load_dwordx4 v40, s[48:51], s82 offen  lds
    s_mov_b32 m0, 160512
    s_mov_b32 s68, L_table-L_pc+300
    buffer_load_dword off, s[64:67], s68 lds
    s_getpc_b64 s[12:13]
    s_cmp_ge_u32 s69, 39
    s_cbranch_scc0 L_lrefresh
    s_mov_b32 m0, 40960
    s_mov_b32 s68, 253952
    s_add_u32 s78, s77, 54
    s_lshr_b32 s74, s78, 4
    s_lshl_b32 s74, s74, 22
    s_and_b32 s78, s78, 15
    s_or_b32 s78, s78, s74
L_w103:
    s_getreg_b32 s74, hwreg(HW_REG_IB_STS)
    s_and_b32 s74, s74, s76
    s_cmp_gt_u32 s74, s78
    s_cbranch_scc1 L_w103
    buffer_load_dwordx4 v12, s[36:39], s68 offen nt lds
    buffer_load_dwordx4 v12, s[36:39], s68 offen offset:1024 nt lds
    buffer_load_dwordx4 v12, s[36:39], s68 offen offset:2048 nt lds
    buffer_load_dwordx4 v12, s[36:39], s68 offen offset:3072 nt lds
    ds_read_b32 v46, v24
    s_waitcnt vmcnt(41)
    s_mov_b32 m0, 86016
    s_nop 0
    buffer_load_dwordx4 v41, s[48:51], s82 offen offset:1024  lds
    s_mov_b32 m0, 45056
    s_mov_b32 s68, 258048
L_w104:
    s_getreg_b32 s74, hwreg(HW_REG_IB_STS)
    s_and_b32 s74, s74, s76
    s_cmp_gt_u32 s74, s78
    s_cbranch_scc1 L_w104
    buffer_load_dwordx4 v12, s[36:39], s68 offen nt lds
    buffer_load_dwordx4 v12, s[36:39], s68 offen offset:1024 nt lds
    buffer_load_dwordx4 v12, s[36:39], s68 offen offset:2048 nt lds
    buffer_load_dwordx4 v12, s[36:39], s68 offen offset:3072 nt lds
    s_waitcnt lgkmcnt(0)
    v_readlane_b32 s15, v46, 0
    v_readlane_b32 s9, v46, 1
    v_readlane_b32 s14, v46, 2
    v_readlane_b32 s77, v46, 4
    s_min_u32 s15, s15, s9
    s_min_u32 s69, s15, s14
    s_waitcnt vmcnt(40)
    s_mov_b32 m0, 86016
    s_nop 0
    buffer_load_dwordx4 v42, s[48:51], s82 offen offset:2048  lds
    buffer_load_dwordx4 v43, s[48:51], s82 offen offset:3072  lds
    s_mov_b32 m0, 160512
    s_mov_b32 s68, L_table-L_pc+304
    buffer_load_dword off, s[64:67], s68 lds
    s_getpc_b64 s[12:13]
    s_cmp_ge_u32 s69, 40
    s_cbranch_scc0 L_lrefresh
    s_xor_b32 s15, s7, 2
    s_lshl_b32 s75, s15, 17
    s_add_u32 s75, s75, 32768
    s_add_u32 s82, s75, 16384
    s_waitcnt vmcnt(38)
    s_mov_b32 m0, 122880
    s_nop 0
    buffer_load_dwordx4 v40, s[48:51], s75 offen  lds
    buffer_load_dwordx4 v41, s[48:51], s75 offen offset:1024  lds
    buffer_load_dwordx4 v42, s[48:51], s75 offen offset:2048  lds
    buffer_load_dwordx4 v43, s[48:51], s75 offen offset:3072  lds
    s_waitcnt vmcnt(38)
    s_mov_b32 m0, 126976
    s_nop 0
    buffer_load_dwordx4 v40, s[48:51], s82 offen  lds
    buffer_load_dwordx4 v41, s[48:51], s82 offen offset:1024  lds
    buffer_load_dwordx4 v42, s[48:51], s82 offen offset:2048  lds
    buffer_load_dwordx4 v43, s[48:51], s82 offen offset:3072  lds
    s_getpc_b64 s[12:13]
    s_cmp_ge_u32 s69, 41
    s_cbranch_scc0 L_lrefresh
    s_xor_b32 s15, s7, 2
    s_lshl_b32 s75, s15, 17
    s_add_u32 s75, s75, 65536
    s_add_u32 s82, s75, 16384
    s_waitcnt vmcnt(38)
    s_mov_b32 m0, 57344
    s_nop 0
    buffer_load_dwordx4 v40, s[48:51], s75 offen  lds
    buffer_load_dwordx4 v41, s[48:51], s75 offen offset:1024  lds
    buffer_load_dwordx4 v42, s[48:51], s75 offen offset:2048  lds
    buffer_load_dwordx4 v43, s[48:51], s75 offen offset:3072  lds
    s_waitcnt vmcnt(38)
    s_mov_b32 m0, 61440
    s_nop 0
    buffer_load_dwordx4 v40, s[48:51], s82 offen  lds
    buffer_load_dwordx4 v41, s[48:51], s82 offen offset:1024  lds
    buffer_load_dwordx4 v42, s[48:51], s82 offen offset:2048  lds
    buffer_load_dwordx4 v43, s[48:51], s82 offen offset:3072  lds
    s_getpc_b64 s[12:13]
    s_cmp_ge_u32 s69, 42
    s_cbranch_scc0 L_lrefresh
    s_xor_b32 s15, s7, 2
    s_lshl_b32 s75, s15, 17
    s_add_u32 s75, s75, 98304
    s_add_u32 s82, s75, 16384
    s_waitcnt vmcnt(38)
    s_mov_b32 m0, 8192
    s_nop 0
    buffer_load_dwordx4 v40, s[48:51], s75 offen  lds
    buffer_load_dwordx4 v41, s[48:51], s75 offen offset:1024  lds
    buffer_load_dwordx4 v42, s[48:51], s75 offen offset:2048  lds
    buffer_load_dwordx4 v43, s[48:51], s75 offen offset:3072  lds
    s_waitcnt vmcnt(38)
    s_mov_b32 m0, 12288
    s_nop 0
    buffer_load_dwordx4 v40, s[48:51], s82 offen  lds
    buffer_load_dwordx4 v41, s[48:51], s82 offen offset:1024  lds
    buffer_load_dwordx4 v42, s[48:51], s82 offen offset:2048  lds
    buffer_load_dwordx4 v43, s[48:51], s82 offen offset:3072  lds
    s_getpc_b64 s[12:13]
    s_cmp_ge_u32 s69, 43
    s_cbranch_scc0 L_lrefresh
    s_xor_b32 s15, s7, 3
    s_lshl_b32 s75, s15, 17
    s_add_u32 s75, s75, 0
    s_add_u32 s82, s75, 16384
    s_waitcnt vmcnt(38)
    s_mov_b32 m0, 65536
    s_nop 0
    buffer_load_dwordx4 v40, s[48:51], s75 offen  lds
    buffer_load_dwordx4 v41, s[48:51], s75 offen offset:1024  lds
    buffer_load_dwordx4 v42, s[48:51], s75 offen offset:2048  lds
    buffer_load_dwordx4 v43, s[48:51], s75 offen offset:3072  lds
    s_waitcnt vmcnt(38)
    s_mov_b32 m0, 69632
    s_nop 0
    buffer_load_dwordx4 v40, s[48:51], s82 offen  lds
    buffer_load_dwordx4 v41, s[48:51], s82 offen offset:1024  lds
    buffer_load_dwordx4 v42, s[48:51], s82 offen offset:2048  lds
    buffer_load_dwordx4 v43, s[48:51], s82 offen offset:3072  lds
    s_getpc_b64 s[12:13]
    s_cmp_ge_u32 s69, 44
    s_cbranch_scc0 L_lrefresh
    s_xor_b32 s15, s7, 3
    s_lshl_b32 s75, s15, 17
    s_add_u32 s75, s75, 32768
    s_add_u32 s82, s75, 16384
    s_waitcnt vmcnt(38)
    s_mov_b32 m0, 131072
    s_nop 0
    buffer_load_dwordx4 v40, s[48:51], s75 offen  lds
    buffer_load_dwordx4 v41, s[48:51], s75 offen offset:1024  lds
    buffer_load_dwordx4 v42, s[48:51], s75 offen offset:2048  lds
    buffer_load_dwordx4 v43, s[48:51], s75 offen offset:3072  lds
    s_waitcnt vmcnt(38)
    s_mov_b32 m0, 135168
    s_nop 0
    buffer_load_dwordx4 v40, s[48:51], s82 offen  lds
    buffer_load_dwordx4 v41, s[48:51], s82 offen offset:1024  lds
    buffer_load_dwordx4 v42, s[48:51], s82 offen offset:2048  lds
    buffer_load_dwordx4 v43, s[48:51], s82 offen offset:3072  lds
    s_getpc_b64 s[12:13]
    s_cmp_ge_u32 s69, 45
    s_cbranch_scc0 L_lrefresh
    s_xor_b32 s15, s7, 3
    s_lshl_b32 s75, s15, 17
    s_add_u32 s75, s75, 65536
    s_add_u32 s82, s75, 16384
    s_waitcnt vmcnt(38)
    s_mov_b32 m0, 139264
    s_nop 0
    buffer_load_dwordx4 v40, s[48:51], s75 offen  lds
    buffer_load_dwordx4 v41, s[48:51], s75 offen offset:1024  lds
    buffer_load_dwordx4 v42, s[48:51], s75 offen offset:2048  lds
    buffer_load_dwordx4 v43, s[48:51], s75 offen offset:3072  lds
    s_waitcnt vmcnt(38)
    s_mov_b32 m0, 143360
    s_nop 0
    buffer_load_dwordx4 v40, s[48:51], s82 offen  lds
    buffer_load_dwordx4 v41, s[48:51], s82 offen offset:1024  lds
    buffer_load_dwordx4 v42, s[48:51], s82 offen offset:2048  lds
    buffer_load_dwordx4 v43, s[48:51], s82 offen offset:3072  lds
    s_getpc_b64 s[12:13]
    s_cmp_ge_u32 s69, 46
    s_cbranch_scc0 L_lrefresh
    s_xor_b32 s15, s7, 3
    s_lshl_b32 s75, s15, 17
    s_add_u32 s75, s75, 98304
    s_add_u32 s82, s75, 16384
    s_waitcnt vmcnt(38)
    s_mov_b32 m0, 147456
    s_nop 0
    buffer_load_dwordx4 v40, s[48:51], s75 offen  lds
    buffer_load_dwordx4 v41, s[48:51], s75 offen offset:1024  lds
    buffer_load_dwordx4 v42, s[48:51], s75 offen offset:2048  lds
    buffer_load_dwordx4 v43, s[48:51], s75 offen offset:3072  lds
    s_waitcnt vmcnt(38)
    s_mov_b32 m0, 151552
    s_nop 0
    buffer_load_dwordx4 v40, s[48:51], s82 offen  lds
    buffer_load_dwordx4 v41, s[48:51], s82 offen offset:1024  lds
    buffer_load_dwordx4 v42, s[48:51], s82 offen offset:2048  lds
    buffer_load_dwordx4 v43, s[48:51], s82 offen offset:3072  lds
    s_mov_b32 m0, 160512
    s_mov_b32 s68, L_table-L_pc+308
    buffer_load_dword off, s[64:67], s68 lds
    s_waitcnt vmcnt(0) lgkmcnt(0)
    s_branch L_fin
L_lpoll:
L_lrefresh:
    ds_read_b32 v30, v24
    s_waitcnt lgkmcnt(0)
    v_readlane_b32 s69, v30, 0
    v_readlane_b32 s9, v30, 1
    v_readlane_b32 s14, v30, 2
    s_min_u32 s69, s69, s9
    s_min_u32 s69, s69, s14
    s_add_u32 s81, s81, 1
    s_and_b32 s100, s81, 0x100000
    s_or_b32 s69, s69, s100
    s_setpc_b64 s[12:13]
L_dwait:
    s_add_u32 s78, s78, s77
L_dwait1:
    s_getreg_b32 s9, hwreg(HW_REG_IB_STS)
    s_lshr_b32 s14, s9, 18
    s_and_b32 s14, s14, 0x30
    s_and_b32 s9, s9, 15
    s_add_u32 s9, s9, s14
    s_cmp_gt_i32 s9, s78
    s_cbranch_scc1 L_dwait1
    s_setpc_b64 s[12:13]
.p2align 6
L_cpoll:
L_crefresh:
    ds_read_b32 v26, v24
    s_add_u32 s81, s81, 1
    s_and_b32 s100, s81, 0x100000
    s_waitcnt lgkmcnt(0)
    v_readfirstlane_b32 s69, v26
    s_nop 0
    s_or_b32 s69, s69, s100
    s_setpc_b64 s[12:13]
L_compute:
    s_lshl_b32 s76, s5, 22
    s_lshl_b32 s9, s3, 14
    s_add_u32 s76, s76, s9
    s_lshl_b32 s9, s6, 19
    s_add_u32 s73, s76, s9
    s_mul_i32 s9, s7, 49152
    s_add_u32 s76, s76, s9
    s_add_u32 s76, s76, 0x40000
    s_add_u32 s77, s3, s5
    s_and_b32 s77, s77, 3
    s_lshl_b32 s77, s77, 8
    s_lshl_b32 s9, s6, 19
    s_add_u32 s72, s76, s9
    s_add_u32 s72, s72, s77
    s_mov_b32 s60, s30
    s_mov_b32 s61, s31
    s_mov_b32 s62, 33554432
    s_mov_b32 s63, 0x20000
    v_and_b32 v8, 7, v1
    v_bfe_u32 v9, v1, 3, 1
    v_lshlrev_b32 v10, 13, v2
    v_lshl_or_b32 v10, v9, 7, v10
    v_lshl_or_b32 v10, v8, 2, v10
    v_mov_b32 v9, 0x111
    v_lshrrev_b32 v9, v3, v9
    v_and_b32 v9, 1, v9
    s_mov_b32 exec_hi, 0
    buffer_store_dword v9, v10, s[60:63], s72 offen sc1
    s_mov_b64 exec, -1
    v_mov_b32 v24, 160512
    s_add_u32 s56, s30, s72
    s_addc_u32 s57, s31, 0
    s_getreg_b32 s82, hwreg(HW_REG_XCC_ID, 2, 1)
    s_add_u32 s9, s6, 24
    s_lshl_b32 s83, s82, s9
    s_cmp_eq_u32 s7, 0
    s_cselect_b32 s83, s83, 0
    s_add_u32 s83, s83, 1
    s_lshr_b32 s75, s6, 2
    s_lshl_b32 s75, s75, 3
    s_add_u32 s75, s75, 8
    s_mul_i32 s9, s5, 69632
    s_add_u32 s9, s9, 33554432
    s_add_u32 s44, s30, s9
    s_addc_u32 s45, s31, 0
    s_lshl_b32 s14, s3, 5
    s_add_u32 s14, s14, s4
    s_mul_i32 s9, s4, 4352
    s_mov_b32 s33, 0
    s_mov_b32 s46, 0
    s_cmp_lt_u32 s14, 16
    s_cbranch_scc0 L_nzr
    s_atomic_swap s33, s[44:45], s9 glc
L_nzr:
    s_add_u32 s9, s8, s6
    s_and_b32 s9, s9, 7
    s_mul_i32 s9, s9, 69632
    s_add_u32 s9, s9, 33554432
    s_add_u32 s44, s30, s9
    s_addc_u32 s45, s31, 0
    s_mul_i32 s9, s5, 3
    s_add_u32 s9, s9, s3
    s_lshl_b32 s9, s9, 15
    s_lshl_b32 s14, s7, 8
    s_lshr_b32 s15, s6, 1
    s_lshl_b32 s15, s15, 6
    s_add_u32 s14, s14, s15
    s_and_b32 s15, s6, 1
    s_lshl_b32 s15, s15, 14
    s_add_u32 s14, s14, s15
    s_add_u32 s9, s9, s14
    s_add_u32 s52, s26, s9
    s_addc_u32 s53, s27, 0
    s_sub_u32 s54, 32768, s14
    s_mov_b32 s55, 0x20000
    s_lshl_b32 s80, s5, 2
    s_mov_b32 s48, s28
    s_mov_b32 s49, s29
    s_mov_b32 s50, 256
    s_mov_b32 s51, 0x20000
    s_lshl_b32 s79, s3, 3
    s_and_b32 s9, s4, 7
    s_add_u32 s79, s79, s9
    s_mov_b32 s10, 0x3e0293ee
    s_mov_b32 s11, 0x49800000
    v_lshlrev_b32 v68, 4, v1
    v_lshrrev_b32 v4, 5, v1
    v_and_b32 v5, 31, v1
    v_xor_b32 v6, v4, v3
    v_lshlrev_b32 v6, 4, v6
    v_lshl_or_b32 v32, v5, 8, v6
    v_xor_b32 v33, 32, v32
    v_xor_b32 v34, 64, v32
    v_xor_b32 v35, 96, v32
    v_xor_b32 v36, 128, v32
    v_xor_b32 v37, 160, v32
    v_xor_b32 v38, 192, v32
    v_xor_b32 v39, 224, v32
    v_add_u32 v40, 65536, v32
    v_add_u32 v41, 65536, v33
    v_add_u32 v42, 65536, v34
    v_add_u32 v43, 65536, v35
    v_add_u32 v44, 65536, v36
    v_add_u32 v45, 65536, v37
    v_add_u32 v46, 65536, v38
    v_add_u32 v47, 65536, v39
    v_add_u32 v48, 131072, v32
    v_add_u32 v49, 131072, v33
    v_add_u32 v50, 131072, v34
    v_add_u32 v51, 131072, v35
    v_add_u32 v52, 131072, v36
    v_add_u32 v53, 131072, v37
    v_add_u32 v54, 131072, v38
    v_add_u32 v55, 131072, v39
    v_and_b32 v6, 1, v2
    v_lshlrev_b32 v6, 1, v6
    v_and_b32 v7, 1, v1
    v_or_b32 v14, v6, v7
    v_and_b32 v7, 12, v3
    v_or_b32 v6, v14, v7
    v_lshlrev_b32 v6, 4, v6
    v_and_b32 v13, 2, v1
    v_lshl_or_b32 v6, v13, 2, v6
    v_lshl_or_b32 v6, v7, 6, v6
    v_lshl_or_b32 v56, v4, 10, v6
    v_xor_b32 v57, 64, v56
    v_xor_b32 v58, 128, v56
    v_xor_b32 v59, 192, v56
    v_add_u32 v60, 65536, v56
    v_add_u32 v61, 65536, v57
    v_add_u32 v62, 65536, v58
    v_add_u32 v63, 65536, v59
    v_add_u32 v64, 131072, v56
    v_add_u32 v65, 131072, v57
    v_add_u32 v66, 131072, v58
    v_add_u32 v67, 131072, v59
    v_lshlrev_b32 v15, 4, v4
    v_and_b32 v14, 1, v2
    v_lshl_or_b32 v15, v14, 5, v15
    v_lshl_or_b32 v70, v3, 10, v15
    v_lshl_or_b32 v7, v4, 11, v6
    s_lshl_b32 s9, s6, 5
    s_and_b32 s9, s9, 0xc0
    v_xor_b32 v69, s9, v7
    v_bfe_u32 v12, v5, 2, 1
    v_lshrrev_b32 v13, 4, v5
    v_xor_b32 v12, v12, v4
    v_or_b32 v12, v12, v13
    v_bfe_u32 v13, v5, 3, 1
    v_bfe_u32 v14, v5, 1, 1
    v_lshl_or_b32 v13, v13, 1, v14
    v_lshl_or_b32 v12, v12, 2, v13
    v_and_b32 v13, 1, v5
    v_lshlrev_b32 v13, 4, v13
    v_mov_b32 v14, 0x3f80
    v_lshlrev_b32 v13, v13, v14
    v_cmp_eq_u32 vcc, 0, v12
    s_nop 1
    v_cndmask_b32 v8, 0, v13, vcc
    v_cmp_eq_u32 vcc, 1, v12
    s_nop 1
    v_cndmask_b32 v9, 0, v13, vcc
    v_cmp_eq_u32 vcc, 2, v12
    s_nop 1
    v_cndmask_b32 v10, 0, v13, vcc
    v_cmp_eq_u32 vcc, 3, v12
    s_nop 1
    v_cndmask_b32 v11, 0, v13, vcc
    v_xor_b32 v12, s6, v1
    v_and_b32 v12, 7, v12
    v_xor_b32 v13, s7, v1
    v_and_b32 v13, 3, v13
    v_mul_u32_u24 v13, 49152, v13
    v_lshl_add_u32 v13, v1, 2, v13
    v_mov_b32 v14, 1
    v_bfe_u32 v6, v5, 1, 3
    v_xor_b32 v6, v6, v4
    v_lshlrev_b32 v6, 4, v6
    v_lshl_or_b32 v6, v5, 7, v6
    s_lshl_b32 s9, s3, 12
    v_add_u32 v6, s9, v6
    v_add_u32 v104, 73728, v7
    v_add_u32 v108, 90112, v6
    v_xor_b32 v105, 64, v104
    v_xor_b32 v109, 32, v108
    v_xor_b32 v106, 128, v104
    v_xor_b32 v110, 64, v108
    v_xor_b32 v107, 192, v104
    v_xor_b32 v111, 96, v108
    v_add_u32 v112, 131072, v7
    v_add_u32 v116, 147456, v6
    v_xor_b32 v113, 64, v112
    v_xor_b32 v117, 32, v116
    v_xor_b32 v114, 128, v112
    v_xor_b32 v118, 64, v116
    v_xor_b32 v115, 192, v112
    v_xor_b32 v119, 96, v116
    v_mov_b32 v29, 0
    s_waitcnt vmcnt(0) lgkmcnt(0)
    s_getpc_b64 s[12:13]
    s_cmp_ge_u32 s69, 1
    s_cbranch_scc0 L_crefresh
    ds_read_b128 v[176:179], v108 offset:0
    ds_read_b64_tr_b16 v[128:129], v104 offset:0
    ds_read_b64_tr_b16 v[130:131], v104 offset:1024
    ds_read_b64_tr_b16 v[132:133], v105 offset:0
    ds_read_b64_tr_b16 v[134:135], v105 offset:1024
    ds_read_b64_tr_b16 v[136:137], v106 offset:0
    ds_read_b64_tr_b16 v[138:139], v106 offset:1024
    ds_read_b64_tr_b16 v[140:141], v107 offset:0
    ds_read_b64_tr_b16 v[142:143], v107 offset:1024
    ds_read_b32 v71, v24
    ds_read_b128 v[180:183], v109 offset:0
    ds_read_b64_tr_b16 v[144:145], v104 offset:4096
    ds_read_b64_tr_b16 v[146:147], v104 offset:5120
    ds_read_b64_tr_b16 v[148:149], v105 offset:4096
    ds_read_b64_tr_b16 v[150:151], v105 offset:5120
    ds_read_b64_tr_b16 v[152:153], v106 offset:4096
    ds_read_b64_tr_b16 v[154:155], v106 offset:5120
    ds_read_b64_tr_b16 v[156:157], v107 offset:4096
    ds_read_b64_tr_b16 v[158:159], v107 offset:5120
    s_waitcnt lgkmcnt(9)
    v_readfirstlane_b32 s69, v71
    v_mfma_f32_32x32x16_bf16 v[192:207], v[128:131], v[176:179], 0
    s_getpc_b64 s[12:13]
    s_cmp_ge_u32 s69, 2
    s_cbranch_scc0 L_crefresh
    ds_read_b128 v[184:187], v110 offset:0
    ds_read_b64_tr_b16 v[160:161], v104 offset:8192
    v_mfma_f32_32x32x16_bf16 v[208:223], v[132:135], v[176:179], 0
    ds_read_b64_tr_b16 v[162:163], v104 offset:9216
    ds_read_b64_tr_b16 v[164:165], v105 offset:8192
    ds_read_b64_tr_b16 v[166:167], v105 offset:9216
    v_mfma_f32_32x32x16_bf16 v[224:239], v[136:139], v[176:179], 0
    ds_read_b64_tr_b16 v[168:169], v106 offset:8192
    ds_read_b64_tr_b16 v[170:171], v106 offset:9216
    ds_read_b64_tr_b16 v[172:173], v107 offset:8192
    v_mfma_f32_32x32x16_bf16 v[240:255], v[140:143], v[176:179], 0
    ds_read_b64_tr_b16 v[174:175], v107 offset:9216
    s_waitcnt lgkmcnt(9)
    v_mfma_f32_32x32x16_bf16 v[192:207], v[144:147], v[180:183], v[192:207]
    ds_read_b32 v71, v24
    ds_read_b128 v[176:179], v111 offset:0
    ds_read_b64_tr_b16 v[128:129], v104 offset:12288
    v_mfma_f32_32x32x16_bf16 v[208:223], v[148:151], v[180:183], v[208:223]
    ds_read_b64_tr_b16 v[130:131], v104 offset:13312
    ds_read_b64_tr_b16 v[132:133], v105 offset:12288
    ds_read_b64_tr_b16 v[134:135], v105 offset:13312
    ds_read_b64_tr_b16 v[136:137], v106 offset:12288
    v_mfma_f32_32x32x16_bf16 v[224:239], v[152:155], v[180:183], v[224:239]
    ds_read_b64_tr_b16 v[138:139], v106 offset:13312
    ds_read_b64_tr_b16 v[140:141], v107 offset:12288
    ds_read_b64_tr_b16 v[142:143], v107 offset:13312
    v_mov_b32 v31, 1
    v_mfma_f32_32x32x16_bf16 v[240:255], v[156:159], v[180:183], v[240:255]
    ds_write_b32 v25, v31
    s_waitcnt lgkmcnt(10)
    v_readfirstlane_b32 s69, v71
    v_mfma_f32_32x32x16_bf16 v[192:207], v[160:163], v[184:187], v[192:207]
    s_getpc_b64 s[12:13]
    s_cmp_ge_u32 s69, 3
    s_cbranch_scc0 L_crefresh
    ds_read_b128 v[180:183], v108 offset:28672
    ds_read_b64_tr_b16 v[144:145], v104 offset:28672
    v_mfma_f32_32x32x16_bf16 v[208:223], v[164:167], v[184:187], v[208:223]
    ds_read_b64_tr_b16 v[146:147], v104 offset:29696
    ds_read_b64_tr_b16 v[148:149], v105 offset:28672
    ds_read_b64_tr_b16 v[150:151], v105 offset:29696
    v_mfma_f32_32x32x16_bf16 v[224:239], v[168:171], v[184:187], v[224:239]
    ds_read_b64_tr_b16 v[152:153], v106 offset:28672
    ds_read_b64_tr_b16 v[154:155], v106 offset:29696
    ds_read_b64_tr_b16 v[156:157], v107 offset:28672
    v_mfma_f32_32x32x16_bf16 v[240:255], v[172:175], v[184:187], v[240:255]
    ds_read_b64_tr_b16 v[158:159], v107 offset:29696
    s_waitcnt lgkmcnt(10)
    v_mfma_f32_32x32x16_bf16 v[192:207], v[128:131], v[176:179], v[192:207]
    ds_read_b32 v71, v24
    ds_read_b128 v[184:187], v109 offset:28672
    v_mfma_f32_32x32x16_bf16 v[208:223], v[132:135], v[176:179], v[208:223]
    ds_read_b64_tr_b16 v[160:161], v104 offset:32768
    ds_read_b64_tr_b16 v[162:163], v104 offset:33792
    ds_read_b64_tr_b16 v[164:165], v105 offset:32768
    v_mfma_f32_32x32x16_bf16 v[224:239], v[136:139], v[176:179], v[224:239]
    ds_read_b64_tr_b16 v[166:167], v105 offset:33792
    ds_read_b64_tr_b16 v[168:169], v106 offset:32768
    ds_read_b64_tr_b16 v[170:171], v106 offset:33792
    v_mfma_f32_32x32x16_bf16 v[240:255], v[140:143], v[176:179], v[240:255]
    ds_read_b64_tr_b16 v[172:173], v107 offset:32768
    ds_read_b64_tr_b16 v[174:175], v107 offset:33792
    s_waitcnt lgkmcnt(9)
    v_readfirstlane_b32 s69, v71
    v_mfma_f32_32x32x16_bf16 v[192:207], v[144:147], v[180:183], v[192:207]
    s_getpc_b64 s[12:13]
    s_cmp_ge_u32 s69, 4
    s_cbranch_scc0 L_crefresh
    ds_read_b128 v[176:179], v110 offset:28672
    ds_read_b64_tr_b16 v[128:129], v104 offset:36864
    v_mfma_f32_32x32x16_bf16 v[208:223], v[148:151], v[180:183], v[208:223]
    ds_read_b64_tr_b16 v[130:131], v104 offset:37888
    ds_read_b64_tr_b16 v[132:133], v105 offset:36864
    ds_read_b64_tr_b16 v[134:135], v105 offset:37888
    v_mfma_f32_32x32x16_bf16 v[224:239], v[152:155], v[180:183], v[224:239]
    ds_read_b64_tr_b16 v[136:137], v106 offset:36864
    ds_read_b64_tr_b16 v[138:139], v106 offset:37888
    ds_read_b64_tr_b16 v[140:141], v107 offset:36864
    v_mfma_f32_32x32x16_bf16 v[240:255], v[156:159], v[180:183], v[240:255]
    ds_read_b64_tr_b16 v[142:143], v107 offset:37888
    s_waitcnt lgkmcnt(9)
    v_mfma_f32_32x32x16_bf16 v[192:207], v[160:163], v[184:187], v[192:207]
    ds_read_b32 v71, v24
    ds_read_b128 v[180:183], v111 offset:28672
    ds_read_b64_tr_b16 v[144:145], v104 offset:40960
    v_mfma_f32_32x32x16_bf16 v[208:223], v[164:167], v[184:187], v[208:223]
    ds_read_b64_tr_b16 v[146:147], v104 offset:41984
    ds_read_b64_tr_b16 v[148:149], v105 offset:40960
    ds_read_b64_tr_b16 v[150:151], v105 offset:41984
    ds_read_b64_tr_b16 v[152:153], v106 offset:40960
    v_mfma_f32_32x32x16_bf16 v[224:239], v[168:171], v[184:187], v[224:239]
    ds_read_b64_tr_b16 v[154:155], v106 offset:41984
    ds_read_b64_tr_b16 v[156:157], v107 offset:40960
    ds_read_b64_tr_b16 v[158:159], v107 offset:41984
    v_mov_b32 v31, 2
    v_mfma_f32_32x32x16_bf16 v[240:255], v[172:175], v[184:187], v[240:255]
    ds_write_b32 v25, v31
    s_waitcnt lgkmcnt(10)
    v_readfirstlane_b32 s69, v71
    v_mfma_f32_32x32x16_bf16 v[192:207], v[128:131], v[176:179], v[192:207]
    s_getpc_b64 s[12:13]
    s_cmp_ge_u32 s69, 5
    s_cbranch_scc0 L_crefresh
    ds_read_b128 v[184:187], v116 offset:0
    ds_read_b64_tr_b16 v[160:161], v112 offset:0
    ds_read_b64_tr_b16 v[162:163], v112 offset:1024
    v_mfma_f32_32x32x16_bf16 v[208:223], v[132:135], v[176:179], v[208:223]
    ds_read_b64_tr_b16 v[164:165], v113 offset:0
    ds_read_b64_tr_b16 v[166:167], v113 offset:1024
    ds_read_b64_tr_b16 v[168:169], v114 offset:0
    ds_read_b64_tr_b16 v[170:171], v114 offset:1024
    v_mfma_f32_32x32x16_bf16 v[224:239], v[136:139], v[176:179], v[224:239]
    ds_read_b64_tr_b16 v[172:173], v115 offset:0
    ds_read_b64_tr_b16 v[174:175], v115 offset:1024
    ds_read_b128 a[64:67], v32 offset:0
    v_mfma_f32_32x32x16_bf16 v[240:255], v[140:143], v[176:179], v[240:255]
    ds_read_b128 a[68:71], v33 offset:0
    ds_read_b128 a[72:75], v34 offset:0
    ds_read_b128 a[76:79], v35 offset:0
    s_waitcnt lgkmcnt(14)
    v_mfma_f32_32x32x16_bf16 v[192:207], v[144:147], v[180:183], v[192:207]
    ds_read_b32 v71, v24
    ds_read_b128 v[176:179], v117 offset:0
    ds_read_b64_tr_b16 v[128:129], v112 offset:4096
    v_mfma_f32_32x32x16_bf16 v[208:223], v[148:151], v[180:183], v[208:223]
    ds_read_b64_tr_b16 v[130:131], v112 offset:5120
    ds_read_b64_tr_b16 v[132:133], v113 offset:4096
    ds_read_b64_tr_b16 v[134:135], v113 offset:5120
    ds_read_b64_tr_b16 v[136:137], v114 offset:4096
    v_mfma_f32_32x32x16_bf16 v[224:239], v[152:155], v[180:183], v[224:239]
    ds_read_b64_tr_b16 v[138:139], v114 offset:5120
    ds_read_b64_tr_b16 v[140:141], v115 offset:4096
    ds_read_b64_tr_b16 v[142:143], v115 offset:5120
    ds_read_b128 a[80:83], v36 offset:0
    v_mfma_f32_32x32x16_bf16 v[240:255], v[156:159], v[180:183], v[240:255]
    ds_read_b128 a[84:87], v37 offset:0
    ds_read_b128 a[88:91], v38 offset:0
    ds_read_b128 a[92:95], v39 offset:0
    s_waitcnt lgkmcnt(13)
    v_readfirstlane_b32 s69, v71
    v_mfma_f32_32x32x16_bf16 v[192:207], v[160:163], v[184:187], v[192:207]
    s_getpc_b64 s[12:13]
    s_cmp_ge_u32 s69, 6
    s_cbranch_scc0 L_crefresh
    ds_read_b128 v[180:183], v118 offset:0
    ds_read_b64_tr_b16 v[144:145], v112 offset:8192
    ds_read_b64_tr_b16 v[146:147], v112 offset:9216
    v_mfma_f32_32x32x16_bf16 v[208:223], v[164:167], v[184:187], v[208:223]
    ds_read_b64_tr_b16 v[148:149], v113 offset:8192
    ds_read_b64_tr_b16 v[150:151], v113 offset:9216
    ds_read_b64_tr_b16 v[152:153], v114 offset:8192
    ds_read_b64_tr_b16 v[154:155], v114 offset:9216
    v_mfma_f32_32x32x16_bf16 v[224:239], v[168:171], v[184:187], v[224:239]
    ds_read_b64_tr_b16 v[156:157], v115 offset:8192
    ds_read_b64_tr_b16 v[158:159], v115 offset:9216
    ds_read_b128 a[96:99], v32 offset:8192
    v_mfma_f32_32x32x16_bf16 v[240:255], v[172:175], v[184:187], v[240:255]
    ds_read_b128 a[100:103], v33 offset:8192
    ds_read_b128 a[104:107], v34 offset:8192
    ds_read_b128 a[108:111], v35 offset:8192
    s_waitcnt lgkmcnt(15)
    v_mfma_f32_32x32x16_bf16 v[192:207], v[128:131], v[176:179], v[192:207]
    ds_read_b32 v71, v24
    ds_read_b128 v[184:187], v119 offset:0
    ds_read_b64_tr_b16 v[160:161], v112 offset:12288
    ds_read_b64_tr_b16 v[162:163], v112 offset:13312
    v_mfma_f32_32x32x16_bf16 v[208:223], v[132:135], v[176:179], v[208:223]
    ds_read_b64_tr_b16 v[164:165], v113 offset:12288
    ds_read_b64_tr_b16 v[166:167], v113 offset:13312
    ds_read_b64_tr_b16 v[168:169], v114 offset:12288
    ds_read_b64_tr_b16 v[170:171], v114 offset:13312
    ds_read_b64_tr_b16 v[172:173], v115 offset:12288
    v_mfma_f32_32x32x16_bf16 v[224:239], v[136:139], v[176:179], v[224:239]
    ds_read_b64_tr_b16 v[174:175], v115 offset:13312
    ds_read_b128 a[112:115], v36 offset:8192
    ds_read_b128 a[116:119], v37 offset:8192
    ds_read_b128 a[120:123], v38 offset:8192
    ds_read_b128 a[124:127], v39 offset:8192
    v_mfma_f32_32x32x16_bf16 v[240:255], v[140:143], v[176:179], v[240:255]
    v_mov_b32 v31, 3
    ds_write_b32 v25, v31
    s_waitcnt lgkmcnt(14)
    v_readfirstlane_b32 s69, v71
    v_mfma_f32_32x32x16_bf16 v[192:207], v[144:147], v[180:183], v[192:207]
    s_getpc_b64 s[12:13]
    s_cmp_ge_u32 s69, 7
    s_cbranch_scc0 L_crefresh
    ds_read_b128 v[176:179], v108 offset:0
    ds_read_b64_tr_b16 v[128:129], v104 offset:0
    ds_read_b64_tr_b16 v[130:131], v104 offset:1024
    v_mfma_f32_32x32x16_bf16 v[208:223], v[148:151], v[180:183], v[208:223]
    ds_read_b64_tr_b16 v[132:133], v105 offset:0
    ds_read_b64_tr_b16 v[134:135], v105 offset:1024
    ds_read_b64_tr_b16 v[136:137], v106 offset:0
    ds_read_b64_tr_b16 v[138:139], v106 offset:1024
    v_mfma_f32_32x32x16_bf16 v[224:239], v[152:155], v[180:183], v[224:239]
    ds_read_b64_tr_b16 v[140:141], v107 offset:0
    ds_read_b64_tr_b16 v[142:143], v107 offset:1024
    ds_read_b128 a[128:131], v32 offset:16384
    v_mfma_f32_32x32x16_bf16 v[240:255], v[156:159], v[180:183], v[240:255]
    ds_read_b128 a[132:135], v33 offset:16384
    ds_read_b128 a[136:139], v34 offset:16384
    ds_read_b128 a[140:143], v35 offset:16384
    s_waitcnt lgkmcnt(15)
    v_mfma_f32_32x32x16_bf16 v[192:207], v[160:163], v[184:187], v[192:207]
    ds_read_b32 v71, v24
    ds_read_b128 v[180:183], v109 offset:0
    ds_read_b64_tr_b16 v[144:145], v104 offset:4096
    v_mfma_f32_32x32x16_bf16 v[208:223], v[164:167], v[184:187], v[208:223]
    ds_read_b64_tr_b16 v[146:147], v104 offset:5120
    ds_read_b64_tr_b16 v[148:149], v105 offset:4096
    ds_read_b64_tr_b16 v[150:151], v105 offset:5120
    ds_read_b64_tr_b16 v[152:153], v106 offset:4096
    v_mfma_f32_32x32x16_bf16 v[224:239], v[168:171], v[184:187], v[224:239]
    ds_read_b64_tr_b16 v[154:155], v106 offset:5120
    ds_read_b64_tr_b16 v[156:157], v107 offset:4096
    ds_read_b64_tr_b16 v[158:159], v107 offset:5120
    ds_read_b128 a[144:147], v36 offset:16384
    v_mfma_f32_32x32x16_bf16 v[240:255], v[172:175], v[184:187], v[240:255]
    ds_read_b128 a[148:151], v37 offset:16384
    ds_read_b128 a[152:155], v38 offset:16384
    ds_read_b128 a[156:159], v39 offset:16384
    s_waitcnt lgkmcnt(13)
    v_readfirstlane_b32 s69, v71
    v_mfma_f32_32x32x16_bf16 v[192:207], v[128:131], v[176:179], v[192:207]
    s_getpc_b64 s[12:13]
    s_cmp_ge_u32 s69, 8
    s_cbranch_scc0 L_crefresh
    ds_read_b128 v[184:187], v110 offset:0
    ds_read_b64_tr_b16 v[160:161], v104 offset:8192
    v_mfma_f32_32x32x16_bf16 v[208:223], v[132:135], v[176:179], v[208:223]
    ds_read_b64_tr_b16 v[162:163], v104 offset:9216
    ds_read_b64_tr_b16 v[164:165], v105 offset:8192
    ds_read_b64_tr_b16 v[166:167], v105 offset:9216
    v_mfma_f32_32x32x16_bf16 v[224:239], v[136:139], v[176:179], v[224:239]
    ds_read_b64_tr_b16 v[168:169], v106 offset:8192
    ds_read_b64_tr_b16 v[170:171], v106 offset:9216
    ds_read_b64_tr_b16 v[172:173], v107 offset:8192
    v_mfma_f32_32x32x16_bf16 v[240:255], v[140:143], v[176:179], v[240:255]
    ds_read_b64_tr_b16 v[174:175], v107 offset:9216
    s_waitcnt lgkmcnt(13)
    v_mfma_f32_32x32x16_bf16 v[192:207], v[144:147], v[180:183], v[192:207]
    ds_read_b32 v71, v24
    ds_read_b128 v[176:179], v111 offset:0
    ds_read_b64_tr_b16 v[128:129], v104 offset:12288
    v_mfma_f32_32x32x16_bf16 v[208:223], v[148:151], v[180:183], v[208:223]
    ds_read_b64_tr_b16 v[130:131], v104 offset:13312
    ds_read_b64_tr_b16 v[132:133], v105 offset:12288
    ds_read_b64_tr_b16 v[134:135], v105 offset:13312
    ds_read_b64_tr_b16 v[136:137], v106 offset:12288
    v_mfma_f32_32x32x16_bf16 v[224:239], v[152:155], v[180:183], v[224:239]
    ds_read_b64_tr_b16 v[138:139], v106 offset:13312
    ds_read_b64_tr_b16 v[140:141], v107 offset:12288
    ds_read_b64_tr_b16 v[142:143], v107 offset:13312
    v_mov_b32 v31, 4
    v_mfma_f32_32x32x16_bf16 v[240:255], v[156:159], v[180:183], v[240:255]
    ds_write_b32 v25, v31
    s_waitcnt lgkmcnt(10)
    v_readfirstlane_b32 s69, v71
    v_mfma_f32_32x32x16_bf16 v[192:207], v[160:163], v[184:187], v[192:207]
    s_getpc_b64 s[12:13]
    s_cmp_ge_u32 s69, 9
    s_cbranch_scc0 L_crefresh
    ds_read_b128 v[180:183], v108 offset:28672
    ds_read_b64_tr_b16 v[144:145], v104 offset:28672
    ds_read_b64_tr_b16 v[146:147], v104 offset:29696
    v_mfma_f32_32x32x16_bf16 v[208:223], v[164:167], v[184:187], v[208:223]
    ds_read_b64_tr_b16 v[148:149], v105 offset:28672
    ds_read_b64_tr_b16 v[150:151], v105 offset:29696
    ds_read_b64_tr_b16 v[152:153], v106 offset:28672
    ds_read_b64_tr_b16 v[154:155], v106 offset:29696
    v_mfma_f32_32x32x16_bf16 v[224:239], v[168:171], v[184:187], v[224:239]
    ds_read_b64_tr_b16 v[156:157], v107 offset:28672
    ds_read_b64_tr_b16 v[158:159], v107 offset:29696
    ds_read_b128 a[160:163], v32 offset:24576
    v_mfma_f32_32x32x16_bf16 v[240:255], v[172:175], v[184:187], v[240:255]
    ds_read_b128 a[164:167], v33 offset:24576
    ds_read_b128 a[168:171], v34 offset:24576
    ds_read_b128 a[172:175], v35 offset:24576
    s_waitcnt lgkmcnt(14)
    v_mfma_f32_32x32x16_bf16 v[192:207], v[128:131], v[176:179], v[192:207]
    ds_read_b32 v71, v24
    ds_read_b128 v[184:187], v109 offset:28672
    ds_read_b64_tr_b16 v[160:161], v104 offset:32768
    v_mfma_f32_32x32x16_bf16 v[208:223], v[132:135], v[176:179], v[208:223]
    ds_read_b64_tr_b16 v[162:163], v104 offset:33792
    ds_read_b64_tr_b16 v[164:165], v105 offset:32768
    ds_read_b64_tr_b16 v[166:167], v105 offset:33792
    ds_read_b64_tr_b16 v[168:169], v106 offset:32768
    v_mfma_f32_32x32x16_bf16 v[224:239], v[136:139], v[176:179], v[224:239]
    ds_read_b64_tr_b16 v[170:171], v106 offset:33792
    ds_read_b64_tr_b16 v[172:173], v107 offset:32768
    ds_read_b64_tr_b16 v[174:175], v107 offset:33792
    ds_read_b128 a[176:179], v36 offset:24576
    v_mfma_f32_32x32x16_bf16 v[240:255], v[140:143], v[176:179], v[240:255]
    ds_read_b128 a[180:183], v37 offset:24576
    ds_read_b128 a[184:187], v38 offset:24576
    ds_read_b128 a[188:191], v39 offset:24576
    s_waitcnt lgkmcnt(13)
    v_readfirstlane_b32 s69, v71
    v_mfma_f32_32x32x16_bf16 v[192:207], v[144:147], v[180:183], v[192:207]
    s_getpc_b64 s[12:13]
    s_cmp_ge_u32 s69, 10
    s_cbranch_scc0 L_crefresh
    ds_read_b128 v[176:179], v110 offset:28672
    ds_read_b64_tr_b16 v[128:129], v104 offset:36864
    v_mfma_f32_32x32x16_bf16 v[208:223], v[148:151], v[180:183], v[208:223]
    ds_read_b64_tr_b16 v[130:131], v104 offset:37888
    ds_read_b64_tr_b16 v[132:133], v105 offset:36864
    ds_read_b64_tr_b16 v[134:135], v105 offset:37888
    v_mfma_f32_32x32x16_bf16 v[224:239], v[152:155], v[180:183], v[224:239]
    ds_read_b64_tr_b16 v[136:137], v106 offset:36864
    ds_read_b64_tr_b16 v[138:139], v106 offset:37888
    ds_read_b64_tr_b16 v[140:141], v107 offset:36864
    v_mfma_f32_32x32x16_bf16 v[240:255], v[156:159], v[180:183], v[240:255]
    ds_read_b64_tr_b16 v[142:143], v107 offset:37888
    s_waitcnt lgkmcnt(13)
    v_mfma_f32_32x32x16_bf16 v[192:207], v[160:163], v[184:187], v[192:207]
    ds_read_b32 v71, v24
    ds_read_b128 v[180:183], v111 offset:28672
    ds_read_b64_tr_b16 v[144:145], v104 offset:40960
    v_mfma_f32_32x32x16_bf16 v[208:223], v[164:167], v[184:187], v[208:223]
    ds_read_b64_tr_b16 v[146:147], v104 offset:41984
    ds_read_b64_tr_b16 v[148:149], v105 offset:40960
    ds_read_b64_tr_b16 v[150:151], v105 offset:41984
    ds_read_b64_tr_b16 v[152:153], v106 offset:40960
    v_mfma_f32_32x32x16_bf16 v[224:239], v[168:171], v[184:187], v[224:239]
    ds_read_b64_tr_b16 v[154:155], v106 offset:41984
    ds_read_b64_tr_b16 v[156:157], v107 offset:40960
    ds_read_b64_tr_b16 v[158:159], v107 offset:41984
    v_mov_b32 v31, 5
    v_mfma_f32_32x32x16_bf16 v[240:255], v[172:175], v[184:187], v[240:255]
    ds_write_b32 v25, v31
    s_waitcnt lgkmcnt(10)
    v_readfirstlane_b32 s69, v71
    v_mfma_f32_32x32x16_bf16 v[192:207], v[128:131], v[176:179], v[192:207]
    s_getpc_b64 s[12:13]
    s_cmp_ge_u32 s69, 11
    s_cbranch_scc0 L_crefresh
    ds_read_b128 v[184:187], v116 offset:0
    ds_read_b64_tr_b16 v[160:161], v112 offset:0
    v_mfma_f32_32x32x16_bf16 v[208:223], v[132:135], v[176:179], v[208:223]
    ds_read_b64_tr_b16 v[162:163], v112 offset:1024
    ds_read_b64_tr_b16 v[164:165], v113 offset:0
    ds_read_b64_tr_b16 v[166:167], v113 offset:1024
    v_mfma_f32_32x32x16_bf16 v[224:239], v[136:139], v[176:179], v[224:239]
    ds_read_b64_tr_b16 v[168:169], v114 offset:0
    ds_read_b64_tr_b16 v[170:171], v114 offset:1024
    ds_read_b64_tr_b16 v[172:173], v115 offset:0
    v_mfma_f32_32x32x16_bf16 v[240:255], v[140:143], v[176:179], v[240:255]
    ds_read_b64_tr_b16 v[174:175], v115 offset:1024
    s_waitcnt lgkmcnt(10)
    v_mfma_f32_32x32x16_bf16 v[192:207], v[144:147], v[180:183], v[192:207]
    ds_read_b32 v71, v24
    ds_read_b128 v[176:179], v117 offset:0
    v_mfma_f32_32x32x16_bf16 v[208:223], v[148:151], v[180:183], v[208:223]
    ds_read_b64_tr_b16 v[128:129], v112 offset:4096
    ds_read_b64_tr_b16 v[130:131], v112 offset:5120
    ds_read_b64_tr_b16 v[132:133], v113 offset:4096
    v_mfma_f32_32x32x16_bf16 v[224:239], v[152:155], v[180:183], v[224:239]
    ds_read_b64_tr_b16 v[134:135], v113 offset:5120
    ds_read_b64_tr_b16 v[136:137], v114 offset:4096
    ds_read_b64_tr_b16 v[138:139], v114 offset:5120
    v_mfma_f32_32x32x16_bf16 v[240:255], v[156:159], v[180:183], v[240:255]
    ds_read_b64_tr_b16 v[140:141], v115 offset:4096
    ds_read_b64_tr_b16 v[142:143], v115 offset:5120
    s_waitcnt lgkmcnt(9)
    v_readfirstlane_b32 s69, v71
    v_mfma_f32_32x32x16_bf16 v[192:207], v[160:163], v[184:187], v[192:207]
    s_getpc_b64 s[12:13]
    s_cmp_ge_u32 s69, 12
    s_cbranch_scc0 L_crefresh
    ds_read_b128 v[180:183], v118 offset:0
    ds_read_b64_tr_b16 v[144:145], v112 offset:8192
    v_mfma_f32_32x32x16_bf16 v[208:223], v[164:167], v[184:187], v[208:223]
    ds_read_b64_tr_b16 v[146:147], v112 offset:9216
    ds_read_b64_tr_b16 v[148:149], v113 offset:8192
    ds_read_b64_tr_b16 v[150:151], v113 offset:9216
    v_mfma_f32_32x32x16_bf16 v[224:239], v[168:171], v[184:187], v[224:239]
    ds_read_b64_tr_b16 v[152:153], v114 offset:8192
    ds_read_b64_tr_b16 v[154:155], v114 offset:9216
    ds_read_b64_tr_b16 v[156:157], v115 offset:8192
    v_mfma_f32_32x32x16_bf16 v[240:255], v[172:175], v[184:187], v[240:255]
    ds_read_b64_tr_b16 v[158:159], v115 offset:9216
    s_waitcnt lgkmcnt(9)
    v_mfma_f32_32x32x16_bf16 v[192:207], v[128:131], v[176:179], v[192:207]
    ds_read_b32 v71, v24
    ds_read_b128 v[184:187], v119 offset:0
    ds_read_b64_tr_b16 v[160:161], v112 offset:12288
    v_mfma_f32_32x32x16_bf16 v[208:223], v[132:135], v[176:179], v[208:223]
    ds_read_b64_tr_b16 v[162:163], v112 offset:13312
    ds_read_b64_tr_b16 v[164:165], v113 offset:12288
    ds_read_b64_tr_b16 v[166:167], v113 offset:13312
    ds_read_b64_tr_b16 v[168:169], v114 offset:12288
    v_mfma_f32_32x32x16_bf16 v[224:239], v[136:139], v[176:179], v[224:239]
    ds_read_b64_tr_b16 v[170:171], v114 offset:13312
    ds_read_b64_tr_b16 v[172:173], v115 offset:12288
    ds_read_b64_tr_b16 v[174:175], v115 offset:13312
    v_mov_b32 v31, 6
    v_mfma_f32_32x32x16_bf16 v[240:255], v[140:143], v[176:179], v[240:255]
    ds_write_b32 v25, v31
    s_waitcnt lgkmcnt(10)
    v_readfirstlane_b32 s69, v71
    v_mfma_f32_32x32x16_bf16 v[192:207], v[144:147], v[180:183], v[192:207]
    s_getpc_b64 s[12:13]
    s_cmp_ge_u32 s69, 13
    s_cbranch_scc0 L_crefresh
    ds_read_b128 v[176:179], v108 offset:0
    ds_read_b64_tr_b16 v[128:129], v104 offset:0
    v_mfma_f32_32x32x16_bf16 v[208:223], v[148:151], v[180:183], v[208:223]
    ds_read_b64_tr_b16 v[130:131], v104 offset:1024
    ds_read_b64_tr_b16 v[132:133], v105 offset:0
    ds_read_b64_tr_b16 v[134:135], v105 offset:1024
    v_mfma_f32_32x32x16_bf16 v[224:239], v[152:155], v[180:183], v[224:239]
    ds_read_b64_tr_b16 v[136:137], v106 offset:0
    ds_read_b64_tr_b16 v[138:139], v106 offset:1024
    ds_read_b64_tr_b16 v[140:141], v107 offset:0
    v_mfma_f32_32x32x16_bf16 v[240:255], v[156:159], v[180:183], v[240:255]
    ds_read_b64_tr_b16 v[142:143], v107 offset:1024
    s_waitcnt lgkmcnt(10)
    v_mfma_f32_32x32x16_bf16 v[192:207], v[160:163], v[184:187], v[192:207]
    ds_read_b32 v71, v24
    ds_read_b128 v[180:183], v109 offset:0
    v_mfma_f32_32x32x16_bf16 v[208:223], v[164:167], v[184:187], v[208:223]
    ds_read_b64_tr_b16 v[144:145], v104 offset:4096
    ds_read_b64_tr_b16 v[146:147], v104 offset:5120
    ds_read_b64_tr_b16 v[148:149], v105 offset:4096
    v_mfma_f32_32x32x16_bf16 v[224:239], v[168:171], v[184:187], v[224:239]
    ds_read_b64_tr_b16 v[150:151], v105 offset:5120
    ds_read_b64_tr_b16 v[152:153], v106 offset:4096
    ds_read_b64_tr_b16 v[154:155], v106 offset:5120
    v_mfma_f32_32x32x16_bf16 v[240:255], v[172:175], v[184:187], v[240:255]
    ds_read_b64_tr_b16 v[156:157], v107 offset:4096
    ds_read_b64_tr_b16 v[158:159], v107 offset:5120
    s_waitcnt lgkmcnt(9)
    v_readfirstlane_b32 s69, v71
    v_mfma_f32_32x32x16_bf16 v[192:207], v[128:131], v[176:179], v[192:207]
    s_getpc_b64 s[12:13]
    s_cmp_ge_u32 s69, 14
    s_cbranch_scc0 L_crefresh
    ds_read_b128 v[184:187], v110 offset:0
    ds_read_b64_tr_b16 v[160:161], v104 offset:8192
    v_mfma_f32_32x32x16_bf16 v[208:223], v[132:135], v[176:179], v[208:223]
    ds_read_b64_tr_b16 v[162:163], v104 offset:9216
    ds_read_b64_tr_b16 v[164:165], v105 offset:8192
    ds_read_b64_tr_b16 v[166:167], v105 offset:9216
    v_mfma_f32_32x32x16_bf16 v[224:239], v[136:139], v[176:179], v[224:239]
    ds_read_b64_tr_b16 v[168:169], v106 offset:8192
    ds_read_b64_tr_b16 v[170:171], v106 offset:9216
    ds_read_b64_tr_b16 v[172:173], v107 offset:8192
    v_mfma_f32_32x32x16_bf16 v[240:255], v[140:143], v[176:179], v[240:255]
    ds_read_b64_tr_b16 v[174:175], v107 offset:9216
    s_waitcnt lgkmcnt(9)
    v_mfma_f32_32x32x16_bf16 v[192:207], v[144:147], v[180:183], v[192:207]
    ds_read_b32 v71, v24
    ds_read_b128 v[176:179], v111 offset:0
    ds_read_b64_tr_b16 v[128:129], v104 offset:12288
    v_mfma_f32_32x32x16_bf16 v[208:223], v[148:151], v[180:183], v[208:223]
    ds_read_b64_tr_b16 v[130:131], v104 offset:13312
    ds_read_b64_tr_b16 v[132:133], v105 offset:12288
    ds_read_b64_tr_b16 v[134:135], v105 offset:13312
    ds_read_b64_tr_b16 v[136:137], v106 offset:12288
    v_mfma_f32_32x32x16_bf16 v[224:239], v[152:155], v[180:183], v[224:239]
    ds_read_b64_tr_b16 v[138:139], v106 offset:13312
    ds_read_b64_tr_b16 v[140:141], v107 offset:12288
    ds_read_b64_tr_b16 v[142:143], v107 offset:13312
    v_mov_b32 v31, 7
    v_mfma_f32_32x32x16_bf16 v[240:255], v[156:159], v[180:183], v[240:255]
    ds_write_b32 v25, v31
    s_waitcnt lgkmcnt(10)
    v_readfirstlane_b32 s69, v71
    v_mfma_f32_32x32x16_bf16 v[192:207], v[160:163], v[184:187], v[192:207]
    s_getpc_b64 s[12:13]
    s_cmp_ge_u32 s69, 15
    s_cbranch_scc0 L_crefresh
    ds_read_b128 v[180:183], v108 offset:28672
    ds_read_b64_tr_b16 v[144:145], v104 offset:28672
    v_mfma_f32_32x32x16_bf16 v[208:223], v[164:167], v[184:187], v[208:223]
    ds_read_b64_tr_b16 v[146:147], v104 offset:29696
    ds_read_b64_tr_b16 v[148:149], v105 offset:28672
    ds_read_b64_tr_b16 v[150:151], v105 offset:29696
    v_mfma_f32_32x32x16_bf16 v[224:239], v[168:171], v[184:187], v[224:239]
    ds_read_b64_tr_b16 v[152:153], v106 offset:28672
    ds_read_b64_tr_b16 v[154:155], v106 offset:29696
    ds_read_b64_tr_b16 v[156:157], v107 offset:28672
    v_mfma_f32_32x32x16_bf16 v[240:255], v[172:175], v[184:187], v[240:255]
    ds_read_b64_tr_b16 v[158:159], v107 offset:29696
    s_waitcnt lgkmcnt(10)
    v_mfma_f32_32x32x16_bf16 v[192:207], v[128:131], v[176:179], v[192:207]
    ds_read_b32 v71, v24
    ds_read_b128 v[184:187], v109 offset:28672
    v_mfma_f32_32x32x16_bf16 v[208:223], v[132:135], v[176:179], v[208:223]
    ds_read_b64_tr_b16 v[160:161], v104 offset:32768
    ds_read_b64_tr_b16 v[162:163], v104 offset:33792
    ds_read_b64_tr_b16 v[164:165], v105 offset:32768
    v_mfma_f32_32x32x16_bf16 v[224:239], v[136:139], v[176:179], v[224:239]
    ds_read_b64_tr_b16 v[166:167], v105 offset:33792
    ds_read_b64_tr_b16 v[168:169], v106 offset:32768
    ds_read_b64_tr_b16 v[170:171], v106 offset:33792
    v_mfma_f32_32x32x16_bf16 v[240:255], v[140:143], v[176:179], v[240:255]
    ds_read_b64_tr_b16 v[172:173], v107 offset:32768
    ds_read_b64_tr_b16 v[174:175], v107 offset:33792
    s_waitcnt lgkmcnt(9)
    v_readfirstlane_b32 s69, v71
    v_mfma_f32_32x32x16_bf16 v[192:207], v[144:147], v[180:183], v[192:207]
    s_getpc_b64 s[12:13]
    s_cmp_ge_u32 s69, 16
    s_cbranch_scc0 L_crefresh
    ds_read_b128 v[176:179], v110 offset:28672
    ds_read_b64_tr_b16 v[128:129], v104 offset:36864
    v_mfma_f32_32x32x16_bf16 v[208:223], v[148:151], v[180:183], v[208:223]
    ds_read_b64_tr_b16 v[130:131], v104 offset:37888
    ds_read_b64_tr_b16 v[132:133], v105 offset:36864
    ds_read_b64_tr_b16 v[134:135], v105 offset:37888
    v_mfma_f32_32x32x16_bf16 v[224:239], v[152:155], v[180:183], v[224:239]
    ds_read_b64_tr_b16 v[136:137], v106 offset:36864
    ds_read_b64_tr_b16 v[138:139], v106 offset:37888
    ds_read_b64_tr_b16 v[140:141], v107 offset:36864
    v_mfma_f32_32x32x16_bf16 v[240:255], v[156:159], v[180:183], v[240:255]
    ds_read_b64_tr_b16 v[142:143], v107 offset:37888
    s_waitcnt lgkmcnt(9)
    v_mfma_f32_32x32x16_bf16 v[192:207], v[160:163], v[184:187], v[192:207]
    ds_read_b128 v[180:183], v111 offset:28672
    ds_read_b64_tr_b16 v[144:145], v104 offset:40960
    v_mfma_f32_32x32x16_bf16 v[208:223], v[164:167], v[184:187], v[208:223]
    ds_read_b64_tr_b16 v[146:147], v104 offset:41984
    ds_read_b64_tr_b16 v[148:149], v105 offset:40960
    ds_read_b64_tr_b16 v[150:151], v105 offset:41984
    v_mfma_f32_32x32x16_bf16 v[224:239], v[168:171], v[184:187], v[224:239]
    ds_read_b64_tr_b16 v[152:153], v106 offset:40960
    ds_read_b64_tr_b16 v[154:155], v106 offset:41984
    ds_read_b64_tr_b16 v[156:157], v107 offset:40960
    v_mfma_f32_32x32x16_bf16 v[240:255], v[172:175], v[184:187], v[240:255]
    ds_read_b64_tr_b16 v[158:159], v107 offset:41984
    v_mov_b32 v31, 8
    ds_write_b32 v25, v31
    s_waitcnt lgkmcnt(10)
    v_mfma_f32_32x32x16_bf16 v[192:207], v[128:131], v[176:179], v[192:207]
    v_mfma_f32_32x32x16_bf16 v[208:223], v[132:135], v[176:179], v[208:223]
    v_mfma_f32_32x32x16_bf16 v[224:239], v[136:139], v[176:179], v[224:239]
    v_mfma_f32_32x32x16_bf16 v[240:255], v[140:143], v[176:179], v[240:255]
    s_waitcnt lgkmcnt(1)
    v_mfma_f32_32x32x16_bf16 v[192:207], v[144:147], v[180:183], v[192:207]
    v_mfma_f32_32x32x16_bf16 v[208:223], v[148:151], v[180:183], v[208:223]
    v_mfma_f32_32x32x16_bf16 v[224:239], v[152:155], v[180:183], v[224:239]
    v_mfma_f32_32x32x16_bf16 v[240:255], v[156:159], v[180:183], v[240:255]
    s_nop 8
    v_mul_f32 v192, s10, v192
    v_mul_f32 v193, s10, v193
    v_mul_f32 v194, s10, v194
    v_mul_f32 v195, s10, v195
    v_mul_f32 v196, s10, v196
    v_mul_f32 v197, s10, v197
    v_mul_f32 v198, s10, v198
    v_mul_f32 v199, s10, v199
    v_cvt_pk_bf16_f32 v96, v192, v193
    v_cvt_pk_bf16_f32 v97, v194, v195
    v_cvt_pk_bf16_f32 v98, v196, v197
    v_cvt_pk_bf16_f32 v99, v198, v199
    v_mul_f32 v200, s10, v200
    v_mul_f32 v201, s10, v201
    v_mul_f32 v202, s10, v202
    v_mul_f32 v203, s10, v203
    v_mul_f32 v204, s10, v204
    v_mul_f32 v205, s10, v205
    v_mul_f32 v206, s10, v206
    v_mul_f32 v207, s10, v207
    v_cvt_pk_bf16_f32 v100, v200, v201
    v_cvt_pk_bf16_f32 v101, v202, v203
    v_cvt_pk_bf16_f32 v102, v204, v205
    v_cvt_pk_bf16_f32 v103, v206, v207
    v_mul_f32 v208, s10, v208
    v_mul_f32 v209, s10, v209
    v_mul_f32 v210, s10, v210
    v_mul_f32 v211, s10, v211
    v_mul_f32 v212, s10, v212
    v_mul_f32 v213, s10, v213
    v_mul_f32 v214, s10, v214
    v_mul_f32 v215, s10, v215
    v_cvt_pk_bf16_f32 v104, v208, v209
    v_cvt_pk_bf16_f32 v105, v210, v211
    v_cvt_pk_bf16_f32 v106, v212, v213
    v_cvt_pk_bf16_f32 v107, v214, v215
    v_mul_f32 v216, s10, v216
    v_mul_f32 v217, s10, v217
    v_mul_f32 v218, s10, v218
    v_mul_f32 v219, s10, v219
    v_mul_f32 v220, s10, v220
    v_mul_f32 v221, s10, v221
    v_mul_f32 v222, s10, v222
    v_mul_f32 v223, s10, v223
    v_cvt_pk_bf16_f32 v108, v216, v217
    v_cvt_pk_bf16_f32 v109, v218, v219
    v_cvt_pk_bf16_f32 v110, v220, v221
    v_cvt_pk_bf16_f32 v111, v222, v223
    v_mul_f32 v224, s10, v224
    v_mul_f32 v225, s10, v225
    v_mul_f32 v226, s10, v226
    v_mul_f32 v227, s10, v227
    v_mul_f32 v228, s10, v228
    v_mul_f32 v229, s10, v229
    v_mul_f32 v230, s10, v230
    v_mul_f32 v231, s10, v231
    v_cvt_pk_bf16_f32 v112, v224, v225
    v_cvt_pk_bf16_f32 v113, v226, v227
    v_cvt_pk_bf16_f32 v114, v228, v229
    v_cvt_pk_bf16_f32 v115, v230, v231
    v_mul_f32 v232, s10, v232
    v_mul_f32 v233, s10, v233
    v_mul_f32 v234, s10, v234
    v_mul_f32 v235, s10, v235
    v_mul_f32 v236, s10, v236
    v_mul_f32 v237, s10, v237
    v_mul_f32 v238, s10, v238
    v_mul_f32 v239, s10, v239
    v_cvt_pk_bf16_f32 v116, v232, v233
    v_cvt_pk_bf16_f32 v117, v234, v235
    v_cvt_pk_bf16_f32 v118, v236, v237
    v_cvt_pk_bf16_f32 v119, v238, v239
    v_mul_f32 v240, s10, v240
    v_mul_f32 v241, s10, v241
    v_mul_f32 v242, s10, v242
    v_mul_f32 v243, s10, v243
    v_mul_f32 v244, s10, v244
    v_mul_f32 v245, s10, v245
    v_mul_f32 v246, s10, v246
    v_mul_f32 v247, s10, v247
    v_cvt_pk_bf16_f32 v120, v240, v241
    v_cvt_pk_bf16_f32 v121, v242, v243
    v_cvt_pk_bf16_f32 v122, v244, v245
    v_cvt_pk_bf16_f32 v123, v246, v247
    v_mul_f32 v248, s10, v248
    v_mul_f32 v249, s10, v249
    v_mul_f32 v250, s10, v250
    v_mul_f32 v251, s10, v251
    v_mul_f32 v252, s10, v252
    v_mul_f32 v253, s10, v253
    v_mul_f32 v254, s10, v254
    v_mul_f32 v255, s10, v255
    v_cvt_pk_bf16_f32 v124, v248, v249
    v_cvt_pk_bf16_f32 v125, v250, v251
    v_cvt_pk_bf16_f32 v126, v252, v253
    v_cvt_pk_bf16_f32 v127, v254, v255
    v_mfma_f32_32x32x16_bf16 v[192:207], a[64:67], v[96:99], 0
    v_mfma_f32_32x32x16_bf16 v[192:207], a[68:71], v[100:103], v[192:207]
    v_mfma_f32_32x32x16_bf16 v[192:207], a[72:75], v[104:107], v[192:207]
    v_mfma_f32_32x32x16_bf16 v[192:207], a[76:79], v[108:111], v[192:207]
    v_mfma_f32_32x32x16_bf16 v[192:207], a[80:83], v[112:115], v[192:207]
    v_mfma_f32_32x32x16_bf16 v[192:207], a[84:87], v[116:119], v[192:207]
    v_mfma_f32_32x32x16_bf16 v[192:207], a[88:91], v[120:123], v[192:207]
    v_mfma_f32_32x32x16_bf16 v[192:207], a[92:95], v[124:127], v[192:207]
    s_nop 11
    v_max3_f32 v30, v192, v193, v194
    v_max3_f32 v30, v30, v195, v196
    v_max3_f32 v30, v30, v197, v198
    v_max3_f32 v30, v30, v199, v200
    v_max3_f32 v30, v30, v201, v202
    v_max3_f32 v30, v30, v203, v204
    v_max3_f32 v30, v30, v205, v206
    v_max_f32 v30, v30, v207
    v_mov_b32 v31, v30
    s_nop 1
    v_permlane32_swap_b32 v30, v31
    v_max_f32 v30, v30, v31
    v_sub_f32 v80, 0, v30
    v_sub_f32 v81, 0, v30
    v_sub_f32 v82, 0, v30
    v_sub_f32 v83, 0, v30
    v_sub_f32 v84, 0, v30
    v_sub_f32 v85, 0, v30
    v_sub_f32 v86, 0, v30
    v_sub_f32 v87, 0, v30
    v_sub_f32 v88, 0, v30
    v_sub_f32 v89, 0, v30
    v_sub_f32 v90, 0, v30
    v_sub_f32 v91, 0, v30
    v_sub_f32 v92, 0, v30
    v_sub_f32 v93, 0, v30
    v_sub_f32 v94, 0, v30
    v_sub_f32 v95, 0, v30
    s_nop 1
    v_mfma_f32_32x32x16_bf16 v[208:223], a[96:99], v[96:99], v[80:95]
    v_sub_f32 v192, v192, v30
    v_sub_f32 v193, v193, v30
    v_sub_f32 v194, v194, v30
    v_sub_f32 v195, v195, v30
    v_sub_f32 v196, v196, v30
    v_sub_f32 v197, v197, v30
    v_mfma_f32_32x32x16_bf16 v[208:223], a[100:103], v[100:103], v[208:223]
    v_sub_f32 v198, v198, v30
    v_sub_f32 v199, v199, v30
    v_sub_f32 v200, v200, v30
    v_sub_f32 v201, v201, v30
    v_sub_f32 v202, v202, v30
    v_sub_f32 v203, v203, v30
    v_mfma_f32_32x32x16_bf16 v[208:223], a[104:107], v[104:107], v[208:223]
    v_sub_f32 v204, v204, v30
    v_sub_f32 v205, v205, v30
    v_sub_f32 v206, v206, v30
    v_sub_f32 v207, v207, v30
    v_exp_f32 v72, v192
    v_mfma_f32_32x32x16_bf16 v[208:223], a[108:111], v[108:111], v[208:223]
    v_exp_f32 v73, v193
    v_exp_f32 v74, v194
    v_exp_f32 v75, v195
    v_mfma_f32_32x32x16_bf16 v[208:223], a[112:115], v[112:115], v[208:223]
    v_cvt_pk_bf16_f32 v128, v72, v73
    v_exp_f32 v76, v196
    v_add_f32 v27, v72, v74
    v_exp_f32 v77, v197
    v_mfma_f32_32x32x16_bf16 v[208:223], a[116:119], v[116:119], v[208:223]
    v_add_f32 v28, v73, v75
    v_cvt_pk_bf16_f32 v129, v74, v75
    v_exp_f32 v78, v198
    v_add_f32 v27, v27, v76
    v_mfma_f32_32x32x16_bf16 v[208:223], a[120:123], v[120:123], v[208:223]
    v_exp_f32 v79, v199
    v_add_f32 v28, v28, v77
    v_cvt_pk_bf16_f32 v130, v76, v77
    v_exp_f32 v72, v200
    v_mfma_f32_32x32x16_bf16 v[208:223], a[124:127], v[124:127], v[208:223]
    v_add_f32 v27, v27, v78
    v_exp_f32 v73, v201
    v_add_f32 v28, v28, v79
    v_cvt_pk_bf16_f32 v131, v78, v79
    v_mfma_f32_32x32x16_bf16 v[224:239], a[128:131], v[96:99], v[80:95]
    v_exp_f32 v74, v202
    v_add_f32 v27, v27, v72
    v_exp_f32 v75, v203
    v_add_f32 v28, v28, v73
    v_mfma_f32_32x32x16_bf16 v[224:239], a[132:135], v[100:103], v[224:239]
    v_cvt_pk_bf16_f32 v132, v72, v73
    v_exp_f32 v76, v204
    v_add_f32 v27, v27, v74
    v_exp_f32 v77, v205
    v_mfma_f32_32x32x16_bf16 v[224:239], a[136:139], v[104:107], v[224:239]
    v_add_f32 v28, v28, v75
    v_cvt_pk_bf16_f32 v133, v74, v75
    v_exp_f32 v78, v206
    v_add_f32 v27, v27, v76
    v_mfma_f32_32x32x16_bf16 v[224:239], a[140:143], v[108:111], v[224:239]
    v_exp_f32 v79, v207
    v_add_f32 v28, v28, v77
    v_cvt_pk_bf16_f32 v134, v76, v77
    v_exp_f32 v72, v208
    v_mfma_f32_32x32x16_bf16 v[224:239], a[144:147], v[112:115], v[224:239]
    v_add_f32 v27, v27, v78
    v_exp_f32 v73, v209
    v_add_f32 v28, v28, v79
    v_cvt_pk_bf16_f32 v135, v78, v79
    v_mfma_f32_32x32x16_bf16 v[224:239], a[148:151], v[116:119], v[224:239]
    v_exp_f32 v74, v210
    v_add_f32 v27, v27, v72
    v_exp_f32 v75, v211
    v_add_f32 v28, v28, v73
    v_mfma_f32_32x32x16_bf16 v[224:239], a[152:155], v[120:123], v[224:239]
    v_cvt_pk_bf16_f32 v136, v72, v73
    v_exp_f32 v76, v212
    v_add_f32 v27, v27, v74
    v_exp_f32 v77, v213
    v_mfma_f32_32x32x16_bf16 v[224:239], a[156:159], v[124:127], v[224:239]
    v_add_f32 v28, v28, v75
    v_cvt_pk_bf16_f32 v137, v74, v75
    v_exp_f32 v78, v214
    v_add_f32 v27, v27, v76
    v_mfma_f32_32x32x16_bf16 v[240:255], a[160:163], v[96:99], v[80:95]
    v_exp_f32 v79, v215
    v_add_f32 v28, v28, v77
    v_cvt_pk_bf16_f32 v138, v76, v77
    v_exp_f32 v72, v216
    v_mfma_f32_32x32x16_bf16 v[240:255], a[164:167], v[100:103], v[240:255]
    v_add_f32 v27, v27, v78
    v_exp_f32 v73, v217
    v_add_f32 v28, v28, v79
    v_cvt_pk_bf16_f32 v139, v78, v79
    v_mfma_f32_32x32x16_bf16 v[240:255], a[168:171], v[104:107], v[240:255]
    v_exp_f32 v74, v218
    v_add_f32 v27, v27, v72
    v_exp_f32 v75, v219
    v_add_f32 v28, v28, v73
    v_mfma_f32_32x32x16_bf16 v[240:255], a[172:175], v[108:111], v[240:255]
    v_cvt_pk_bf16_f32 v140, v72, v73
    v_exp_f32 v76, v220
    v_add_f32 v27, v27, v74
    v_exp_f32 v77, v221
    v_mfma_f32_32x32x16_bf16 v[240:255], a[176:179], v[112:115], v[240:255]
    v_add_f32 v28, v28, v75
    v_cvt_pk_bf16_f32 v141, v74, v75
    v_exp_f32 v78, v222
    v_add_f32 v27, v27, v76
    v_mfma_f32_32x32x16_bf16 v[240:255], a[180:183], v[116:119], v[240:255]
    v_exp_f32 v79, v223
    v_add_f32 v28, v28, v77
    v_cvt_pk_bf16_f32 v142, v76, v77
    v_mfma_f32_32x32x16_bf16 v[240:255], a[184:187], v[120:123], v[240:255]
    v_mfma_f32_32x32x16_bf16 v[240:255], a[188:191], v[124:127], v[240:255]
    v_exp_f32 v72, v224
    v_add_f32 v27, v27, v78
    v_exp_f32 v73, v225
    v_add_f32 v28, v28, v79
    v_cvt_pk_bf16_f32 v143, v78, v79
    v_exp_f32 v74, v226
    v_add_f32 v27, v27, v72
    v_exp_f32 v75, v227
    v_add_f32 v28, v28, v73
    v_cvt_pk_bf16_f32 v144, v72, v73
    v_exp_f32 v76, v228
    v_add_f32 v27, v27, v74
    v_exp_f32 v77, v229
    v_add_f32 v28, v28, v75
    v_cvt_pk_bf16_f32 v145, v74, v75
    v_exp_f32 v78, v230
    v_add_f32 v27, v27, v76
    v_exp_f32 v79, v231
    v_add_f32 v28, v28, v77
    v_cvt_pk_bf16_f32 v146, v76, v77
    v_exp_f32 v72, v232
    v_add_f32 v27, v27, v78
    v_exp_f32 v73, v233
    v_add_f32 v28, v28, v79
    v_cvt_pk_bf16_f32 v147, v78, v79
    v_exp_f32 v74, v234
    v_add_f32 v27, v27, v72
    v_exp_f32 v75, v235
    v_add_f32 v28, v28, v73
    v_cvt_pk_bf16_f32 v148, v72, v73
    v_exp_f32 v76, v236
    v_add_f32 v27, v27, v74
    v_exp_f32 v77, v237
    v_add_f32 v28, v28, v75
    v_cvt_pk_bf16_f32 v149, v74, v75
    v_exp_f32 v78, v238
    v_add_f32 v27, v27, v76
    v_exp_f32 v79, v239
    v_add_f32 v28, v28, v77
    v_cvt_pk_bf16_f32 v150, v76, v77
    s_getpc_b64 s[12:13]
    s_cmp_ge_u32 s69, 17
    s_cbranch_scc0 L_crefresh
    ds_read_b128 a[64:67], v32 offset:32768
    ds_read_b128 a[68:71], v33 offset:32768
    ds_read_b128 a[72:75], v34 offset:32768
    ds_read_b128 a[76:79], v35 offset:32768
    ds_read_b128 a[80:83], v36 offset:32768
    ds_read_b128 a[84:87], v37 offset:32768
    ds_read_b128 a[88:91], v38 offset:32768
    ds_read_b128 a[92:95], v39 offset:32768
    v_exp_f32 v72, v240
    v_add_f32 v27, v27, v78
    v_exp_f32 v73, v241
    v_add_f32 v28, v28, v79
    v_cvt_pk_bf16_f32 v151, v78, v79
    v_exp_f32 v74, v242
    v_add_f32 v27, v27, v72
    v_exp_f32 v75, v243
    v_add_f32 v28, v28, v73
    v_cvt_pk_bf16_f32 v152, v72, v73
    v_exp_f32 v76, v244
    v_add_f32 v27, v27, v74
    v_exp_f32 v77, v245
    v_add_f32 v28, v28, v75
    v_cvt_pk_bf16_f32 v153, v74, v75
    v_exp_f32 v78, v246
    v_add_f32 v27, v27, v76
    v_exp_f32 v79, v247
    v_add_f32 v28, v28, v77
    v_cvt_pk_bf16_f32 v154, v76, v77
    v_exp_f32 v72, v248
    v_add_f32 v27, v27, v78
    v_exp_f32 v73, v249
    v_add_f32 v28, v28, v79
    v_cvt_pk_bf16_f32 v155, v78, v79
    v_exp_f32 v74, v250
    v_add_f32 v27, v27, v72
    v_exp_f32 v75, v251
    v_add_f32 v28, v28, v73
    v_cvt_pk_bf16_f32 v156, v72, v73
    v_exp_f32 v76, v252
    v_add_f32 v27, v27, v74
    v_exp_f32 v77, v253
    v_add_f32 v28, v28, v75
    v_cvt_pk_bf16_f32 v157, v74, v75
    v_exp_f32 v78, v254
    v_add_f32 v27, v27, v76
    v_exp_f32 v79, v255
    v_add_f32 v28, v28, v77
    v_cvt_pk_bf16_f32 v158, v76, v77
    v_add_f32 v27, v27, v78
    v_add_f32 v28, v28, v79
    v_cvt_pk_bf16_f32 v159, v78, v79
    v_add_f32 v27, v27, v28
    v_cmp_lt_f32 vcc, s11, v27
    s_cbranch_vccnz L_rs0
L_skip0:
    v_add_f32 v29, v29, v27
    s_waitcnt lgkmcnt(4)
    v_mfma_f32_32x32x16_bf16 v[192:207], a[64:67], v[96:99], v[80:95]
    s_getpc_b64 s[12:13]
    s_cmp_ge_u32 s69, 18
    s_cbranch_scc0 L_crefresh
    ds_read_b128 a[96:99], v32 offset:40960
    v_mfma_f32_32x32x16_bf16 v[192:207], a[68:71], v[100:103], v[192:207]
    ds_read_b128 a[100:103], v33 offset:40960
    ds_read_b128 a[104:107], v34 offset:40960
    v_mfma_f32_32x32x16_bf16 v[192:207], a[72:75], v[104:107], v[192:207]
    ds_read_b128 a[108:111], v35 offset:40960
    ds_read_b128 a[112:115], v36 offset:40960
    v_mfma_f32_32x32x16_bf16 v[192:207], a[76:79], v[108:111], v[192:207]
    ds_read_b128 a[116:119], v37 offset:40960
    ds_read_b128 a[120:123], v38 offset:40960
    s_waitcnt lgkmcnt(7)
    v_mfma_f32_32x32x16_bf16 v[192:207], a[80:83], v[112:115], v[192:207]
    ds_read_b128 a[124:127], v39 offset:40960
    v_mov_b32 v31, 10
    v_mfma_f32_32x32x16_bf16 v[192:207], a[84:87], v[116:119], v[192:207]
    ds_write_b32 v25, v31
    v_mfma_f32_32x32x16_bf16 v[192:207], a[88:91], v[120:123], v[192:207]
    v_mfma_f32_32x32x16_bf16 v[192:207], a[92:95], v[124:127], v[192:207]
    s_waitcnt lgkmcnt(5)
    v_mfma_f32_32x32x16_bf16 v[208:223], a[96:99], v[96:99], v[80:95]
    s_getpc_b64 s[12:13]
    s_cmp_ge_u32 s69, 19
    s_cbranch_scc0 L_crefresh
    ds_read_b128 a[128:131], v32 offset:49152
    v_mfma_f32_32x32x16_bf16 v[208:223], a[100:103], v[100:103], v[208:223]
    ds_read_b128 a[132:135], v33 offset:49152
    v_mfma_f32_32x32x16_bf16 v[208:223], a[104:107], v[104:107], v[208:223]
    ds_read_b128 a[136:139], v34 offset:49152
    ds_read_b128 a[140:143], v35 offset:49152
    s_nop 0
    v_exp_f32 v72, v192
    v_exp_f32 v73, v193
    v_mfma_f32_32x32x16_bf16 v[208:223], a[108:111], v[108:111], v[208:223]
    ds_read_b128 a[144:147], v36 offset:49152
    v_exp_f32 v74, v194
    v_exp_f32 v75, v195
    v_cvt_pk_bf16_f32 v160, v72, v73
    s_waitcnt lgkmcnt(6)
    v_mfma_f32_32x32x16_bf16 v[208:223], a[112:115], v[112:115], v[208:223]
    ds_read_b128 a[148:151], v37 offset:49152
    ds_read_b128 a[152:155], v38 offset:49152
    v_exp_f32 v76, v196
    v_add_f32 v27, v72, v74
    v_exp_f32 v77, v197
    v_mfma_f32_32x32x16_bf16 v[208:223], a[116:119], v[116:119], v[208:223]
    ds_read_b128 a[156:159], v39 offset:49152
    v_add_f32 v28, v73, v75
    v_cvt_pk_bf16_f32 v161, v74, v75
    v_exp_f32 v78, v198
    v_add_f32 v27, v27, v76
    v_mfma_f32_32x32x16_bf16 v[208:223], a[120:123], v[120:123], v[208:223]
    v_exp_f32 v79, v199
    v_add_f32 v28, v28, v77
    v_cvt_pk_bf16_f32 v162, v76, v77
    v_exp_f32 v72, v200
    v_add_f32 v27, v27, v78
    v_mfma_f32_32x32x16_bf16 v[208:223], a[124:127], v[124:127], v[208:223]
    v_exp_f32 v73, v201
    v_add_f32 v28, v28, v79
    v_cvt_pk_bf16_f32 v163, v78, v79
    v_exp_f32 v74, v202
    v_add_f32 v27, v27, v72
    s_waitcnt lgkmcnt(4)
    v_mfma_f32_32x32x16_bf16 v[224:239], a[128:131], v[96:99], v[80:95]
    s_getpc_b64 s[12:13]
    s_cmp_ge_u32 s69, 20
    s_cbranch_scc0 L_crefresh
    ds_read_b128 a[160:163], v32 offset:57344
    v_exp_f32 v75, v203
    v_add_f32 v28, v28, v73
    v_cvt_pk_bf16_f32 v164, v72, v73
    v_mfma_f32_32x32x16_bf16 v[224:239], a[132:135], v[100:103], v[224:239]
    ds_read_b128 a[164:167], v33 offset:57344
    ds_read_b128 a[168:171], v34 offset:57344
    v_exp_f32 v76, v204
    v_add_f32 v27, v27, v74
    v_exp_f32 v77, v205
    v_mfma_f32_32x32x16_bf16 v[224:239], a[136:139], v[104:107], v[224:239]
    ds_read_b128 a[172:175], v35 offset:57344
    ds_read_b128 a[176:179], v36 offset:57344
    v_add_f32 v28, v28, v75
    v_cvt_pk_bf16_f32 v165, v74, v75
    v_exp_f32 v78, v206
    v_add_f32 v27, v27, v76
    v_mfma_f32_32x32x16_bf16 v[224:239], a[140:143], v[108:111], v[224:239]
    ds_read_b128 a[180:183], v37 offset:57344
    ds_read_b128 a[184:187], v38 offset:57344
    v_exp_f32 v79, v207
    v_add_f32 v28, v28, v77
    v_cvt_pk_bf16_f32 v166, v76, v77
    s_waitcnt lgkmcnt(7)
    v_mfma_f32_32x32x16_bf16 v[224:239], a[144:147], v[112:115], v[224:239]
    ds_read_b128 a[188:191], v39 offset:57344
    v_mov_b32 v31, 11
    v_exp_f32 v72, v208
    v_add_f32 v27, v27, v78
    v_exp_f32 v73, v209
    v_mfma_f32_32x32x16_bf16 v[224:239], a[148:151], v[116:119], v[224:239]
    ds_write_b32 v25, v31
    v_add_f32 v28, v28, v79
    v_cvt_pk_bf16_f32 v167, v78, v79
    v_exp_f32 v74, v210
    v_add_f32 v27, v27, v72
    v_mfma_f32_32x32x16_bf16 v[224:239], a[152:155], v[120:123], v[224:239]
    v_exp_f32 v75, v211
    v_add_f32 v28, v28, v73
    v_cvt_pk_bf16_f32 v168, v72, v73
    v_exp_f32 v76, v212
    v_add_f32 v27, v27, v74
    v_mfma_f32_32x32x16_bf16 v[224:239], a[156:159], v[124:127], v[224:239]
    v_exp_f32 v77, v213
    v_add_f32 v28, v28, v75
    v_cvt_pk_bf16_f32 v169, v74, v75
    v_exp_f32 v78, v214
    v_add_f32 v27, v27, v76
    s_waitcnt lgkmcnt(5)
    v_mfma_f32_32x32x16_bf16 v[240:255], a[160:163], v[96:99], v[80:95]
    s_cmp_eq_u32 s79, 0
    s_cbranch_scc1 L_as0
L_na0:
    s_getpc_b64 s[12:13]
    s_cmp_ge_u32 s69, 21
    s_cbranch_scc0 L_crefresh
    ds_read_b64_tr_b16 a[192:193], v60 offset:0
    v_exp_f32 v79, v215
    v_mfma_f32_32x32x16_bf16 v[240:255], a[164:167], v[100:103], v[240:255]
    ds_read_b64_tr_b16 a[194:195], v60 offset:2048
    ds_read_b64_tr_b16 a[196:197], v60 offset:4096
    ds_read_b64_tr_b16 a[198:199], v60 offset:6144
    v_add_f32 v28, v28, v77
    v_cvt_pk_bf16_f32 v170, v76, v77
    v_exp_f32 v72, v216
    v_mfma_f32_32x32x16_bf16 v[240:255], a[168:171], v[104:107], v[240:255]
    ds_read_b64_tr_b16 a[200:201], v61 offset:0
    ds_read_b64_tr_b16 a[202:203], v61 offset:2048
    ds_read_b64_tr_b16 a[204:205], v61 offset:4096
    v_add_f32 v27, v27, v78
    v_exp_f32 v73, v217
    v_add_f32 v28, v28, v79
    v_mfma_f32_32x32x16_bf16 v[240:255], a[172:175], v[108:111], v[240:255]
    ds_read_b64_tr_b16 a[206:207], v61 offset:6144
    ds_read_b64_tr_b16 a[208:209], v62 offset:0
    ds_read_b64_tr_b16 a[210:211], v62 offset:2048
    v_cvt_pk_bf16_f32 v171, v78, v79
    v_exp_f32 v74, v218
    v_add_f32 v27, v27, v72
    s_waitcnt lgkmcnt(11)
    v_mfma_f32_32x32x16_bf16 v[240:255], a[176:179], v[112:115], v[240:255]
    ds_read_b64_tr_b16 a[212:213], v62 offset:4096
    ds_read_b64_tr_b16 a[214:215], v62 offset:6144
    ds_read_b64_tr_b16 a[216:217], v63 offset:0
    v_exp_f32 v75, v219
    v_add_f32 v28, v28, v73
    v_cvt_pk_bf16_f32 v172, v72, v73
    v_mfma_f32_32x32x16_bf16 v[240:255], a[180:183], v[116:119], v[240:255]
    ds_read_b64_tr_b16 a[218:219], v63 offset:2048
    ds_read_b64_tr_b16 a[220:221], v63 offset:4096
    ds_read_b64_tr_b16 a[222:223], v63 offset:6144
    v_exp_f32 v76, v220
    v_add_f32 v27, v27, v74
    v_mfma_f32_32x32x16_bf16 v[240:255], a[184:187], v[120:123], v[240:255]
    v_exp_f32 v77, v221
    v_add_f32 v28, v28, v75
    v_cvt_pk_bf16_f32 v173, v74, v75
    v_exp_f32 v78, v222
    v_add_f32 v27, v27, v76
    v_mfma_f32_32x32x16_bf16 v[240:255], a[188:191], v[124:127], v[240:255]
    v_exp_f32 v79, v223
    v_add_f32 v28, v28, v77
    v_cvt_pk_bf16_f32 v174, v76, v77
    v_exp_f32 v72, v224
    v_add_f32 v27, v27, v78
    s_waitcnt lgkmcnt(0)
    v_mfma_f32_32x32x16_bf16 a[0:15], a[192:195], v[128:131], 0
    s_getpc_b64 s[12:13]
    s_cmp_ge_u32 s69, 22
    s_cbranch_scc0 L_crefresh
    ds_read_b64_tr_b16 a[224:225], v56 offset:0
    ds_read_b64_tr_b16 a[226:227], v56 offset:2048
    ds_read_b64_tr_b16 a[228:229], v56 offset:4096
    v_exp_f32 v73, v225
    v_mfma_f32_32x32x16_bf16 a[16:31], a[200:203], v[128:131], 0
    ds_read_b64_tr_b16 a[230:231], v56 offset:6144
    ds_read_b64_tr_b16 a[232:233], v57 offset:0
    ds_read_b64_tr_b16 a[234:235], v57 offset:2048
    v_add_f32 v28, v28, v79
    v_cvt_pk_bf16_f32 v175, v78, v79
    v_exp_f32 v74, v226
    v_mfma_f32_32x32x16_bf16 a[32:47], a[208:211], v[128:131], 0
    ds_read_b64_tr_b16 a[236:237], v57 offset:4096
    ds_read_b64_tr_b16 a[238:239], v57 offset:6144
    ds_read_b64_tr_b16 a[240:241], v58 offset:0
    v_add_f32 v27, v27, v72
    v_exp_f32 v75, v227
    v_add_f32 v28, v28, v73
    v_mfma_f32_32x32x16_bf16 a[48:63], a[216:219], v[128:131], 0
    ds_read_b64_tr_b16 a[242:243], v58 offset:2048
    ds_read_b64_tr_b16 a[244:245], v58 offset:4096
    ds_read_b64_tr_b16 a[246:247], v58 offset:6144
    v_cvt_pk_bf16_f32 v176, v72, v73
    v_exp_f32 v76, v228
    v_add_f32 v27, v27, v74
    v_mfma_f32_32x32x16_bf16 a[0:15], a[196:199], v[132:135], a[0:15]
    ds_read_b64_tr_b16 a[248:249], v59 offset:0
    ds_read_b64_tr_b16 a[250:251], v59 offset:2048
    ds_read_b64_tr_b16 a[252:253], v59 offset:4096
    v_exp_f32 v77, v229
    v_add_f32 v28, v28, v75
    v_cvt_pk_bf16_f32 v177, v74, v75
    v_mfma_f32_32x32x16_bf16 a[16:31], a[204:207], v[132:135], a[16:31]
    ds_read_b64_tr_b16 a[254:255], v59 offset:6144
    v_mov_b32 v31, 12
    ds_write_b32 v25, v31
    v_exp_f32 v78, v230
    v_add_f32 v27, v27, v76
    v_mfma_f32_32x32x16_bf16 a[32:47], a[212:215], v[132:135], a[32:47]
    v_exp_f32 v79, v231
    v_add_f32 v28, v28, v77
    v_cvt_pk_bf16_f32 v178, v76, v77
    v_exp_f32 v72, v232
    v_add_f32 v27, v27, v78
    v_mfma_f32_32x32x16_bf16 a[48:63], a[220:223], v[132:135], a[48:63]
    v_exp_f32 v73, v233
    v_add_f32 v28, v28, v79
    v_cvt_pk_bf16_f32 v179, v78, v79
    v_exp_f32 v74, v234
    v_add_f32 v27, v27, v72
    s_waitcnt lgkmcnt(1)
    v_mfma_f32_32x32x16_bf16 a[0:15], a[224:227], v[136:139], a[0:15]
    s_getpc_b64 s[12:13]
    s_cmp_ge_u32 s69, 23
    s_cbranch_scc0 L_crefresh
    ds_read_b64_tr_b16 a[192:193], v56 offset:8192
    ds_read_b64_tr_b16 a[194:195], v56 offset:10240
    v_exp_f32 v75, v235
    v_add_f32 v28, v28, v73
    v_mfma_f32_32x32x16_bf16 a[16:31], a[232:235], v[136:139], a[16:31]
    ds_read_b64_tr_b16 a[196:197], v56 offset:12288
    ds_read_b64_tr_b16 a[198:199], v56 offset:14336
    ds_read_b64_tr_b16 a[200:201], v57 offset:8192
    v_cvt_pk_bf16_f32 v180, v72, v73
    v_exp_f32 v76, v236
    v_add_f32 v27, v27, v74
    v_mfma_f32_32x32x16_bf16 a[32:47], a[240:243], v[136:139], a[32:47]
    ds_read_b64_tr_b16 a[202:203], v57 offset:10240
    ds_read_b64_tr_b16 a[204:205], v57 offset:12288
    ds_read_b64_tr_b16 a[206:207], v57 offset:14336
    v_exp_f32 v77, v237
    v_add_f32 v28, v28, v75
    v_cvt_pk_bf16_f32 v181, v74, v75
    v_mfma_f32_32x32x16_bf16 a[48:63], a[248:251], v[136:139], a[48:63]
    ds_read_b64_tr_b16 a[208:209], v58 offset:8192
    ds_read_b64_tr_b16 a[210:211], v58 offset:10240
    ds_read_b64_tr_b16 a[212:213], v58 offset:12288
    v_exp_f32 v78, v238
    v_add_f32 v27, v27, v76
    v_mfma_f32_32x32x16_bf16 a[0:15], a[228:231], v[140:143], a[0:15]
    ds_read_b64_tr_b16 a[214:215], v58 offset:14336
    ds_read_b64_tr_b16 a[216:217], v59 offset:8192
    ds_read_b64_tr_b16 a[218:219], v59 offset:10240
    v_exp_f32 v79, v239
    v_add_f32 v28, v28, v77
    v_cvt_pk_bf16_f32 v182, v76, v77
    v_mfma_f32_32x32x16_bf16 a[16:31], a[236:239], v[140:143], a[16:31]
    ds_read_b64_tr_b16 a[220:221], v59 offset:12288
    ds_read_b64_tr_b16 a[222:223], v59 offset:14336
    v_exp_f32 v72, v240
    v_add_f32 v27, v27, v78
    v_exp_f32 v73, v241
    v_mfma_f32_32x32x16_bf16 a[32:47], a[244:247], v[140:143], a[32:47]
    v_add_f32 v28, v28, v79
    v_cvt_pk_bf16_f32 v183, v78, v79
    v_exp_f32 v74, v242
    v_add_f32 v27, v27, v72
    v_exp_f32 v75, v243
    v_mfma_f32_32x32x16_bf16 a[48:63], a[252:255], v[140:143], a[48:63]
    v_add_f32 v28, v28, v73
    v_cvt_pk_bf16_f32 v184, v72, v73
    v_exp_f32 v76, v244
    v_add_f32 v27, v27, v74
    v_exp_f32 v77, v245
    s_waitcnt lgkmcnt(0)
    v_mfma_f32_32x32x16_bf16 a[0:15], a[192:195], v[144:147], a[0:15]
    s_getpc_b64 s[12:13]
    s_cmp_ge_u32 s69, 24
    s_cbranch_scc0 L_crefresh
    ds_read_b64_tr_b16 a[224:225], v56 offset:16384
    ds_read_b64_tr_b16 a[226:227], v56 offset:18432
    ds_read_b64_tr_b16 a[228:229], v56 offset:20480
    v_add_f32 v28, v28, v75
    v_cvt_pk_bf16_f32 v185, v74, v75
    v_mfma_f32_32x32x16_bf16 a[16:31], a[200:203], v[144:147], a[16:31]
    ds_read_b64_tr_b16 a[230:231], v56 offset:22528
    ds_read_b64_tr_b16 a[232:233], v57 offset:16384
    ds_read_b64_tr_b16 a[234:235], v57 offset:18432
    v_exp_f32 v78, v246
    v_add_f32 v27, v27, v76
    v_mfma_f32_32x32x16_bf16 a[32:47], a[208:211], v[144:147], a[32:47]
    ds_read_b64_tr_b16 a[236:237], v57 offset:20480
    ds_read_b64_tr_b16 a[238:239], v57 offset:22528
    ds_read_b64_tr_b16 a[240:241], v58 offset:16384
    v_exp_f32 v79, v247
    v_add_f32 v28, v28, v77
    v_cvt_pk_bf16_f32 v186, v76, v77
    v_mfma_f32_32x32x16_bf16 a[48:63], a[216:219], v[144:147], a[48:63]
    ds_read_b64_tr_b16 a[242:243], v58 offset:18432
    ds_read_b64_tr_b16 a[244:245], v58 offset:20480
    ds_read_b64_tr_b16 a[246:247], v58 offset:22528
    v_exp_f32 v72, v248
    v_add_f32 v27, v27, v78
    v_mfma_f32_32x32x16_bf16 a[0:15], a[196:199], v[148:151], a[0:15]
    ds_read_b64_tr_b16 a[248:249], v59 offset:16384
    ds_read_b64_tr_b16 a[250:251], v59 offset:18432
    ds_read_b64_tr_b16 a[252:253], v59 offset:20480
    v_exp_f32 v73, v249
    v_add_f32 v28, v28, v79
    v_cvt_pk_bf16_f32 v187, v78, v79
    v_mfma_f32_32x32x16_bf16 a[16:31], a[204:207], v[148:151], a[16:31]
    ds_read_b64_tr_b16 a[254:255], v59 offset:22528
    v_mov_b32 v31, 13
    ds_write_b32 v25, v31
    v_exp_f32 v74, v250
    v_add_f32 v27, v27, v72
    v_mfma_f32_32x32x16_bf16 a[32:47], a[212:215], v[148:151], a[32:47]
    v_exp_f32 v75, v251
    v_add_f32 v28, v28, v73
    v_cvt_pk_bf16_f32 v188, v72, v73
    v_exp_f32 v76, v252
    v_add_f32 v27, v27, v74
    v_mfma_f32_32x32x16_bf16 a[48:63], a[220:223], v[148:151], a[48:63]
    v_exp_f32 v77, v253
    v_add_f32 v28, v28, v75
    v_cvt_pk_bf16_f32 v189, v74, v75
    v_exp_f32 v78, v254
    v_add_f32 v27, v27, v76
    s_waitcnt lgkmcnt(1)
    v_mfma_f32_32x32x16_bf16 a[0:15], a[224:227], v[152:155], a[0:15]
    s_cmp_eq_u32 s79, 1
    s_cbranch_scc1 L_as1
L_na1:
    s_getpc_b64 s[12:13]
    s_cmp_ge_u32 s69, 25
    s_cbranch_scc0 L_crefresh
    v_exp_f32 v79, v255
    v_add_f32 v28, v28, v77
    v_mfma_f32_32x32x16_bf16 a[16:31], a[232:235], v[152:155], a[16:31]
    ds_read_b128 a[64:67], v32 offset:24576
    ds_read_b128 a[68:71], v33 offset:24576
    v_cvt_pk_bf16_f32 v190, v76, v77
    v_add_f32 v27, v27, v78
    v_add_f32 v28, v28, v79
    v_cvt_pk_bf16_f32 v191, v78, v79
    v_mfma_f32_32x32x16_bf16 a[32:47], a[240:243], v[152:155], a[32:47]
    ds_read_b128 a[72:75], v34 offset:24576
    ds_read_b128 a[76:79], v35 offset:24576
    v_mfma_f32_32x32x16_bf16 a[48:63], a[248:251], v[152:155], a[48:63]
    ds_read_b128 a[80:83], v36 offset:24576
    ds_read_b128 a[84:87], v37 offset:24576
    v_mfma_f32_32x32x16_bf16 a[0:15], a[228:231], v[156:159], a[0:15]
    ds_read_b128 a[88:91], v38 offset:24576
    ds_read_b128 a[92:95], v39 offset:24576
    v_mfma_f32_32x32x16_bf16 a[16:31], a[236:239], v[156:159], a[16:31]
    s_cmp_eq_u32 s3, 1
    s_cbranch_scc1 L_fb0a
L_fbr0a:
    v_mfma_f32_32x32x16_bf16 a[32:47], a[244:247], v[156:159], a[32:47]
    v_mfma_f32_32x32x16_bf16 a[48:63], a[252:255], v[156:159], a[48:63]
    v_add_f32 v27, v27, v28
    v_cmp_lt_f32 vcc, s11, v27
    s_cbranch_vccnz L_rs1
L_skip1:
    v_add_f32 v29, v29, v27
    s_waitcnt lgkmcnt(4)
    v_mfma_f32_32x32x16_bf16 v[192:207], a[64:67], v[96:99], v[80:95]
    s_getpc_b64 s[12:13]
    s_cmp_ge_u32 s69, 26
    s_cbranch_scc0 L_crefresh
    ds_read_b128 a[96:99], v48 offset:0
    v_mfma_f32_32x32x16_bf16 v[192:207], a[68:71], v[100:103], v[192:207]
    ds_read_b128 a[100:103], v49 offset:0
    ds_read_b128 a[104:107], v50 offset:0
    v_mfma_f32_32x32x16_bf16 v[192:207], a[72:75], v[104:107], v[192:207]
    ds_read_b128 a[108:111], v51 offset:0
    ds_read_b128 a[112:115], v52 offset:0
    v_mfma_f32_32x32x16_bf16 v[192:207], a[76:79], v[108:111], v[192:207]
    ds_read_b128 a[116:119], v53 offset:0
    ds_read_b128 a[120:123], v54 offset:0
    s_waitcnt lgkmcnt(7)
    v_mfma_f32_32x32x16_bf16 v[192:207], a[80:83], v[112:115], v[192:207]
    ds_read_b128 a[124:127], v55 offset:0
    v_mov_b32 v31, 14
    v_mfma_f32_32x32x16_bf16 v[192:207], a[84:87], v[116:119], v[192:207]
    ds_write_b32 v25, v31
    v_mfma_f32_32x32x16_bf16 v[192:207], a[88:91], v[120:123], v[192:207]
    v_mfma_f32_32x32x16_bf16 v[192:207], a[92:95], v[124:127], v[192:207]
    s_waitcnt lgkmcnt(5)
    v_mfma_f32_32x32x16_bf16 v[208:223], a[96:99], v[96:99], v[80:95]
    s_cmp_eq_u32 s3, 1
    s_cbranch_scc1 L_fb0b
L_fbr0b:
    s_getpc_b64 s[12:13]
    s_cmp_ge_u32 s69, 27
    s_cbranch_scc0 L_crefresh
    v_mfma_f32_32x32x16_bf16 v[208:223], a[100:103], v[100:103], v[208:223]
    ds_read_b128 a[128:131], v48 offset:8192
    ds_read_b128 a[132:135], v49 offset:8192
    v_mfma_f32_32x32x16_bf16 v[208:223], a[104:107], v[104:107], v[208:223]
    ds_read_b128 a[136:139], v50 offset:8192
    v_exp_f32 v72, v192
    v_exp_f32 v73, v193
    v_exp_f32 v74, v194
    v_mfma_f32_32x32x16_bf16 v[208:223], a[108:111], v[108:111], v[208:223]
    ds_read_b128 a[140:143], v51 offset:8192
    ds_read_b128 a[144:147], v52 offset:8192
    v_exp_f32 v75, v195
    v_cvt_pk_bf16_f32 v128, v72, v73
    v_exp_f32 v76, v196
    s_waitcnt lgkmcnt(6)
    v_mfma_f32_32x32x16_bf16 v[208:223], a[112:115], v[112:115], v[208:223]
    ds_read_b128 a[148:151], v53 offset:8192
    ds_read_b128 a[152:155], v54 offset:8192
    v_add_f32 v27, v72, v74
    v_exp_f32 v77, v197
    v_add_f32 v28, v73, v75
    v_cvt_pk_bf16_f32 v129, v74, v75
    v_mfma_f32_32x32x16_bf16 v[208:223], a[116:119], v[116:119], v[208:223]
    ds_read_b128 a[156:159], v55 offset:8192
    v_exp_f32 v78, v198
    v_add_f32 v27, v27, v76
    v_exp_f32 v79, v199
    v_add_f32 v28, v28, v77
    v_mfma_f32_32x32x16_bf16 v[208:223], a[120:123], v[120:123], v[208:223]
    v_cvt_pk_bf16_f32 v130, v76, v77
    v_exp_f32 v72, v200
    v_add_f32 v27, v27, v78
    v_exp_f32 v73, v201
    v_add_f32 v28, v28, v79
    v_mfma_f32_32x32x16_bf16 v[208:223], a[124:127], v[124:127], v[208:223]
    v_cvt_pk_bf16_f32 v131, v78, v79
    v_exp_f32 v74, v202
    v_add_f32 v27, v27, v72
    v_exp_f32 v75, v203
    v_add_f32 v28, v28, v73
    s_waitcnt lgkmcnt(4)
    v_mfma_f32_32x32x16_bf16 v[224:239], a[128:131], v[96:99], v[80:95]
    s_getpc_b64 s[12:13]
    s_cmp_ge_u32 s69, 28
    s_cbranch_scc0 L_crefresh
    ds_read_b128 a[160:163], v48 offset:16384
    v_cvt_pk_bf16_f32 v132, v72, v73
    v_exp_f32 v76, v204
    v_add_f32 v27, v27, v74
    v_mfma_f32_32x32x16_bf16 v[224:239], a[132:135], v[100:103], v[224:239]
    ds_read_b128 a[164:167], v49 offset:16384
    ds_read_b128 a[168:171], v50 offset:16384
    v_exp_f32 v77, v205
    v_add_f32 v28, v28, v75
    v_cvt_pk_bf16_f32 v133, v74, v75
    v_mfma_f32_32x32x16_bf16 v[224:239], a[136:139], v[104:107], v[224:239]
    ds_read_b128 a[172:175], v51 offset:16384
    ds_read_b128 a[176:179], v52 offset:16384
    v_exp_f32 v78, v206
    v_add_f32 v27, v27, v76
    v_exp_f32 v79, v207
    v_mfma_f32_32x32x16_bf16 v[224:239], a[140:143], v[108:111], v[224:239]
    ds_read_b128 a[180:183], v53 offset:16384
    ds_read_b128 a[184:187], v54 offset:16384
    v_add_f32 v28, v28, v77
    v_cvt_pk_bf16_f32 v134, v76, v77
    v_exp_f32 v72, v208
    v_add_f32 v27, v27, v78
    s_waitcnt lgkmcnt(7)
    v_mfma_f32_32x32x16_bf16 v[224:239], a[144:147], v[112:115], v[224:239]
    ds_read_b128 a[188:191], v55 offset:16384
    v_mov_b32 v31, 15
    v_exp_f32 v73, v209
    v_add_f32 v28, v28, v79
    v_cvt_pk_bf16_f32 v135, v78, v79
    v_mfma_f32_32x32x16_bf16 v[224:239], a[148:151], v[116:119], v[224:239]
    ds_write_b32 v25, v31
    v_exp_f32 v74, v210
    v_add_f32 v27, v27, v72
    v_exp_f32 v75, v211
    v_add_f32 v28, v28, v73
    v_mfma_f32_32x32x16_bf16 v[224:239], a[152:155], v[120:123], v[224:239]
    v_cvt_pk_bf16_f32 v136, v72, v73
    v_exp_f32 v76, v212
    v_add_f32 v27, v27, v74
    v_exp_f32 v77, v213
    v_add_f32 v28, v28, v75
    v_mfma_f32_32x32x16_bf16 v[224:239], a[156:159], v[124:127], v[224:239]
    v_cvt_pk_bf16_f32 v137, v74, v75
    v_exp_f32 v78, v214
    v_add_f32 v27, v27, v76
    v_exp_f32 v79, v215
    v_add_f32 v28, v28, v77
    s_waitcnt lgkmcnt(5)
    v_mfma_f32_32x32x16_bf16 v[240:255], a[160:163], v[96:99], v[80:95]
    s_cmp_eq_u32 s79, 2
    s_cbranch_scc1 L_as2
L_na2:
    s_getpc_b64 s[12:13]
    s_cmp_ge_u32 s69, 29
    s_cbranch_scc0 L_crefresh
    ds_read_b64_tr_b16 a[192:193], v60 offset:8192
    v_cvt_pk_bf16_f32 v138, v76, v77
    v_mfma_f32_32x32x16_bf16 v[240:255], a[164:167], v[100:103], v[240:255]
    ds_read_b64_tr_b16 a[194:195], v60 offset:10240
    ds_read_b64_tr_b16 a[196:197], v60 offset:12288
    ds_read_b64_tr_b16 a[198:199], v60 offset:14336
    v_exp_f32 v72, v216
    v_add_f32 v27, v27, v78
    v_mfma_f32_32x32x16_bf16 v[240:255], a[168:171], v[104:107], v[240:255]
    ds_read_b64_tr_b16 a[200:201], v61 offset:8192
    ds_read_b64_tr_b16 a[202:203], v61 offset:10240
    ds_read_b64_tr_b16 a[204:205], v61 offset:12288
    v_exp_f32 v73, v217
    v_add_f32 v28, v28, v79
    v_cvt_pk_bf16_f32 v139, v78, v79
    v_mfma_f32_32x32x16_bf16 v[240:255], a[172:175], v[108:111], v[240:255]
    ds_read_b64_tr_b16 a[206:207], v61 offset:14336
    ds_read_b64_tr_b16 a[208:209], v62 offset:8192
    ds_read_b64_tr_b16 a[210:211], v62 offset:10240
    v_exp_f32 v74, v218
    v_add_f32 v27, v27, v72
    s_waitcnt lgkmcnt(11)
    v_mfma_f32_32x32x16_bf16 v[240:255], a[176:179], v[112:115], v[240:255]
    ds_read_b64_tr_b16 a[212:213], v62 offset:12288
    ds_read_b64_tr_b16 a[214:215], v62 offset:14336
    ds_read_b64_tr_b16 a[216:217], v63 offset:8192
    v_exp_f32 v75, v219
    v_add_f32 v28, v28, v73
    v_cvt_pk_bf16_f32 v140, v72, v73
    v_mfma_f32_32x32x16_bf16 v[240:255], a[180:183], v[116:119], v[240:255]
    ds_read_b64_tr_b16 a[218:219], v63 offset:10240
    ds_read_b64_tr_b16 a[220:221], v63 offset:12288
    ds_read_b64_tr_b16 a[222:223], v63 offset:14336
    v_exp_f32 v76, v220
    v_add_f32 v27, v27, v74
    v_mfma_f32_32x32x16_bf16 v[240:255], a[184:187], v[120:123], v[240:255]
    v_exp_f32 v77, v221
    v_add_f32 v28, v28, v75
    v_cvt_pk_bf16_f32 v141, v74, v75
    v_exp_f32 v78, v222
    v_add_f32 v27, v27, v76
    v_mfma_f32_32x32x16_bf16 v[240:255], a[188:191], v[124:127], v[240:255]
    v_exp_f32 v79, v223
    v_add_f32 v28, v28, v77
    v_cvt_pk_bf16_f32 v142, v76, v77
    v_exp_f32 v72, v224
    v_add_f32 v27, v27, v78
    s_waitcnt lgkmcnt(0)
    v_mfma_f32_32x32x16_bf16 a[0:15], a[192:195], v[160:163], a[0:15]
    s_getpc_b64 s[12:13]
    s_cmp_ge_u32 s69, 30
    s_cbranch_scc0 L_crefresh
    ds_read_b64_tr_b16 a[224:225], v60 offset:16384
    ds_read_b64_tr_b16 a[226:227], v60 offset:18432
    ds_read_b64_tr_b16 a[228:229], v60 offset:20480
    v_exp_f32 v73, v225
    v_mfma_f32_32x32x16_bf16 a[16:31], a[200:203], v[160:163], a[16:31]
    ds_read_b64_tr_b16 a[230:231], v60 offset:22528
    ds_read_b64_tr_b16 a[232:233], v61 offset:16384
    ds_read_b64_tr_b16 a[234:235], v61 offset:18432
    v_add_f32 v28, v28, v79
    v_cvt_pk_bf16_f32 v143, v78, v79
    v_exp_f32 v74, v226
    v_mfma_f32_32x32x16_bf16 a[32:47], a[208:211], v[160:163], a[32:47]
    ds_read_b64_tr_b16 a[236:237], v61 offset:20480
    ds_read_b64_tr_b16 a[238:239], v61 offset:22528
    ds_read_b64_tr_b16 a[240:241], v62 offset:16384
    v_add_f32 v27, v27, v72
    v_exp_f32 v75, v227
    v_add_f32 v28, v28, v73
    v_mfma_f32_32x32x16_bf16 a[48:63], a[216:219], v[160:163], a[48:63]
    ds_read_b64_tr_b16 a[242:243], v62 offset:18432
    ds_read_b64_tr_b16 a[244:245], v62 offset:20480
    ds_read_b64_tr_b16 a[246:247], v62 offset:22528
    v_cvt_pk_bf16_f32 v144, v72, v73
    v_exp_f32 v76, v228
    v_add_f32 v27, v27, v74
    v_mfma_f32_32x32x16_bf16 a[0:15], a[196:199], v[164:167], a[0:15]
    ds_read_b64_tr_b16 a[248:249], v63 offset:16384
    ds_read_b64_tr_b16 a[250:251], v63 offset:18432
    ds_read_b64_tr_b16 a[252:253], v63 offset:20480
    v_exp_f32 v77, v229
    v_add_f32 v28, v28, v75
    v_cvt_pk_bf16_f32 v145, v74, v75
    v_mfma_f32_32x32x16_bf16 a[16:31], a[204:207], v[164:167], a[16:31]
    ds_read_b64_tr_b16 a[254:255], v63 offset:22528
    v_mov_b32 v31, 16
    ds_write_b32 v25, v31
    v_exp_f32 v78, v230
    v_add_f32 v27, v27, v76
    v_mfma_f32_32x32x16_bf16 a[32:47], a[212:215], v[164:167], a[32:47]
    v_exp_f32 v79, v231
    v_add_f32 v28, v28, v77
    v_cvt_pk_bf16_f32 v146, v76, v77
    v_exp_f32 v72, v232
    v_add_f32 v27, v27, v78
    v_mfma_f32_32x32x16_bf16 a[48:63], a[220:223], v[164:167], a[48:63]
    v_exp_f32 v73, v233
    v_add_f32 v28, v28, v79
    v_cvt_pk_bf16_f32 v147, v78, v79
    v_exp_f32 v74, v234
    v_add_f32 v27, v27, v72
    s_waitcnt lgkmcnt(1)
    v_mfma_f32_32x32x16_bf16 a[0:15], a[224:227], v[168:171], a[0:15]
    s_getpc_b64 s[12:13]
    s_cmp_ge_u32 s69, 31
    s_cbranch_scc0 L_crefresh
    ds_read_b64_tr_b16 a[192:193], v60 offset:24576
    ds_read_b64_tr_b16 a[194:195], v60 offset:26624
    v_exp_f32 v75, v235
    v_add_f32 v28, v28, v73
    v_mfma_f32_32x32x16_bf16 a[16:31], a[232:235], v[168:171], a[16:31]
    ds_read_b64_tr_b16 a[196:197], v60 offset:28672
    ds_read_b64_tr_b16 a[198:199], v60 offset:30720
    ds_read_b64_tr_b16 a[200:201], v61 offset:24576
    v_cvt_pk_bf16_f32 v148, v72, v73
    v_exp_f32 v76, v236
    v_add_f32 v27, v27, v74
    v_mfma_f32_32x32x16_bf16 a[32:47], a[240:243], v[168:171], a[32:47]
    ds_read_b64_tr_b16 a[202:203], v61 offset:26624
    ds_read_b64_tr_b16 a[204:205], v61 offset:28672
    ds_read_b64_tr_b16 a[206:207], v61 offset:30720
    v_exp_f32 v77, v237
    v_add_f32 v28, v28, v75
    v_cvt_pk_bf16_f32 v149, v74, v75
    v_mfma_f32_32x32x16_bf16 a[48:63], a[248:251], v[168:171], a[48:63]
    ds_read_b64_tr_b16 a[208:209], v62 offset:24576
    ds_read_b64_tr_b16 a[210:211], v62 offset:26624
    ds_read_b64_tr_b16 a[212:213], v62 offset:28672
    v_exp_f32 v78, v238
    v_add_f32 v27, v27, v76
    v_mfma_f32_32x32x16_bf16 a[0:15], a[228:231], v[172:175], a[0:15]
    ds_read_b64_tr_b16 a[214:215], v62 offset:30720
    ds_read_b64_tr_b16 a[216:217], v63 offset:24576
    ds_read_b64_tr_b16 a[218:219], v63 offset:26624
    v_exp_f32 v79, v239
    v_add_f32 v28, v28, v77
    v_cvt_pk_bf16_f32 v150, v76, v77
    v_mfma_f32_32x32x16_bf16 a[16:31], a[236:239], v[172:175], a[16:31]
    ds_read_b64_tr_b16 a[220:221], v63 offset:28672
    ds_read_b64_tr_b16 a[222:223], v63 offset:30720
    v_exp_f32 v72, v240
    v_add_f32 v27, v27, v78
    v_exp_f32 v73, v241
    v_mfma_f32_32x32x16_bf16 a[32:47], a[244:247], v[172:175], a[32:47]
    v_add_f32 v28, v28, v79
    v_cvt_pk_bf16_f32 v151, v78, v79
    v_exp_f32 v74, v242
    v_add_f32 v27, v27, v72
    v_exp_f32 v75, v243
    v_mfma_f32_32x32x16_bf16 a[48:63], a[252:255], v[172:175], a[48:63]
    v_add_f32 v28, v28, v73
    v_cvt_pk_bf16_f32 v152, v72, v73
    v_exp_f32 v76, v244
    v_add_f32 v27, v27, v74
    v_exp_f32 v77, v245
    s_waitcnt lgkmcnt(0)
    v_mfma_f32_32x32x16_bf16 a[0:15], a[192:195], v[176:179], a[0:15]
    s_getpc_b64 s[12:13]
    s_cmp_ge_u32 s69, 32
    s_cbranch_scc0 L_crefresh
    ds_read_b64_tr_b16 a[224:225], v60 offset:32768
    ds_read_b64_tr_b16 a[226:227], v60 offset:34816
    ds_read_b64_tr_b16 a[228:229], v60 offset:36864
    v_add_f32 v28, v28, v75
    v_cvt_pk_bf16_f32 v153, v74, v75
    v_mfma_f32_32x32x16_bf16 a[16:31], a[200:203], v[176:179], a[16:31]
    ds_read_b64_tr_b16 a[230:231], v60 offset:38912
    ds_read_b64_tr_b16 a[232:233], v61 offset:32768
    ds_read_b64_tr_b16 a[234:235], v61 offset:34816
    v_exp_f32 v78, v246
    v_add_f32 v27, v27, v76
    v_mfma_f32_32x32x16_bf16 a[32:47], a[208:211], v[176:179], a[32:47]
    ds_read_b64_tr_b16 a[236:237], v61 offset:36864
    ds_read_b64_tr_b16 a[238:239], v61 offset:38912
    ds_read_b64_tr_b16 a[240:241], v62 offset:32768
    v_exp_f32 v79, v247
    v_add_f32 v28, v28, v77
    v_cvt_pk_bf16_f32 v154, v76, v77
    v_mfma_f32_32x32x16_bf16 a[48:63], a[216:219], v[176:179], a[48:63]
    ds_read_b64_tr_b16 a[242:243], v62 offset:34816
    ds_read_b64_tr_b16 a[244:245], v62 offset:36864
    ds_read_b64_tr_b16 a[246:247], v62 offset:38912
    v_exp_f32 v72, v248
    v_add_f32 v27, v27, v78
    v_mfma_f32_32x32x16_bf16 a[0:15], a[196:199], v[180:183], a[0:15]
    ds_read_b64_tr_b16 a[248:249], v63 offset:32768
    ds_read_b64_tr_b16 a[250:251], v63 offset:34816
    ds_read_b64_tr_b16 a[252:253], v63 offset:36864
    v_exp_f32 v73, v249
    v_add_f32 v28, v28, v79
    v_cvt_pk_bf16_f32 v155, v78, v79
    v_mfma_f32_32x32x16_bf16 a[16:31], a[204:207], v[180:183], a[16:31]
    ds_read_b64_tr_b16 a[254:255], v63 offset:38912
    v_mov_b32 v31, 17
    ds_write_b32 v25, v31
    v_exp_f32 v74, v250
    v_add_f32 v27, v27, v72
    v_mfma_f32_32x32x16_bf16 a[32:47], a[212:215], v[180:183], a[32:47]
    v_exp_f32 v75, v251
    v_add_f32 v28, v28, v73
    v_cvt_pk_bf16_f32 v156, v72, v73
    v_exp_f32 v76, v252
    v_add_f32 v27, v27, v74
    v_mfma_f32_32x32x16_bf16 a[48:63], a[220:223], v[180:183], a[48:63]
    v_exp_f32 v77, v253
    v_add_f32 v28, v28, v75
    v_cvt_pk_bf16_f32 v157, v74, v75
    v_exp_f32 v78, v254
    v_add_f32 v27, v27, v76
    s_waitcnt lgkmcnt(1)
    v_mfma_f32_32x32x16_bf16 a[0:15], a[224:227], v[184:187], a[0:15]
    s_cmp_eq_u32 s79, 3
    s_cbranch_scc1 L_as3
L_na3:
    s_getpc_b64 s[12:13]
    s_cmp_ge_u32 s69, 33
    s_cbranch_scc0 L_crefresh
    v_exp_f32 v79, v255
    v_add_f32 v28, v28, v77
    v_mfma_f32_32x32x16_bf16 a[16:31], a[232:235], v[184:187], a[16:31]
    ds_read_b128 a[64:67], v40 offset:40960
    ds_read_b128 a[68:71], v41 offset:40960
    v_cvt_pk_bf16_f32 v158, v76, v77
    v_add_f32 v27, v27, v78
    v_add_f32 v28, v28, v79
    v_cvt_pk_bf16_f32 v159, v78, v79
    v_mfma_f32_32x32x16_bf16 a[32:47], a[240:243], v[184:187], a[32:47]
    ds_read_b128 a[72:75], v42 offset:40960
    ds_read_b128 a[76:79], v43 offset:40960
    v_mfma_f32_32x32x16_bf16 a[48:63], a[248:251], v[184:187], a[48:63]
    ds_read_b128 a[80:83], v44 offset:40960
    ds_read_b128 a[84:87], v45 offset:40960
    v_mfma_f32_32x32x16_bf16 a[0:15], a[228:231], v[188:191], a[0:15]
    ds_read_b128 a[88:91], v46 offset:40960
    ds_read_b128 a[92:95], v47 offset:40960
    v_mfma_f32_32x32x16_bf16 a[16:31], a[236:239], v[188:191], a[16:31]
    s_cmp_eq_u32 s3, 2
    s_cbranch_scc1 L_fb1a
L_fbr1a:
    v_mfma_f32_32x32x16_bf16 a[32:47], a[244:247], v[188:191], a[32:47]
    v_mfma_f32_32x32x16_bf16 a[48:63], a[252:255], v[188:191], a[48:63]
    v_add_f32 v27, v27, v28
    v_cmp_lt_f32 vcc, s11, v27
    s_cbranch_vccnz L_rs2
L_skip2:
    v_add_f32 v29, v29, v27
    s_waitcnt lgkmcnt(4)
    v_mfma_f32_32x32x16_bf16 v[192:207], a[64:67], v[96:99], v[80:95]
    s_getpc_b64 s[12:13]
    s_cmp_ge_u32 s69, 34
    s_cbranch_scc0 L_crefresh
    ds_read_b128 a[96:99], v40 offset:49152
    v_mfma_f32_32x32x16_bf16 v[192:207], a[68:71], v[100:103], v[192:207]
    ds_read_b128 a[100:103], v41 offset:49152
    ds_read_b128 a[104:107], v42 offset:49152
    v_mfma_f32_32x32x16_bf16 v[192:207], a[72:75], v[104:107], v[192:207]
    ds_read_b128 a[108:111], v43 offset:49152
    ds_read_b128 a[112:115], v44 offset:49152
    v_mfma_f32_32x32x16_bf16 v[192:207], a[76:79], v[108:111], v[192:207]
    ds_read_b128 a[116:119], v45 offset:49152
    ds_read_b128 a[120:123], v46 offset:49152
    s_waitcnt lgkmcnt(7)
    v_mfma_f32_32x32x16_bf16 v[192:207], a[80:83], v[112:115], v[192:207]
    ds_read_b128 a[124:127], v47 offset:49152
    v_mov_b32 v31, 18
    v_mfma_f32_32x32x16_bf16 v[192:207], a[84:87], v[116:119], v[192:207]
    ds_write_b32 v25, v31
    v_mfma_f32_32x32x16_bf16 v[192:207], a[88:91], v[120:123], v[192:207]
    v_mfma_f32_32x32x16_bf16 v[192:207], a[92:95], v[124:127], v[192:207]
    s_waitcnt lgkmcnt(5)
    v_mfma_f32_32x32x16_bf16 v[208:223], a[96:99], v[96:99], v[80:95]
    s_cmp_eq_u32 s3, 2
    s_cbranch_scc1 L_fb1b
L_fbr1b:
    s_getpc_b64 s[12:13]
    s_cmp_ge_u32 s69, 35
    s_cbranch_scc0 L_crefresh
    v_mfma_f32_32x32x16_bf16 v[208:223], a[100:103], v[100:103], v[208:223]
    ds_read_b128 a[128:131], v40 offset:57344
    ds_read_b128 a[132:135], v41 offset:57344
    v_mfma_f32_32x32x16_bf16 v[208:223], a[104:107], v[104:107], v[208:223]
    ds_read_b128 a[136:139], v42 offset:57344
    v_exp_f32 v72, v192
    v_exp_f32 v73, v193
    v_exp_f32 v74, v194
    v_mfma_f32_32x32x16_bf16 v[208:223], a[108:111], v[108:111], v[208:223]
    ds_read_b128 a[140:143], v43 offset:57344
    ds_read_b128 a[144:147], v44 offset:57344
    v_exp_f32 v75, v195
    v_cvt_pk_bf16_f32 v160, v72, v73
    v_exp_f32 v76, v196
    s_waitcnt lgkmcnt(6)
    v_mfma_f32_32x32x16_bf16 v[208:223], a[112:115], v[112:115], v[208:223]
    ds_read_b128 a[148:151], v45 offset:57344
    ds_read_b128 a[152:155], v46 offset:57344
    v_add_f32 v27, v72, v74
    v_exp_f32 v77, v197
    v_add_f32 v28, v73, v75
    v_cvt_pk_bf16_f32 v161, v74, v75
    v_mfma_f32_32x32x16_bf16 v[208:223], a[116:119], v[116:119], v[208:223]
    ds_read_b128 a[156:159], v47 offset:57344
    v_exp_f32 v78, v198
    v_add_f32 v27, v27, v76
    v_exp_f32 v79, v199
    v_add_f32 v28, v28, v77
    v_mfma_f32_32x32x16_bf16 v[208:223], a[120:123], v[120:123], v[208:223]
    v_cvt_pk_bf16_f32 v162, v76, v77
    v_exp_f32 v72, v200
    v_add_f32 v27, v27, v78
    v_exp_f32 v73, v201
    v_add_f32 v28, v28, v79
    v_mfma_f32_32x32x16_bf16 v[208:223], a[124:127], v[124:127], v[208:223]
    v_cvt_pk_bf16_f32 v163, v78, v79
    v_exp_f32 v74, v202
    v_add_f32 v27, v27, v72
    v_exp_f32 v75, v203
    v_add_f32 v28, v28, v73
    s_waitcnt lgkmcnt(4)
    v_mfma_f32_32x32x16_bf16 v[224:239], a[128:131], v[96:99], v[80:95]
    s_getpc_b64 s[12:13]
    s_cmp_ge_u32 s69, 36
    s_cbranch_scc0 L_crefresh
    ds_read_b128 a[160:163], v32 offset:32768
    v_cvt_pk_bf16_f32 v164, v72, v73
    v_exp_f32 v76, v204
    v_add_f32 v27, v27, v74
    v_mfma_f32_32x32x16_bf16 v[224:239], a[132:135], v[100:103], v[224:239]
    ds_read_b128 a[164:167], v33 offset:32768
    ds_read_b128 a[168:171], v34 offset:32768
    v_exp_f32 v77, v205
    v_add_f32 v28, v28, v75
    v_cvt_pk_bf16_f32 v165, v74, v75
    v_mfma_f32_32x32x16_bf16 v[224:239], a[136:139], v[104:107], v[224:239]
    ds_read_b128 a[172:175], v35 offset:32768
    ds_read_b128 a[176:179], v36 offset:32768
    v_exp_f32 v78, v206
    v_add_f32 v27, v27, v76
    v_exp_f32 v79, v207
    v_mfma_f32_32x32x16_bf16 v[224:239], a[140:143], v[108:111], v[224:239]
    ds_read_b128 a[180:183], v37 offset:32768
    ds_read_b128 a[184:187], v38 offset:32768
    v_add_f32 v28, v28, v77
    v_cvt_pk_bf16_f32 v166, v76, v77
    v_exp_f32 v72, v208
    v_add_f32 v27, v27, v78
    s_waitcnt lgkmcnt(7)
    v_mfma_f32_32x32x16_bf16 v[224:239], a[144:147], v[112:115], v[224:239]
    ds_read_b128 a[188:191], v39 offset:32768
    v_mov_b32 v31, 19
    v_exp_f32 v73, v209
    v_add_f32 v28, v28, v79
    v_cvt_pk_bf16_f32 v167, v78, v79
    v_mfma_f32_32x32x16_bf16 v[224:239], a[148:151], v[116:119], v[224:239]
    ds_write_b32 v25, v31
    v_exp_f32 v74, v210
    v_add_f32 v27, v27, v72
    v_exp_f32 v75, v211
    v_add_f32 v28, v28, v73
    v_mfma_f32_32x32x16_bf16 v[224:239], a[152:155], v[120:123], v[224:239]
    v_cvt_pk_bf16_f32 v168, v72, v73
    v_exp_f32 v76, v212
    v_add_f32 v27, v27, v74
    v_exp_f32 v77, v213
    v_add_f32 v28, v28, v75
    v_mfma_f32_32x32x16_bf16 v[224:239], a[156:159], v[124:127], v[224:239]
    v_cvt_pk_bf16_f32 v169, v74, v75
    v_exp_f32 v78, v214
    v_add_f32 v27, v27, v76
    v_exp_f32 v79, v215
    v_add_f32 v28, v28, v77
    s_waitcnt lgkmcnt(5)
    v_mfma_f32_32x32x16_bf16 v[240:255], a[160:163], v[96:99], v[80:95]
    s_cmp_eq_u32 s79, 4
    s_cbranch_scc1 L_as4
L_na4:
    s_getpc_b64 s[12:13]
    s_cmp_ge_u32 s69, 37
    s_cbranch_scc0 L_crefresh
    ds_read_b64_tr_b16 a[192:193], v56 offset:40960
    v_cvt_pk_bf16_f32 v170, v76, v77
    v_mfma_f32_32x32x16_bf16 v[240:255], a[164:167], v[100:103], v[240:255]
    ds_read_b64_tr_b16 a[194:195], v56 offset:43008
    ds_read_b64_tr_b16 a[196:197], v56 offset:45056
    ds_read_b64_tr_b16 a[198:199], v56 offset:47104
    v_exp_f32 v72, v216
    v_add_f32 v27, v27, v78
    v_mfma_f32_32x32x16_bf16 v[240:255], a[168:171], v[104:107], v[240:255]
    ds_read_b64_tr_b16 a[200:201], v57 offset:40960
    ds_read_b64_tr_b16 a[202:203], v57 offset:43008
    ds_read_b64_tr_b16 a[204:205], v57 offset:45056
    v_exp_f32 v73, v217
    v_add_f32 v28, v28, v79
    v_cvt_pk_bf16_f32 v171, v78, v79
    v_mfma_f32_32x32x16_bf16 v[240:255], a[172:175], v[108:111], v[240:255]
    ds_read_b64_tr_b16 a[206:207], v57 offset:47104
    ds_read_b64_tr_b16 a[208:209], v58 offset:40960
    ds_read_b64_tr_b16 a[210:211], v58 offset:43008
    v_exp_f32 v74, v218
    v_add_f32 v27, v27, v72
    s_waitcnt lgkmcnt(11)
    v_mfma_f32_32x32x16_bf16 v[240:255], a[176:179], v[112:115], v[240:255]
    ds_read_b64_tr_b16 a[212:213], v58 offset:45056
    ds_read_b64_tr_b16 a[214:215], v58 offset:47104
    ds_read_b64_tr_b16 a[216:217], v59 offset:40960
    v_exp_f32 v75, v219
    v_add_f32 v28, v28, v73
    v_cvt_pk_bf16_f32 v172, v72, v73
    v_mfma_f32_32x32x16_bf16 v[240:255], a[180:183], v[116:119], v[240:255]
    ds_read_b64_tr_b16 a[218:219], v59 offset:43008
    ds_read_b64_tr_b16 a[220:221], v59 offset:45056
    ds_read_b64_tr_b16 a[222:223], v59 offset:47104
    v_exp_f32 v76, v220
    v_add_f32 v27, v27, v74
    v_mfma_f32_32x32x16_bf16 v[240:255], a[184:187], v[120:123], v[240:255]
    v_exp_f32 v77, v221
    v_add_f32 v28, v28, v75
    v_cvt_pk_bf16_f32 v173, v74, v75
    v_exp_f32 v78, v222
    v_add_f32 v27, v27, v76
    v_mfma_f32_32x32x16_bf16 v[240:255], a[188:191], v[124:127], v[240:255]
    v_exp_f32 v79, v223
    v_add_f32 v28, v28, v77
    v_cvt_pk_bf16_f32 v174, v76, v77
    v_exp_f32 v72, v224
    v_add_f32 v27, v27, v78
    s_waitcnt lgkmcnt(0)
    v_mfma_f32_32x32x16_bf16 a[0:15], a[192:195], v[128:131], a[0:15]
    s_getpc_b64 s[12:13]
    s_cmp_ge_u32 s69, 38
    s_cbranch_scc0 L_crefresh
    ds_read_b64_tr_b16 a[224:225], v56 offset:49152
    ds_read_b64_tr_b16 a[226:227], v56 offset:51200
    ds_read_b64_tr_b16 a[228:229], v56 offset:53248
    v_exp_f32 v73, v225
    v_mfma_f32_32x32x16_bf16 a[16:31], a[200:203], v[128:131], a[16:31]
    ds_read_b64_tr_b16 a[230:231], v56 offset:55296
    ds_read_b64_tr_b16 a[232:233], v57 offset:49152
    ds_read_b64_tr_b16 a[234:235], v57 offset:51200
    v_add_f32 v28, v28, v79
    v_cvt_pk_bf16_f32 v175, v78, v79
    v_exp_f32 v74, v226
    v_mfma_f32_32x32x16_bf16 a[32:47], a[208:211], v[128:131], a[32:47]
    ds_read_b64_tr_b16 a[236:237], v57 offset:53248
    ds_read_b64_tr_b16 a[238:239], v57 offset:55296
    ds_read_b64_tr_b16 a[240:241], v58 offset:49152
    v_add_f32 v27, v27, v72
    v_exp_f32 v75, v227
    v_add_f32 v28, v28, v73
    v_mfma_f32_32x32x16_bf16 a[48:63], a[216:219], v[128:131], a[48:63]
    ds_read_b64_tr_b16 a[242:243], v58 offset:51200
    ds_read_b64_tr_b16 a[244:245], v58 offset:53248
    ds_read_b64_tr_b16 a[246:247], v58 offset:55296
    v_cvt_pk_bf16_f32 v176, v72, v73
    v_exp_f32 v76, v228
    v_add_f32 v27, v27, v74
    v_mfma_f32_32x32x16_bf16 a[0:15], a[196:199], v[132:135], a[0:15]
    ds_read_b64_tr_b16 a[248:249], v59 offset:49152
    ds_read_b64_tr_b16 a[250:251], v59 offset:51200
    ds_read_b64_tr_b16 a[252:253], v59 offset:53248
    v_exp_f32 v77, v229
    v_add_f32 v28, v28, v75
    v_cvt_pk_bf16_f32 v177, v74, v75
    v_mfma_f32_32x32x16_bf16 a[16:31], a[204:207], v[132:135], a[16:31]
    ds_read_b64_tr_b16 a[254:255], v59 offset:55296
    v_mov_b32 v31, 20
    ds_write_b32 v25, v31
    v_exp_f32 v78, v230
    v_add_f32 v27, v27, v76
    v_mfma_f32_32x32x16_bf16 a[32:47], a[212:215], v[132:135], a[32:47]
    v_exp_f32 v79, v231
    v_add_f32 v28, v28, v77
    v_cvt_pk_bf16_f32 v178, v76, v77
    v_exp_f32 v72, v232
    v_add_f32 v27, v27, v78
    v_mfma_f32_32x32x16_bf16 a[48:63], a[220:223], v[132:135], a[48:63]
    v_exp_f32 v73, v233
    v_add_f32 v28, v28, v79
    v_cvt_pk_bf16_f32 v179, v78, v79
    v_exp_f32 v74, v234
    v_add_f32 v27, v27, v72
    s_waitcnt lgkmcnt(1)
    v_mfma_f32_32x32x16_bf16 a[0:15], a[224:227], v[136:139], a[0:15]
    s_getpc_b64 s[12:13]
    s_cmp_ge_u32 s69, 39
    s_cbranch_scc0 L_crefresh
    ds_read_b64_tr_b16 a[192:193], v56 offset:57344
    ds_read_b64_tr_b16 a[194:195], v56 offset:59392
    v_exp_f32 v75, v235
    v_add_f32 v28, v28, v73
    v_mfma_f32_32x32x16_bf16 a[16:31], a[232:235], v[136:139], a[16:31]
    ds_read_b64_tr_b16 a[196:197], v56 offset:61440
    ds_read_b64_tr_b16 a[198:199], v56 offset:63488
    ds_read_b64_tr_b16 a[200:201], v57 offset:57344
    v_cvt_pk_bf16_f32 v180, v72, v73
    v_exp_f32 v76, v236
    v_add_f32 v27, v27, v74
    v_mfma_f32_32x32x16_bf16 a[32:47], a[240:243], v[136:139], a[32:47]
    ds_read_b64_tr_b16 a[202:203], v57 offset:59392
    ds_read_b64_tr_b16 a[204:205], v57 offset:61440
    ds_read_b64_tr_b16 a[206:207], v57 offset:63488
    v_exp_f32 v77, v237
    v_add_f32 v28, v28, v75
    v_cvt_pk_bf16_f32 v181, v74, v75
    v_mfma_f32_32x32x16_bf16 a[48:63], a[248:251], v[136:139], a[48:63]
    ds_read_b64_tr_b16 a[208:209], v58 offset:57344
    ds_read_b64_tr_b16 a[210:211], v58 offset:59392
    ds_read_b64_tr_b16 a[212:213], v58 offset:61440
    v_exp_f32 v78, v238
    v_add_f32 v27, v27, v76
    v_mfma_f32_32x32x16_bf16 a[0:15], a[228:231], v[140:143], a[0:15]
    ds_read_b64_tr_b16 a[214:215], v58 offset:63488
    ds_read_b64_tr_b16 a[216:217], v59 offset:57344
    ds_read_b64_tr_b16 a[218:219], v59 offset:59392
    v_exp_f32 v79, v239
    v_add_f32 v28, v28, v77
    v_cvt_pk_bf16_f32 v182, v76, v77
    v_mfma_f32_32x32x16_bf16 a[16:31], a[236:239], v[140:143], a[16:31]
    ds_read_b64_tr_b16 a[220:221], v59 offset:61440
    ds_read_b64_tr_b16 a[222:223], v59 offset:63488
    v_exp_f32 v72, v240
    v_add_f32 v27, v27, v78
    v_exp_f32 v73, v241
    v_mfma_f32_32x32x16_bf16 a[32:47], a[244:247], v[140:143], a[32:47]
    v_add_f32 v28, v28, v79
    v_cvt_pk_bf16_f32 v183, v78, v79
    v_exp_f32 v74, v242
    v_add_f32 v27, v27, v72
    v_exp_f32 v75, v243
    v_mfma_f32_32x32x16_bf16 a[48:63], a[252:255], v[140:143], a[48:63]
    v_add_f32 v28, v28, v73
    v_cvt_pk_bf16_f32 v184, v72, v73
    v_exp_f32 v76, v244
    v_add_f32 v27, v27, v74
    v_exp_f32 v77, v245
    s_waitcnt lgkmcnt(0)
    v_mfma_f32_32x32x16_bf16 a[0:15], a[192:195], v[144:147], a[0:15]
    s_getpc_b64 s[12:13]
    s_cmp_ge_u32 s69, 40
    s_cbranch_scc0 L_crefresh
    ds_read_b64_tr_b16 a[224:225], v56 offset:0
    ds_read_b64_tr_b16 a[226:227], v56 offset:2048
    ds_read_b64_tr_b16 a[228:229], v56 offset:4096
    v_add_f32 v28, v28, v75
    v_cvt_pk_bf16_f32 v185, v74, v75
    v_mfma_f32_32x32x16_bf16 a[16:31], a[200:203], v[144:147], a[16:31]
    ds_read_b64_tr_b16 a[230:231], v56 offset:6144
    ds_read_b64_tr_b16 a[232:233], v57 offset:0
    ds_read_b64_tr_b16 a[234:235], v57 offset:2048
    v_exp_f32 v78, v246
    v_add_f32 v27, v27, v76
    v_mfma_f32_32x32x16_bf16 a[32:47], a[208:211], v[144:147], a[32:47]
    ds_read_b64_tr_b16 a[236:237], v57 offset:4096
    ds_read_b64_tr_b16 a[238:239], v57 offset:6144
    ds_read_b64_tr_b16 a[240:241], v58 offset:0
    v_exp_f32 v79, v247
    v_add_f32 v28, v28, v77
    v_cvt_pk_bf16_f32 v186, v76, v77
    v_mfma_f32_32x32x16_bf16 a[48:63], a[216:219], v[144:147], a[48:63]
    ds_read_b64_tr_b16 a[242:243], v58 offset:2048
    ds_read_b64_tr_b16 a[244:245], v58 offset:4096
    ds_read_b64_tr_b16 a[246:247], v58 offset:6144
    v_exp_f32 v72, v248
    v_add_f32 v27, v27, v78
    v_mfma_f32_32x32x16_bf16 a[0:15], a[196:199], v[148:151], a[0:15]
    ds_read_b64_tr_b16 a[248:249], v59 offset:0
    ds_read_b64_tr_b16 a[250:251], v59 offset:2048
    ds_read_b64_tr_b16 a[252:253], v59 offset:4096
    v_exp_f32 v73, v249
    v_add_f32 v28, v28, v79
    v_cvt_pk_bf16_f32 v187, v78, v79
    v_mfma_f32_32x32x16_bf16 a[16:31], a[204:207], v[148:151], a[16:31]
    ds_read_b64_tr_b16 a[254:255], v59 offset:6144
    v_mov_b32 v31, 21
    ds_write_b32 v25, v31
    v_exp_f32 v74, v250
    v_add_f32 v27, v27, v72
    v_mfma_f32_32x32x16_bf16 a[32:47], a[212:215], v[148:151], a[32:47]
    v_exp_f32 v75, v251
    v_add_f32 v28, v28, v73
    v_cvt_pk_bf16_f32 v188, v72, v73
    v_exp_f32 v76, v252
    v_add_f32 v27, v27, v74
    v_mfma_f32_32x32x16_bf16 a[48:63], a[220:223], v[148:151], a[48:63]
    v_exp_f32 v77, v253
    v_add_f32 v28, v28, v75
    v_cvt_pk_bf16_f32 v189, v74, v75
    v_exp_f32 v78, v254
    v_add_f32 v27, v27, v76
    s_waitcnt lgkmcnt(1)
    v_mfma_f32_32x32x16_bf16 a[0:15], a[224:227], v[152:155], a[0:15]
    s_cmp_eq_u32 s79, 5
    s_cbranch_scc1 L_as5
L_na5:
    s_getpc_b64 s[12:13]
    s_cmp_ge_u32 s69, 41
    s_cbranch_scc0 L_crefresh
    v_exp_f32 v79, v255
    v_add_f32 v28, v28, v77
    v_mfma_f32_32x32x16_bf16 a[16:31], a[232:235], v[152:155], a[16:31]
    ds_read_b128 a[64:67], v40 offset:0
    ds_read_b128 a[68:71], v41 offset:0
    v_cvt_pk_bf16_f32 v190, v76, v77
    v_add_f32 v27, v27, v78
    v_add_f32 v28, v28, v79
    v_cvt_pk_bf16_f32 v191, v78, v79
    v_mfma_f32_32x32x16_bf16 a[32:47], a[240:243], v[152:155], a[32:47]
    ds_read_b128 a[72:75], v42 offset:0
    ds_read_b128 a[76:79], v43 offset:0
    v_mfma_f32_32x32x16_bf16 a[48:63], a[248:251], v[152:155], a[48:63]
    ds_read_b128 a[80:83], v44 offset:0
    ds_read_b128 a[84:87], v45 offset:0
    v_mfma_f32_32x32x16_bf16 a[0:15], a[228:231], v[156:159], a[0:15]
    ds_read_b128 a[88:91], v46 offset:0
    ds_read_b128 a[92:95], v47 offset:0
    v_mfma_f32_32x32x16_bf16 a[16:31], a[236:239], v[156:159], a[16:31]
    s_cmp_eq_u32 s3, 1
    s_cbranch_scc1 L_fb2a
L_fbr2a:
    v_mfma_f32_32x32x16_bf16 a[32:47], a[244:247], v[156:159], a[32:47]
    v_mfma_f32_32x32x16_bf16 a[48:63], a[252:255], v[156:159], a[48:63]
    v_add_f32 v27, v27, v28
    v_cmp_lt_f32 vcc, s11, v27
    s_cbranch_vccnz L_rs3
L_skip3:
    v_add_f32 v29, v29, v27
    s_waitcnt lgkmcnt(4)
    v_mfma_f32_32x32x16_bf16 v[192:207], a[64:67], v[96:99], v[80:95]
    s_getpc_b64 s[12:13]
    s_cmp_ge_u32 s69, 42
    s_cbranch_scc0 L_crefresh
    ds_read_b128 a[96:99], v32 offset:8192
    v_mfma_f32_32x32x16_bf16 v[192:207], a[68:71], v[100:103], v[192:207]
    ds_read_b128 a[100:103], v33 offset:8192
    ds_read_b128 a[104:107], v34 offset:8192
    v_mfma_f32_32x32x16_bf16 v[192:207], a[72:75], v[104:107], v[192:207]
    ds_read_b128 a[108:111], v35 offset:8192
    ds_read_b128 a[112:115], v36 offset:8192
    v_mfma_f32_32x32x16_bf16 v[192:207], a[76:79], v[108:111], v[192:207]
    ds_read_b128 a[116:119], v37 offset:8192
    ds_read_b128 a[120:123], v38 offset:8192
    s_waitcnt lgkmcnt(7)
    v_mfma_f32_32x32x16_bf16 v[192:207], a[80:83], v[112:115], v[192:207]
    ds_read_b128 a[124:127], v39 offset:8192
    v_mov_b32 v31, 22
    v_mfma_f32_32x32x16_bf16 v[192:207], a[84:87], v[116:119], v[192:207]
    ds_write_b32 v25, v31
    v_mfma_f32_32x32x16_bf16 v[192:207], a[88:91], v[120:123], v[192:207]
    v_mfma_f32_32x32x16_bf16 v[192:207], a[92:95], v[124:127], v[192:207]
    s_waitcnt lgkmcnt(5)
    v_mfma_f32_32x32x16_bf16 v[208:223], a[96:99], v[96:99], v[80:95]
    s_cmp_eq_u32 s3, 1
    s_cbranch_scc1 L_fb2b
L_fbr2b:
    s_getpc_b64 s[12:13]
    s_cmp_ge_u32 s69, 43
    s_cbranch_scc0 L_crefresh
    v_mfma_f32_32x32x16_bf16 v[208:223], a[100:103], v[100:103], v[208:223]
    ds_read_b128 a[128:131], v32 offset:16384
    ds_read_b128 a[132:135], v33 offset:16384
    v_mfma_f32_32x32x16_bf16 v[208:223], a[104:107], v[104:107], v[208:223]
    ds_read_b128 a[136:139], v34 offset:16384
    v_exp_f32 v72, v192
    v_exp_f32 v73, v193
    v_exp_f32 v74, v194
    v_mfma_f32_32x32x16_bf16 v[208:223], a[108:111], v[108:111], v[208:223]
    ds_read_b128 a[140:143], v35 offset:16384
    ds_read_b128 a[144:147], v36 offset:16384
    v_exp_f32 v75, v195
    v_cvt_pk_bf16_f32 v128, v72, v73
    v_exp_f32 v76, v196
    s_waitcnt lgkmcnt(6)
    v_mfma_f32_32x32x16_bf16 v[208:223], a[112:115], v[112:115], v[208:223]
    ds_read_b128 a[148:151], v37 offset:16384
    ds_read_b128 a[152:155], v38 offset:16384
    v_add_f32 v27, v72, v74
    v_exp_f32 v77, v197
    v_add_f32 v28, v73, v75
    v_cvt_pk_bf16_f32 v129, v74, v75
    v_mfma_f32_32x32x16_bf16 v[208:223], a[116:119], v[116:119], v[208:223]
    ds_read_b128 a[156:159], v39 offset:16384
    v_exp_f32 v78, v198
    v_add_f32 v27, v27, v76
    v_exp_f32 v79, v199
    v_add_f32 v28, v28, v77
    v_mfma_f32_32x32x16_bf16 v[208:223], a[120:123], v[120:123], v[208:223]
    v_cvt_pk_bf16_f32 v130, v76, v77
    v_exp_f32 v72, v200
    v_add_f32 v27, v27, v78
    v_exp_f32 v73, v201
    v_add_f32 v28, v28, v79
    v_mfma_f32_32x32x16_bf16 v[208:223], a[124:127], v[124:127], v[208:223]
    v_cvt_pk_bf16_f32 v131, v78, v79
    v_exp_f32 v74, v202
    v_add_f32 v27, v27, v72
    v_exp_f32 v75, v203
    v_add_f32 v28, v28, v73
    s_waitcnt lgkmcnt(4)
    v_mfma_f32_32x32x16_bf16 v[224:239], a[128:131], v[96:99], v[80:95]
    s_getpc_b64 s[12:13]
    s_cmp_ge_u32 s69, 44
    s_cbranch_scc0 L_crefresh
    ds_read_b128 a[160:163], v32 offset:24576
    v_cvt_pk_bf16_f32 v132, v72, v73
    v_exp_f32 v76, v204
    v_add_f32 v27, v27, v74
    v_mfma_f32_32x32x16_bf16 v[224:239], a[132:135], v[100:103], v[224:239]
    ds_read_b128 a[164:167], v33 offset:24576
    ds_read_b128 a[168:171], v34 offset:24576
    v_exp_f32 v77, v205
    v_add_f32 v28, v28, v75
    v_cvt_pk_bf16_f32 v133, v74, v75
    v_mfma_f32_32x32x16_bf16 v[224:239], a[136:139], v[104:107], v[224:239]
    ds_read_b128 a[172:175], v35 offset:24576
    ds_read_b128 a[176:179], v36 offset:24576
    v_exp_f32 v78, v206
    v_add_f32 v27, v27, v76
    v_exp_f32 v79, v207
    v_mfma_f32_32x32x16_bf16 v[224:239], a[140:143], v[108:111], v[224:239]
    ds_read_b128 a[180:183], v37 offset:24576
    ds_read_b128 a[184:187], v38 offset:24576
    v_add_f32 v28, v28, v77
    v_cvt_pk_bf16_f32 v134, v76, v77
    v_exp_f32 v72, v208
    v_add_f32 v27, v27, v78
    s_waitcnt lgkmcnt(7)
    v_mfma_f32_32x32x16_bf16 v[224:239], a[144:147], v[112:115], v[224:239]
    ds_read_b128 a[188:191], v39 offset:24576
    v_mov_b32 v31, 23
    v_exp_f32 v73, v209
    v_add_f32 v28, v28, v79
    v_cvt_pk_bf16_f32 v135, v78, v79
    v_mfma_f32_32x32x16_bf16 v[224:239], a[148:151], v[116:119], v[224:239]
    ds_write_b32 v25, v31
    v_exp_f32 v74, v210
    v_add_f32 v27, v27, v72
    v_exp_f32 v75, v211
    v_add_f32 v28, v28, v73
    v_mfma_f32_32x32x16_bf16 v[224:239], a[152:155], v[120:123], v[224:239]
    v_cvt_pk_bf16_f32 v136, v72, v73
    v_exp_f32 v76, v212
    v_add_f32 v27, v27, v74
    v_exp_f32 v77, v213
    v_add_f32 v28, v28, v75
    v_mfma_f32_32x32x16_bf16 v[224:239], a[156:159], v[124:127], v[224:239]
    v_cvt_pk_bf16_f32 v137, v74, v75
    v_exp_f32 v78, v214
    v_add_f32 v27, v27, v76
    v_exp_f32 v79, v215
    v_add_f32 v28, v28, v77
    s_waitcnt lgkmcnt(5)
    v_mfma_f32_32x32x16_bf16 v[240:255], a[160:163], v[96:99], v[80:95]
    s_cmp_eq_u32 s79, 6
    s_cbranch_scc1 L_as6
L_na6:
    s_getpc_b64 s[12:13]
    s_cmp_ge_u32 s69, 45
    s_cbranch_scc0 L_crefresh
    ds_read_b64_tr_b16 a[192:193], v64 offset:0
    ds_read_b64_tr_b16 a[194:195], v64 offset:2048
    v_cvt_pk_bf16_f32 v138, v76, v77
    v_mfma_f32_32x32x16_bf16 v[240:255], a[164:167], v[100:103], v[240:255]
    ds_read_b64_tr_b16 a[196:197], v64 offset:4096
    ds_read_b64_tr_b16 a[198:199], v64 offset:6144
    ds_read_b64_tr_b16 a[200:201], v65 offset:0
    v_exp_f32 v72, v216
    v_add_f32 v27, v27, v78
    v_mfma_f32_32x32x16_bf16 v[240:255], a[168:171], v[104:107], v[240:255]
    ds_read_b64_tr_b16 a[202:203], v65 offset:2048
    ds_read_b64_tr_b16 a[204:205], v65 offset:4096
    ds_read_b64_tr_b16 a[206:207], v65 offset:6144
    v_exp_f32 v73, v217
    v_add_f32 v28, v28, v79
    v_cvt_pk_bf16_f32 v139, v78, v79
    v_mfma_f32_32x32x16_bf16 v[240:255], a[172:175], v[108:111], v[240:255]
    ds_read_b64_tr_b16 a[208:209], v66 offset:0
    ds_read_b64_tr_b16 a[210:211], v66 offset:2048
    ds_read_b64_tr_b16 a[212:213], v66 offset:4096
    v_exp_f32 v74, v218
    v_add_f32 v27, v27, v72
    s_waitcnt lgkmcnt(12)
    v_mfma_f32_32x32x16_bf16 v[240:255], a[176:179], v[112:115], v[240:255]
    ds_read_b64_tr_b16 a[214:215], v66 offset:6144
    ds_read_b64_tr_b16 a[216:217], v67 offset:0
    ds_read_b64_tr_b16 a[218:219], v67 offset:2048
    v_exp_f32 v75, v219
    v_add_f32 v28, v28, v73
    v_cvt_pk_bf16_f32 v140, v72, v73
    v_mfma_f32_32x32x16_bf16 v[240:255], a[180:183], v[116:119], v[240:255]
    ds_read_b64_tr_b16 a[220:221], v67 offset:4096
    ds_read_b64_tr_b16 a[222:223], v67 offset:6144
    s_cmp_eq_u32 s3, 2
    s_cbranch_scc1 L_fb3a
L_fbr3a:
    v_exp_f32 v76, v220
    v_add_f32 v27, v27, v74
    v_mfma_f32_32x32x16_bf16 v[240:255], a[184:187], v[120:123], v[240:255]
    v_exp_f32 v77, v221
    v_add_f32 v28, v28, v75
    v_cvt_pk_bf16_f32 v141, v74, v75
    v_exp_f32 v78, v222
    v_add_f32 v27, v27, v76
    v_mfma_f32_32x32x16_bf16 v[240:255], a[188:191], v[124:127], v[240:255]
    v_exp_f32 v79, v223
    v_add_f32 v28, v28, v77
    v_cvt_pk_bf16_f32 v142, v76, v77
    v_exp_f32 v72, v224
    v_add_f32 v27, v27, v78
    s_waitcnt lgkmcnt(0)
    v_mfma_f32_32x32x16_bf16 a[0:15], a[192:195], v[160:163], a[0:15]
    s_getpc_b64 s[12:13]
    s_cmp_ge_u32 s69, 46
    s_cbranch_scc0 L_crefresh
    ds_read_b64_tr_b16 a[224:225], v64 offset:8192
    ds_read_b64_tr_b16 a[226:227], v64 offset:10240
    ds_read_b64_tr_b16 a[228:229], v64 offset:12288
    v_exp_f32 v73, v225
    v_mfma_f32_32x32x16_bf16 a[16:31], a[200:203], v[160:163], a[16:31]
    ds_read_b64_tr_b16 a[230:231], v64 offset:14336
    ds_read_b64_tr_b16 a[232:233], v65 offset:8192
    ds_read_b64_tr_b16 a[234:235], v65 offset:10240
    v_add_f32 v28, v28, v79
    v_cvt_pk_bf16_f32 v143, v78, v79
    v_exp_f32 v74, v226
    v_mfma_f32_32x32x16_bf16 a[32:47], a[208:211], v[160:163], a[32:47]
    ds_read_b64_tr_b16 a[236:237], v65 offset:12288
    ds_read_b64_tr_b16 a[238:239], v65 offset:14336
    ds_read_b64_tr_b16 a[240:241], v66 offset:8192
    v_add_f32 v27, v27, v72
    v_exp_f32 v75, v227
    v_add_f32 v28, v28, v73
    v_mfma_f32_32x32x16_bf16 a[48:63], a[216:219], v[160:163], a[48:63]
    ds_read_b64_tr_b16 a[242:243], v66 offset:10240
    ds_read_b64_tr_b16 a[244:245], v66 offset:12288
    ds_read_b64_tr_b16 a[246:247], v66 offset:14336
    v_cvt_pk_bf16_f32 v144, v72, v73
    v_exp_f32 v76, v228
    v_add_f32 v27, v27, v74
    v_mfma_f32_32x32x16_bf16 a[0:15], a[196:199], v[164:167], a[0:15]
    ds_read_b64_tr_b16 a[248:249], v67 offset:8192
    ds_read_b64_tr_b16 a[250:251], v67 offset:10240
    ds_read_b64_tr_b16 a[252:253], v67 offset:12288
    v_exp_f32 v77, v229
    v_add_f32 v28, v28, v75
    v_cvt_pk_bf16_f32 v145, v74, v75
    v_mfma_f32_32x32x16_bf16 a[16:31], a[204:207], v[164:167], a[16:31]
    ds_read_b64_tr_b16 a[254:255], v67 offset:14336
    v_mov_b32 v31, 24
    ds_write_b32 v25, v31
    v_exp_f32 v78, v230
    v_add_f32 v27, v27, v76
    v_mfma_f32_32x32x16_bf16 a[32:47], a[212:215], v[164:167], a[32:47]
    v_exp_f32 v79, v231
    v_add_f32 v28, v28, v77
    v_cvt_pk_bf16_f32 v146, v76, v77
    v_exp_f32 v72, v232
    v_add_f32 v27, v27, v78
    v_mfma_f32_32x32x16_bf16 a[48:63], a[220:223], v[164:167], a[48:63]
    v_exp_f32 v73, v233
    v_add_f32 v28, v28, v79
    v_cvt_pk_bf16_f32 v147, v78, v79
    v_exp_f32 v74, v234
    v_add_f32 v27, v27, v72
    s_waitcnt lgkmcnt(1)
    v_mfma_f32_32x32x16_bf16 a[0:15], a[224:227], v[168:171], a[0:15]
    s_cmp_eq_u32 s3, 2
    s_cbranch_scc1 L_fb3b
L_fbr3b:
    s_getpc_b64 s[12:13]
    s_cmp_ge_u32 s69, 47
    s_cbranch_scc0 L_crefresh
    ds_read_b64_tr_b16 a[192:193], v64 offset:16384
    v_exp_f32 v75, v235
    v_mfma_f32_32x32x16_bf16 a[16:31], a[232:235], v[168:171], a[16:31]
    ds_read_b64_tr_b16 a[194:195], v64 offset:18432
    ds_read_b64_tr_b16 a[196:197], v64 offset:20480
    ds_read_b64_tr_b16 a[198:199], v64 offset:22528
    v_add_f32 v28, v28, v73
    v_cvt_pk_bf16_f32 v148, v72, v73
    v_exp_f32 v76, v236
    v_mfma_f32_32x32x16_bf16 a[32:47], a[240:243], v[168:171], a[32:47]
    ds_read_b64_tr_b16 a[200:201], v65 offset:16384
    ds_read_b64_tr_b16 a[202:203], v65 offset:18432
    ds_read_b64_tr_b16 a[204:205], v65 offset:20480
    v_add_f32 v27, v27, v74
    v_exp_f32 v77, v237
    v_add_f32 v28, v28, v75
    v_mfma_f32_32x32x16_bf16 a[48:63], a[248:251], v[168:171], a[48:63]
    ds_read_b64_tr_b16 a[206:207], v65 offset:22528
    ds_read_b64_tr_b16 a[208:209], v66 offset:16384
    ds_read_b64_tr_b16 a[210:211], v66 offset:18432
    v_cvt_pk_bf16_f32 v149, v74, v75
    v_exp_f32 v78, v238
    v_add_f32 v27, v27, v76
    v_mfma_f32_32x32x16_bf16 a[0:15], a[228:231], v[172:175], a[0:15]
    ds_read_b64_tr_b16 a[212:213], v66 offset:20480
    ds_read_b64_tr_b16 a[214:215], v66 offset:22528
    ds_read_b64_tr_b16 a[216:217], v67 offset:16384
    v_exp_f32 v79, v239
    v_add_f32 v28, v28, v77
    v_cvt_pk_bf16_f32 v150, v76, v77
    v_mfma_f32_32x32x16_bf16 a[16:31], a[236:239], v[172:175], a[16:31]
    ds_read_b64_tr_b16 a[218:219], v67 offset:18432
    ds_read_b64_tr_b16 a[220:221], v67 offset:20480
    ds_read_b64_tr_b16 a[222:223], v67 offset:22528
    v_exp_f32 v72, v240
    v_add_f32 v27, v27, v78
    v_mfma_f32_32x32x16_bf16 a[32:47], a[244:247], v[172:175], a[32:47]
    v_exp_f32 v73, v241
    v_add_f32 v28, v28, v79
    v_cvt_pk_bf16_f32 v151, v78, v79
    v_exp_f32 v74, v242
    v_add_f32 v27, v27, v72
    v_mfma_f32_32x32x16_bf16 a[48:63], a[252:255], v[172:175], a[48:63]
    v_exp_f32 v75, v243
    v_add_f32 v28, v28, v73
    v_cvt_pk_bf16_f32 v152, v72, v73
    v_exp_f32 v76, v244
    v_add_f32 v27, v27, v74
    s_waitcnt lgkmcnt(0)
    v_mfma_f32_32x32x16_bf16 a[0:15], a[192:195], v[176:179], a[0:15]
    s_getpc_b64 s[12:13]
    s_cmp_ge_u32 s69, 48
    s_cbranch_scc0 L_crefresh
    ds_read_b64_tr_b16 a[224:225], v60 offset:8192
    ds_read_b64_tr_b16 a[226:227], v60 offset:10240
    ds_read_b64_tr_b16 a[228:229], v60 offset:12288
    v_exp_f32 v77, v245
    v_mfma_f32_32x32x16_bf16 a[16:31], a[200:203], v[176:179], a[16:31]
    ds_read_b64_tr_b16 a[230:231], v60 offset:14336
    ds_read_b64_tr_b16 a[232:233], v61 offset:8192
    ds_read_b64_tr_b16 a[234:235], v61 offset:10240
    v_add_f32 v28, v28, v75
    v_cvt_pk_bf16_f32 v153, v74, v75
    v_exp_f32 v78, v246
    v_mfma_f32_32x32x16_bf16 a[32:47], a[208:211], v[176:179], a[32:47]
    ds_read_b64_tr_b16 a[236:237], v61 offset:12288
    ds_read_b64_tr_b16 a[238:239], v61 offset:14336
    ds_read_b64_tr_b16 a[240:241], v62 offset:8192
    v_add_f32 v27, v27, v76
    v_exp_f32 v79, v247
    v_add_f32 v28, v28, v77
    v_mfma_f32_32x32x16_bf16 a[48:63], a[216:219], v[176:179], a[48:63]
    ds_read_b64_tr_b16 a[242:243], v62 offset:10240
    ds_read_b64_tr_b16 a[244:245], v62 offset:12288
    ds_read_b64_tr_b16 a[246:247], v62 offset:14336
    v_cvt_pk_bf16_f32 v154, v76, v77
    v_exp_f32 v72, v248
    v_add_f32 v27, v27, v78
    v_mfma_f32_32x32x16_bf16 a[0:15], a[196:199], v[180:183], a[0:15]
    ds_read_b64_tr_b16 a[248:249], v63 offset:8192
    ds_read_b64_tr_b16 a[250:251], v63 offset:10240
    ds_read_b64_tr_b16 a[252:253], v63 offset:12288
    v_exp_f32 v73, v249
    v_add_f32 v28, v28, v79
    v_cvt_pk_bf16_f32 v155, v78, v79
    v_mfma_f32_32x32x16_bf16 a[16:31], a[204:207], v[180:183], a[16:31]
    ds_read_b64_tr_b16 a[254:255], v63 offset:14336
    v_mov_b32 v31, 25
    ds_write_b32 v25, v31
    v_exp_f32 v74, v250
    v_add_f32 v27, v27, v72
    v_mfma_f32_32x32x16_bf16 a[32:47], a[212:215], v[180:183], a[32:47]
    v_exp_f32 v75, v251
    v_add_f32 v28, v28, v73
    v_cvt_pk_bf16_f32 v156, v72, v73
    v_exp_f32 v76, v252
    v_add_f32 v27, v27, v74
    v_mfma_f32_32x32x16_bf16 a[48:63], a[220:223], v[180:183], a[48:63]
    v_exp_f32 v77, v253
    v_add_f32 v28, v28, v75
    v_cvt_pk_bf16_f32 v157, v74, v75
    v_exp_f32 v78, v254
    v_add_f32 v27, v27, v76
    s_waitcnt lgkmcnt(1)
    v_mfma_f32_32x32x16_bf16 a[0:15], a[224:227], v[184:187], a[0:15]
    s_cmp_eq_u32 s79, 7
    s_cbranch_scc1 L_as7
L_na7:
    s_getpc_b64 s[12:13]
    s_cmp_ge_u32 s69, 49
    s_cbranch_scc0 L_crefresh
    v_exp_f32 v79, v255
    v_add_f32 v28, v28, v77
    v_mfma_f32_32x32x16_bf16 a[16:31], a[232:235], v[184:187], a[16:31]
    ds_read_b128 a[64:67], v40 offset:16384
    ds_read_b128 a[68:71], v41 offset:16384
    v_cvt_pk_bf16_f32 v158, v76, v77
    v_add_f32 v27, v27, v78
    v_add_f32 v28, v28, v79
    v_cvt_pk_bf16_f32 v159, v78, v79
    v_mfma_f32_32x32x16_bf16 a[32:47], a[240:243], v[184:187], a[32:47]
    ds_read_b128 a[72:75], v42 offset:16384
    ds_read_b128 a[76:79], v43 offset:16384
    v_mfma_f32_32x32x16_bf16 a[48:63], a[248:251], v[184:187], a[48:63]
    ds_read_b128 a[80:83], v44 offset:16384
    ds_read_b128 a[84:87], v45 offset:16384
    v_mfma_f32_32x32x16_bf16 a[0:15], a[228:231], v[188:191], a[0:15]
    ds_read_b128 a[88:91], v46 offset:16384
    ds_read_b128 a[92:95], v47 offset:16384
    v_mfma_f32_32x32x16_bf16 a[16:31], a[236:239], v[188:191], a[16:31]
    s_cmp_eq_u32 s3, 1
    s_cbranch_scc1 L_fb4a
L_fbr4a:
    v_mfma_f32_32x32x16_bf16 a[32:47], a[244:247], v[188:191], a[32:47]
    v_mfma_f32_32x32x16_bf16 a[48:63], a[252:255], v[188:191], a[48:63]
    v_add_f32 v27, v27, v28
    v_cmp_lt_f32 vcc, s11, v27
    s_cbranch_vccnz L_rs4
L_skip4:
    v_add_f32 v29, v29, v27
    s_waitcnt lgkmcnt(4)
    v_mfma_f32_32x32x16_bf16 v[192:207], a[64:67], v[96:99], v[80:95]
    s_getpc_b64 s[12:13]
    s_cmp_ge_u32 s69, 50
    s_cbranch_scc0 L_crefresh
    ds_read_b128 a[96:99], v40 offset:32768
    v_mfma_f32_32x32x16_bf16 v[192:207], a[68:71], v[100:103], v[192:207]
    ds_read_b128 a[100:103], v41 offset:32768
    ds_read_b128 a[104:107], v42 offset:32768
    v_mfma_f32_32x32x16_bf16 v[192:207], a[72:75], v[104:107], v[192:207]
    ds_read_b128 a[108:111], v43 offset:32768
    ds_read_b128 a[112:115], v44 offset:32768
    v_mfma_f32_32x32x16_bf16 v[192:207], a[76:79], v[108:111], v[192:207]
    ds_read_b128 a[116:119], v45 offset:32768
    ds_read_b128 a[120:123], v46 offset:32768
    s_waitcnt lgkmcnt(7)
    v_mfma_f32_32x32x16_bf16 v[192:207], a[80:83], v[112:115], v[192:207]
    ds_read_b128 a[124:127], v47 offset:32768
    v_mov_b32 v31, 26
    v_mfma_f32_32x32x16_bf16 v[192:207], a[84:87], v[116:119], v[192:207]
    ds_write_b32 v25, v31
    v_mfma_f32_32x32x16_bf16 v[192:207], a[88:91], v[120:123], v[192:207]
    v_mfma_f32_32x32x16_bf16 v[192:207], a[92:95], v[124:127], v[192:207]
    s_waitcnt lgkmcnt(5)
    v_mfma_f32_32x32x16_bf16 v[208:223], a[96:99], v[96:99], v[80:95]
    s_cmp_eq_u32 s3, 1
    s_cbranch_scc1 L_fb4b
L_fbr4b:
    s_getpc_b64 s[12:13]
    s_cmp_ge_u32 s69, 51
    s_cbranch_scc0 L_crefresh
    v_mfma_f32_32x32x16_bf16 v[208:223], a[100:103], v[100:103], v[208:223]
    ds_read_b128 a[128:131], v40 offset:40960
    ds_read_b128 a[132:135], v41 offset:40960
    v_mfma_f32_32x32x16_bf16 v[208:223], a[104:107], v[104:107], v[208:223]
    ds_read_b128 a[136:139], v42 offset:40960
    v_exp_f32 v72, v192
    v_exp_f32 v73, v193
    v_exp_f32 v74, v194
    v_mfma_f32_32x32x16_bf16 v[208:223], a[108:111], v[108:111], v[208:223]
    ds_read_b128 a[140:143], v43 offset:40960
    ds_read_b128 a[144:147], v44 offset:40960
    v_exp_f32 v75, v195
    v_cvt_pk_bf16_f32 v160, v72, v73
    v_exp_f32 v76, v196
    s_waitcnt lgkmcnt(6)
    v_mfma_f32_32x32x16_bf16 v[208:223], a[112:115], v[112:115], v[208:223]
    ds_read_b128 a[148:151], v45 offset:40960
    ds_read_b128 a[152:155], v46 offset:40960
    v_add_f32 v27, v72, v74
    v_exp_f32 v77, v197
    v_add_f32 v28, v73, v75
    v_cvt_pk_bf16_f32 v161, v74, v75
    v_mfma_f32_32x32x16_bf16 v[208:223], a[116:119], v[116:119], v[208:223]
    ds_read_b128 a[156:159], v47 offset:40960
    v_exp_f32 v78, v198
    v_add_f32 v27, v27, v76
    v_exp_f32 v79, v199
    v_add_f32 v28, v28, v77
    v_mfma_f32_32x32x16_bf16 v[208:223], a[120:123], v[120:123], v[208:223]
    v_cvt_pk_bf16_f32 v162, v76, v77
    v_exp_f32 v72, v200
    v_add_f32 v27, v27, v78
    v_exp_f32 v73, v201
    v_add_f32 v28, v28, v79
    v_mfma_f32_32x32x16_bf16 v[208:223], a[124:127], v[124:127], v[208:223]
    v_cvt_pk_bf16_f32 v163, v78, v79
    v_exp_f32 v74, v202
    v_add_f32 v27, v27, v72
    v_exp_f32 v75, v203
    v_add_f32 v28, v28, v73
    s_waitcnt lgkmcnt(4)
    v_mfma_f32_32x32x16_bf16 v[224:239], a[128:131], v[96:99], v[80:95]
    s_getpc_b64 s[12:13]
    s_cmp_ge_u32 s69, 52
    s_cbranch_scc0 L_crefresh
    ds_read_b128 a[160:163], v40 offset:49152
    v_cvt_pk_bf16_f32 v164, v72, v73
    v_exp_f32 v76, v204
    v_add_f32 v27, v27, v74
    v_mfma_f32_32x32x16_bf16 v[224:239], a[132:135], v[100:103], v[224:239]
    ds_read_b128 a[164:167], v41 offset:49152
    ds_read_b128 a[168:171], v42 offset:49152
    v_exp_f32 v77, v205
    v_add_f32 v28, v28, v75
    v_cvt_pk_bf16_f32 v165, v74, v75
    v_mfma_f32_32x32x16_bf16 v[224:239], a[136:139], v[104:107], v[224:239]
    ds_read_b128 a[172:175], v43 offset:49152
    ds_read_b128 a[176:179], v44 offset:49152
    v_exp_f32 v78, v206
    v_add_f32 v27, v27, v76
    v_exp_f32 v79, v207
    v_mfma_f32_32x32x16_bf16 v[224:239], a[140:143], v[108:111], v[224:239]
    ds_read_b128 a[180:183], v45 offset:49152
    ds_read_b128 a[184:187], v46 offset:49152
    v_add_f32 v28, v28, v77
    v_cvt_pk_bf16_f32 v166, v76, v77
    v_exp_f32 v72, v208
    v_add_f32 v27, v27, v78
    s_waitcnt lgkmcnt(7)
    v_mfma_f32_32x32x16_bf16 v[224:239], a[144:147], v[112:115], v[224:239]
    ds_read_b128 a[188:191], v47 offset:49152
    v_mov_b32 v31, 27
    v_exp_f32 v73, v209
    v_add_f32 v28, v28, v79
    v_cvt_pk_bf16_f32 v167, v78, v79
    v_mfma_f32_32x32x16_bf16 v[224:239], a[148:151], v[116:119], v[224:239]
    ds_write_b32 v25, v31
    v_exp_f32 v74, v210
    v_add_f32 v27, v27, v72
    v_exp_f32 v75, v211
    v_add_f32 v28, v28, v73
    v_mfma_f32_32x32x16_bf16 v[224:239], a[152:155], v[120:123], v[224:239]
    v_cvt_pk_bf16_f32 v168, v72, v73
    v_exp_f32 v76, v212
    v_add_f32 v27, v27, v74
    v_exp_f32 v77, v213
    v_add_f32 v28, v28, v75
    v_mfma_f32_32x32x16_bf16 v[224:239], a[156:159], v[124:127], v[224:239]
    v_cvt_pk_bf16_f32 v169, v74, v75
    v_exp_f32 v78, v214
    v_add_f32 v27, v27, v76
    v_exp_f32 v79, v215
    v_add_f32 v28, v28, v77
    s_waitcnt lgkmcnt(5)
    v_mfma_f32_32x32x16_bf16 v[240:255], a[160:163], v[96:99], v[80:95]
    s_getpc_b64 s[12:13]
    s_cmp_ge_u32 s69, 53
    s_cbranch_scc0 L_crefresh
    ds_read_b64_tr_b16 a[192:193], v60 offset:57344
    ds_read_b64_tr_b16 a[194:195], v60 offset:59392
    v_cvt_pk_bf16_f32 v170, v76, v77
    v_exp_f32 v72, v216
    v_mfma_f32_32x32x16_bf16 v[240:255], a[164:167], v[100:103], v[240:255]
    ds_read_b64_tr_b16 a[196:197], v60 offset:61440
    ds_read_b64_tr_b16 a[198:199], v60 offset:63488
    ds_read_b64_tr_b16 a[200:201], v61 offset:57344
    v_add_f32 v27, v27, v78
    v_exp_f32 v73, v217
    v_add_f32 v28, v28, v79
    v_mfma_f32_32x32x16_bf16 v[240:255], a[168:171], v[104:107], v[240:255]
    ds_read_b64_tr_b16 a[202:203], v61 offset:59392
    ds_read_b64_tr_b16 a[204:205], v61 offset:61440
    ds_read_b64_tr_b16 a[206:207], v61 offset:63488
    v_cvt_pk_bf16_f32 v171, v78, v79
    v_exp_f32 v74, v218
    v_add_f32 v27, v27, v72
    v_mfma_f32_32x32x16_bf16 v[240:255], a[172:175], v[108:111], v[240:255]
    ds_read_b64_tr_b16 a[208:209], v62 offset:57344
    ds_read_b64_tr_b16 a[210:211], v62 offset:59392
    ds_read_b64_tr_b16 a[212:213], v62 offset:61440
    v_exp_f32 v75, v219
    v_add_f32 v28, v28, v73
    v_cvt_pk_bf16_f32 v172, v72, v73
    s_waitcnt lgkmcnt(12)
    v_mfma_f32_32x32x16_bf16 v[240:255], a[176:179], v[112:115], v[240:255]
    ds_read_b64_tr_b16 a[214:215], v62 offset:63488
    ds_read_b64_tr_b16 a[216:217], v63 offset:57344
    ds_read_b64_tr_b16 a[218:219], v63 offset:59392
    v_exp_f32 v76, v220
    v_add_f32 v27, v27, v74
    v_mfma_f32_32x32x16_bf16 v[240:255], a[180:183], v[116:119], v[240:255]
    ds_read_b64_tr_b16 a[220:221], v63 offset:61440
    ds_read_b64_tr_b16 a[222:223], v63 offset:63488
    s_cmp_eq_u32 s3, 2
    s_cbranch_scc1 L_fb5a
L_fbr5a:
    v_exp_f32 v77, v221
    v_add_f32 v28, v28, v75
    v_mfma_f32_32x32x16_bf16 v[240:255], a[184:187], v[120:123], v[240:255]
    v_cvt_pk_bf16_f32 v173, v74, v75
    v_exp_f32 v78, v222
    v_add_f32 v27, v27, v76
    v_exp_f32 v79, v223
    v_add_f32 v28, v28, v77
    v_mfma_f32_32x32x16_bf16 v[240:255], a[188:191], v[124:127], v[240:255]
    v_cvt_pk_bf16_f32 v174, v76, v77
    v_exp_f32 v72, v224
    v_add_f32 v27, v27, v78
    v_exp_f32 v73, v225
    v_add_f32 v28, v28, v79
    s_waitcnt lgkmcnt(0)
    v_mfma_f32_32x32x16_bf16 a[0:15], a[192:195], v[128:131], a[0:15]
    s_getpc_b64 s[12:13]
    s_cmp_ge_u32 s69, 54
    s_cbranch_scc0 L_crefresh
    ds_read_b64_tr_b16 a[224:225], v56 offset:40960
    ds_read_b64_tr_b16 a[226:227], v56 offset:43008
    ds_read_b64_tr_b16 a[228:229], v56 offset:45056
    v_cvt_pk_bf16_f32 v175, v78, v79
    v_mfma_f32_32x32x16_bf16 a[16:31], a[200:203], v[128:131], a[16:31]
    ds_read_b64_tr_b16 a[230:231], v56 offset:47104
    ds_read_b64_tr_b16 a[232:233], v57 offset:40960
    ds_read_b64_tr_b16 a[234:235], v57 offset:43008
    v_exp_f32 v74, v226
    v_add_f32 v27, v27, v72
    v_mfma_f32_32x32x16_bf16 a[32:47], a[208:211], v[128:131], a[32:47]
    ds_read_b64_tr_b16 a[236:237], v57 offset:45056
    ds_read_b64_tr_b16 a[238:239], v57 offset:47104
    ds_read_b64_tr_b16 a[240:241], v58 offset:40960
    v_exp_f32 v75, v227
    v_add_f32 v28, v28, v73
    v_cvt_pk_bf16_f32 v176, v72, v73
    v_mfma_f32_32x32x16_bf16 a[48:63], a[216:219], v[128:131], a[48:63]
    ds_read_b64_tr_b16 a[242:243], v58 offset:43008
    ds_read_b64_tr_b16 a[244:245], v58 offset:45056
    ds_read_b64_tr_b16 a[246:247], v58 offset:47104
    v_exp_f32 v76, v228
    v_add_f32 v27, v27, v74
    v_mfma_f32_32x32x16_bf16 a[0:15], a[196:199], v[132:135], a[0:15]
    ds_read_b64_tr_b16 a[248:249], v59 offset:40960
    ds_read_b64_tr_b16 a[250:251], v59 offset:43008
    ds_read_b64_tr_b16 a[252:253], v59 offset:45056
    v_exp_f32 v77, v229
    v_add_f32 v28, v28, v75
    v_cvt_pk_bf16_f32 v177, v74, v75
    v_mfma_f32_32x32x16_bf16 a[16:31], a[204:207], v[132:135], a[16:31]
    ds_read_b64_tr_b16 a[254:255], v59 offset:47104
    v_mov_b32 v31, 28
    ds_write_b32 v25, v31
    v_exp_f32 v78, v230
    v_add_f32 v27, v27, v76
    v_mfma_f32_32x32x16_bf16 a[32:47], a[212:215], v[132:135], a[32:47]
    v_exp_f32 v79, v231
    v_add_f32 v28, v28, v77
    v_cvt_pk_bf16_f32 v178, v76, v77
    v_exp_f32 v72, v232
    v_add_f32 v27, v27, v78
    v_mfma_f32_32x32x16_bf16 a[48:63], a[220:223], v[132:135], a[48:63]
    v_exp_f32 v73, v233
    v_add_f32 v28, v28, v79
    v_cvt_pk_bf16_f32 v179, v78, v79
    v_exp_f32 v74, v234
    v_add_f32 v27, v27, v72
    s_waitcnt lgkmcnt(1)
    v_mfma_f32_32x32x16_bf16 a[0:15], a[224:227], v[136:139], a[0:15]
    s_cmp_eq_u32 s3, 2
    s_cbranch_scc1 L_fb5b
L_fbr5b:
    s_getpc_b64 s[12:13]
    s_cmp_ge_u32 s69, 55
    s_cbranch_scc0 L_crefresh
    ds_read_b64_tr_b16 a[192:193], v56 offset:49152
    v_exp_f32 v75, v235
    v_mfma_f32_32x32x16_bf16 a[16:31], a[232:235], v[136:139], a[16:31]
    ds_read_b64_tr_b16 a[194:195], v56 offset:51200
    ds_read_b64_tr_b16 a[196:197], v56 offset:53248
    ds_read_b64_tr_b16 a[198:199], v56 offset:55296
    v_add_f32 v28, v28, v73
    v_cvt_pk_bf16_f32 v180, v72, v73
    v_exp_f32 v76, v236
    v_mfma_f32_32x32x16_bf16 a[32:47], a[240:243], v[136:139], a[32:47]
    ds_read_b64_tr_b16 a[200:201], v57 offset:49152
    ds_read_b64_tr_b16 a[202:203], v57 offset:51200
    ds_read_b64_tr_b16 a[204:205], v57 offset:53248
    v_add_f32 v27, v27, v74
    v_exp_f32 v77, v237
    v_add_f32 v28, v28, v75
    v_mfma_f32_32x32x16_bf16 a[48:63], a[248:251], v[136:139], a[48:63]
    ds_read_b64_tr_b16 a[206:207], v57 offset:55296
    ds_read_b64_tr_b16 a[208:209], v58 offset:49152
    ds_read_b64_tr_b16 a[210:211], v58 offset:51200
    v_cvt_pk_bf16_f32 v181, v74, v75
    v_exp_f32 v78, v238
    v_add_f32 v27, v27, v76
    v_mfma_f32_32x32x16_bf16 a[0:15], a[228:231], v[140:143], a[0:15]
    ds_read_b64_tr_b16 a[212:213], v58 offset:53248
    ds_read_b64_tr_b16 a[214:215], v58 offset:55296
    ds_read_b64_tr_b16 a[216:217], v59 offset:49152
    v_exp_f32 v79, v239
    v_add_f32 v28, v28, v77
    v_cvt_pk_bf16_f32 v182, v76, v77
    v_mfma_f32_32x32x16_bf16 a[16:31], a[236:239], v[140:143], a[16:31]
    ds_read_b64_tr_b16 a[218:219], v59 offset:51200
    ds_read_b64_tr_b16 a[220:221], v59 offset:53248
    ds_read_b64_tr_b16 a[222:223], v59 offset:55296
    v_exp_f32 v72, v240
    v_add_f32 v27, v27, v78
    v_mfma_f32_32x32x16_bf16 a[32:47], a[244:247], v[140:143], a[32:47]
    v_exp_f32 v73, v241
    v_add_f32 v28, v28, v79
    v_cvt_pk_bf16_f32 v183, v78, v79
    v_exp_f32 v74, v242
    v_add_f32 v27, v27, v72
    v_mfma_f32_32x32x16_bf16 a[48:63], a[252:255], v[140:143], a[48:63]
    v_exp_f32 v75, v243
    v_add_f32 v28, v28, v73
    v_cvt_pk_bf16_f32 v184, v72, v73
    v_exp_f32 v76, v244
    v_add_f32 v27, v27, v74
    s_waitcnt lgkmcnt(0)
    v_mfma_f32_32x32x16_bf16 a[0:15], a[192:195], v[144:147], a[0:15]
    s_getpc_b64 s[12:13]
    s_cmp_ge_u32 s69, 56
    s_cbranch_scc0 L_crefresh
    ds_read_b64_tr_b16 a[224:225], v56 offset:57344
    ds_read_b64_tr_b16 a[226:227], v56 offset:59392
    ds_read_b64_tr_b16 a[228:229], v56 offset:61440
    v_exp_f32 v77, v245
    v_mfma_f32_32x32x16_bf16 a[16:31], a[200:203], v[144:147], a[16:31]
    ds_read_b64_tr_b16 a[230:231], v56 offset:63488
    ds_read_b64_tr_b16 a[232:233], v57 offset:57344
    ds_read_b64_tr_b16 a[234:235], v57 offset:59392
    v_add_f32 v28, v28, v75
    v_cvt_pk_bf16_f32 v185, v74, v75
    v_exp_f32 v78, v246
    v_mfma_f32_32x32x16_bf16 a[32:47], a[208:211], v[144:147], a[32:47]
    ds_read_b64_tr_b16 a[236:237], v57 offset:61440
    ds_read_b64_tr_b16 a[238:239], v57 offset:63488
    ds_read_b64_tr_b16 a[240:241], v58 offset:57344
    v_add_f32 v27, v27, v76
    v_exp_f32 v79, v247
    v_add_f32 v28, v28, v77
    v_mfma_f32_32x32x16_bf16 a[48:63], a[216:219], v[144:147], a[48:63]
    ds_read_b64_tr_b16 a[242:243], v58 offset:59392
    ds_read_b64_tr_b16 a[244:245], v58 offset:61440
    ds_read_b64_tr_b16 a[246:247], v58 offset:63488
    v_cvt_pk_bf16_f32 v186, v76, v77
    v_exp_f32 v72, v248
    v_add_f32 v27, v27, v78
    v_mfma_f32_32x32x16_bf16 a[0:15], a[196:199], v[148:151], a[0:15]
    ds_read_b64_tr_b16 a[248:249], v59 offset:57344
    ds_read_b64_tr_b16 a[250:251], v59 offset:59392
    ds_read_b64_tr_b16 a[252:253], v59 offset:61440
    v_exp_f32 v73, v249
    v_add_f32 v28, v28, v79
    v_cvt_pk_bf16_f32 v187, v78, v79
    v_mfma_f32_32x32x16_bf16 a[16:31], a[204:207], v[148:151], a[16:31]
    ds_read_b64_tr_b16 a[254:255], v59 offset:63488
    v_mov_b32 v31, 29
    ds_write_b32 v25, v31
    v_exp_f32 v74, v250
    v_add_f32 v27, v27, v72
    v_mfma_f32_32x32x16_bf16 a[32:47], a[212:215], v[148:151], a[32:47]
    v_exp_f32 v75, v251
    v_add_f32 v28, v28, v73
    v_cvt_pk_bf16_f32 v188, v72, v73
    v_exp_f32 v76, v252
    v_add_f32 v27, v27, v74
    v_mfma_f32_32x32x16_bf16 a[48:63], a[220:223], v[148:151], a[48:63]
    v_exp_f32 v77, v253
    v_add_f32 v28, v28, v75
    v_cvt_pk_bf16_f32 v189, v74, v75
    v_exp_f32 v78, v254
    v_add_f32 v27, v27, v76
    s_waitcnt lgkmcnt(1)
    v_mfma_f32_32x32x16_bf16 a[0:15], a[224:227], v[152:155], a[0:15]
    s_getpc_b64 s[12:13]
    s_cmp_ge_u32 s69, 57
    s_cbranch_scc0 L_crefresh
    ds_read_b128 a[64:67], v32 offset:8192
    v_exp_f32 v79, v255
    v_add_f32 v28, v28, v77
    v_cvt_pk_bf16_f32 v190, v76, v77
    v_mfma_f32_32x32x16_bf16 a[16:31], a[232:235], v[152:155], a[16:31]
    ds_read_b128 a[68:71], v33 offset:8192
    ds_read_b128 a[72:75], v34 offset:8192
    v_add_f32 v27, v27, v78
    v_add_f32 v28, v28, v79
    v_cvt_pk_bf16_f32 v191, v78, v79
    v_mfma_f32_32x32x16_bf16 a[32:47], a[240:243], v[152:155], a[32:47]
    ds_read_b128 a[76:79], v35 offset:8192
    ds_read_b128 a[80:83], v36 offset:8192
    v_mfma_f32_32x32x16_bf16 a[48:63], a[248:251], v[152:155], a[48:63]
    ds_read_b128 a[84:87], v37 offset:8192
    ds_read_b128 a[88:91], v38 offset:8192
    v_mfma_f32_32x32x16_bf16 a[0:15], a[228:231], v[156:159], a[0:15]
    ds_read_b128 a[92:95], v39 offset:8192
    v_mov_b32 v31, 30
    v_mfma_f32_32x32x16_bf16 a[16:31], a[236:239], v[156:159], a[16:31]
    ds_write_b32 v25, v31
    s_cmp_eq_u32 s3, 1
    s_cbranch_scc1 L_fb6a
L_fbr6a:
    v_mfma_f32_32x32x16_bf16 a[32:47], a[244:247], v[156:159], a[32:47]
    v_mfma_f32_32x32x16_bf16 a[48:63], a[252:255], v[156:159], a[48:63]
    v_add_f32 v27, v27, v28
    v_cmp_lt_f32 vcc, s11, v27
    s_cbranch_vccnz L_rs5
L_skip5:
    v_add_f32 v29, v29, v27
    s_waitcnt lgkmcnt(5)
    v_mfma_f32_32x32x16_bf16 v[192:207], a[64:67], v[96:99], v[80:95]
    s_getpc_b64 s[12:13]
    s_cmp_ge_u32 s69, 58
    s_cbranch_scc0 L_crefresh
    ds_read_b128 a[96:99], v40 offset:0
    v_mfma_f32_32x32x16_bf16 v[192:207], a[68:71], v[100:103], v[192:207]
    ds_read_b128 a[100:103], v41 offset:0
    ds_read_b128 a[104:107], v42 offset:0
    v_mfma_f32_32x32x16_bf16 v[192:207], a[72:75], v[104:107], v[192:207]
    ds_read_b128 a[108:111], v43 offset:0
    ds_read_b128 a[112:115], v44 offset:0
    v_mfma_f32_32x32x16_bf16 v[192:207], a[76:79], v[108:111], v[192:207]
    ds_read_b128 a[116:119], v45 offset:0
    ds_read_b128 a[120:123], v46 offset:0
    s_waitcnt lgkmcnt(8)
    v_mfma_f32_32x32x16_bf16 v[192:207], a[80:83], v[112:115], v[192:207]
    ds_read_b128 a[124:127], v47 offset:0
    v_mov_b32 v31, 31
    v_mfma_f32_32x32x16_bf16 v[192:207], a[84:87], v[116:119], v[192:207]
    ds_write_b32 v25, v31
    v_mfma_f32_32x32x16_bf16 v[192:207], a[88:91], v[120:123], v[192:207]
    v_mfma_f32_32x32x16_bf16 v[192:207], a[92:95], v[124:127], v[192:207]
    s_waitcnt lgkmcnt(5)
    v_mfma_f32_32x32x16_bf16 v[208:223], a[96:99], v[96:99], v[80:95]
    s_cmp_eq_u32 s3, 1
    s_cbranch_scc1 L_fb6b
L_fbr6b:
    s_getpc_b64 s[12:13]
    s_cmp_ge_u32 s69, 59
    s_cbranch_scc0 L_crefresh
    v_mfma_f32_32x32x16_bf16 v[208:223], a[100:103], v[100:103], v[208:223]
    ds_read_b128 a[128:131], v32 offset:24576
    ds_read_b128 a[132:135], v33 offset:24576
    v_mfma_f32_32x32x16_bf16 v[208:223], a[104:107], v[104:107], v[208:223]
    ds_read_b128 a[136:139], v34 offset:24576
    ds_read_b128 a[140:143], v35 offset:24576
    v_exp_f32 v72, v192
    v_exp_f32 v73, v193
    v_mfma_f32_32x32x16_bf16 v[208:223], a[108:111], v[108:111], v[208:223]
    ds_read_b128 a[144:147], v36 offset:24576
    ds_read_b128 a[148:151], v37 offset:24576
    v_exp_f32 v74, v194
    v_exp_f32 v75, v195
    v_cvt_pk_bf16_f32 v128, v72, v73
    s_waitcnt lgkmcnt(7)
    v_mfma_f32_32x32x16_bf16 v[208:223], a[112:115], v[112:115], v[208:223]
    ds_read_b128 a[152:155], v38 offset:24576
    ds_read_b128 a[156:159], v39 offset:24576
    v_exp_f32 v76, v196
    v_add_f32 v27, v72, v74
    v_exp_f32 v77, v197
    v_mfma_f32_32x32x16_bf16 v[208:223], a[116:119], v[116:119], v[208:223]
    v_mov_b32 v31, 32
    ds_write_b32 v25, v31
    v_add_f32 v28, v73, v75
    v_cvt_pk_bf16_f32 v129, v74, v75
    v_exp_f32 v78, v198
    v_add_f32 v27, v27, v76
    v_mfma_f32_32x32x16_bf16 v[208:223], a[120:123], v[120:123], v[208:223]
    v_exp_f32 v79, v199
    v_add_f32 v28, v28, v77
    v_cvt_pk_bf16_f32 v130, v76, v77
    v_exp_f32 v72, v200
    v_add_f32 v27, v27, v78
    v_mfma_f32_32x32x16_bf16 v[208:223], a[124:127], v[124:127], v[208:223]
    v_exp_f32 v73, v201
    v_add_f32 v28, v28, v79
    v_cvt_pk_bf16_f32 v131, v78, v79
    v_exp_f32 v74, v202
    v_add_f32 v27, v27, v72
    s_waitcnt lgkmcnt(5)
    v_mfma_f32_32x32x16_bf16 v[224:239], a[128:131], v[96:99], v[80:95]
    s_getpc_b64 s[12:13]
    s_cmp_ge_u32 s69, 60
    s_cbranch_scc0 L_crefresh
    ds_read_b128 a[160:163], v48 offset:0
    v_exp_f32 v75, v203
    v_add_f32 v28, v28, v73
    v_cvt_pk_bf16_f32 v132, v72, v73
    v_mfma_f32_32x32x16_bf16 v[224:239], a[132:135], v[100:103], v[224:239]
    ds_read_b128 a[164:167], v49 offset:0
    ds_read_b128 a[168:171], v50 offset:0
    v_exp_f32 v76, v204
    v_add_f32 v27, v27, v74
    v_exp_f32 v77, v205
    v_mfma_f32_32x32x16_bf16 v[224:239], a[136:139], v[104:107], v[224:239]
    ds_read_b128 a[172:175], v51 offset:0
    ds_read_b128 a[176:179], v52 offset:0
    v_add_f32 v28, v28, v75
    v_cvt_pk_bf16_f32 v133, v74, v75
    v_exp_f32 v78, v206
    v_add_f32 v27, v27, v76
    v_mfma_f32_32x32x16_bf16 v[224:239], a[140:143], v[108:111], v[224:239]
    ds_read_b128 a[180:183], v53 offset:0
    ds_read_b128 a[184:187], v54 offset:0
    v_exp_f32 v79, v207
    v_add_f32 v28, v28, v77
    v_cvt_pk_bf16_f32 v134, v76, v77
    s_waitcnt lgkmcnt(8)
    v_mfma_f32_32x32x16_bf16 v[224:239], a[144:147], v[112:115], v[224:239]
    ds_read_b128 a[188:191], v55 offset:0
    v_mov_b32 v31, 33
    v_exp_f32 v72, v208
    v_add_f32 v27, v27, v78
    v_exp_f32 v73, v209
    v_mfma_f32_32x32x16_bf16 v[224:239], a[148:151], v[116:119], v[224:239]
    ds_write_b32 v25, v31
    v_add_f32 v28, v28, v79
    v_cvt_pk_bf16_f32 v135, v78, v79
    v_exp_f32 v74, v210
    v_add_f32 v27, v27, v72
    v_mfma_f32_32x32x16_bf16 v[224:239], a[152:155], v[120:123], v[224:239]
    v_exp_f32 v75, v211
    v_add_f32 v28, v28, v73
    v_cvt_pk_bf16_f32 v136, v72, v73
    v_exp_f32 v76, v212
    v_add_f32 v27, v27, v74
    v_mfma_f32_32x32x16_bf16 v[224:239], a[156:159], v[124:127], v[224:239]
    v_exp_f32 v77, v213
    v_add_f32 v28, v28, v75
    v_cvt_pk_bf16_f32 v137, v74, v75
    v_exp_f32 v78, v214
    v_add_f32 v27, v27, v76
    s_waitcnt lgkmcnt(5)
    v_mfma_f32_32x32x16_bf16 v[240:255], a[160:163], v[96:99], v[80:95]
    buffer_load_dword v71, off, s[48:51], s80 sc1
    s_getpc_b64 s[12:13]
    s_cmp_ge_u32 s69, 61
    s_cbranch_scc0 L_crefresh
    ds_read_b64_tr_b16 a[192:193], v64 offset:8192
    ds_read_b64_tr_b16 a[194:195], v64 offset:10240
    v_mfma_f32_32x32x16_bf16 v[240:255], a[164:167], v[100:103], v[240:255]
    ds_read_b64_tr_b16 a[196:197], v64 offset:12288
    ds_read_b64_tr_b16 a[198:199], v64 offset:14336
    ds_read_b64_tr_b16 a[200:201], v65 offset:8192
    v_exp_f32 v79, v215
    v_add_f32 v28, v28, v77
    v_cvt_pk_bf16_f32 v138, v76, v77
    v_mfma_f32_32x32x16_bf16 v[240:255], a[168:171], v[104:107], v[240:255]
    ds_read_b64_tr_b16 a[202:203], v65 offset:10240
    ds_read_b64_tr_b16 a[204:205], v65 offset:12288
    ds_read_b64_tr_b16 a[206:207], v65 offset:14336
    ds_read_b64_tr_b16 a[208:209], v66 offset:8192
    v_exp_f32 v72, v216
    v_add_f32 v27, v27, v78
    v_mfma_f32_32x32x16_bf16 v[240:255], a[172:175], v[108:111], v[240:255]
    ds_read_b64_tr_b16 a[210:211], v66 offset:10240
    ds_read_b64_tr_b16 a[212:213], v66 offset:12288
    ds_read_b64_tr_b16 a[214:215], v66 offset:14336
    v_exp_f32 v73, v217
    v_add_f32 v28, v28, v79
    v_cvt_pk_bf16_f32 v139, v78, v79
    s_waitcnt lgkmcnt(13)
    v_mfma_f32_32x32x16_bf16 v[240:255], a[176:179], v[112:115], v[240:255]
    ds_read_b64_tr_b16 a[216:217], v67 offset:8192
    ds_read_b64_tr_b16 a[218:219], v67 offset:10240
    ds_read_b64_tr_b16 a[220:221], v67 offset:12288
    ds_read_b64_tr_b16 a[222:223], v67 offset:14336
    v_exp_f32 v74, v218
    v_add_f32 v27, v27, v72
    v_mfma_f32_32x32x16_bf16 v[240:255], a[180:183], v[116:119], v[240:255]
    v_mov_b32 v31, 34
    ds_write_b32 v25, v31
    s_cmp_eq_u32 s3, 2
    s_cbranch_scc1 L_fb7a
L_fbr7a:
    v_exp_f32 v75, v219
    v_add_f32 v28, v28, v73
    v_mfma_f32_32x32x16_bf16 v[240:255], a[184:187], v[120:123], v[240:255]
    v_cvt_pk_bf16_f32 v140, v72, v73
    v_exp_f32 v76, v220
    v_add_f32 v27, v27, v74
    v_exp_f32 v77, v221
    v_add_f32 v28, v28, v75
    v_mfma_f32_32x32x16_bf16 v[240:255], a[188:191], v[124:127], v[240:255]
    v_cvt_pk_bf16_f32 v141, v74, v75
    v_exp_f32 v78, v222
    v_add_f32 v27, v27, v76
    v_exp_f32 v79, v223
    v_add_f32 v28, v28, v77
    s_waitcnt lgkmcnt(1)
    v_mfma_f32_32x32x16_bf16 a[0:15], a[192:195], v[160:163], a[0:15]
    s_getpc_b64 s[12:13]
    s_cmp_ge_u32 s69, 62
    s_cbranch_scc0 L_crefresh
    ds_read_b64_tr_b16 a[224:225], v64 offset:16384
    ds_read_b64_tr_b16 a[226:227], v64 offset:18432
    ds_read_b64_tr_b16 a[228:229], v64 offset:20480
    v_cvt_pk_bf16_f32 v142, v76, v77
    v_mfma_f32_32x32x16_bf16 a[16:31], a[200:203], v[160:163], a[16:31]
    ds_read_b64_tr_b16 a[230:231], v64 offset:22528
    ds_read_b64_tr_b16 a[232:233], v65 offset:16384
    ds_read_b64_tr_b16 a[234:235], v65 offset:18432
    v_exp_f32 v72, v224
    v_add_f32 v27, v27, v78
    v_mfma_f32_32x32x16_bf16 a[32:47], a[208:211], v[160:163], a[32:47]
    ds_read_b64_tr_b16 a[236:237], v65 offset:20480
    ds_read_b64_tr_b16 a[238:239], v65 offset:22528
    ds_read_b64_tr_b16 a[240:241], v66 offset:16384
    v_exp_f32 v73, v225
    v_add_f32 v28, v28, v79
    v_cvt_pk_bf16_f32 v143, v78, v79
    v_mfma_f32_32x32x16_bf16 a[48:63], a[216:219], v[160:163], a[48:63]
    ds_read_b64_tr_b16 a[242:243], v66 offset:18432
    ds_read_b64_tr_b16 a[244:245], v66 offset:20480
    ds_read_b64_tr_b16 a[246:247], v66 offset:22528
    v_exp_f32 v74, v226
    v_add_f32 v27, v27, v72
    v_mfma_f32_32x32x16_bf16 a[0:15], a[196:199], v[164:167], a[0:15]
    ds_read_b64_tr_b16 a[248:249], v67 offset:16384
    ds_read_b64_tr_b16 a[250:251], v67 offset:18432
    ds_read_b64_tr_b16 a[252:253], v67 offset:20480
    v_exp_f32 v75, v227
    v_add_f32 v28, v28, v73
    v_cvt_pk_bf16_f32 v144, v72, v73
    v_mfma_f32_32x32x16_bf16 a[16:31], a[204:207], v[164:167], a[16:31]
    ds_read_b64_tr_b16 a[254:255], v67 offset:22528
    v_mov_b32 v31, 35
    ds_write_b32 v25, v31
    v_exp_f32 v76, v228
    v_add_f32 v27, v27, v74
    v_mfma_f32_32x32x16_bf16 a[32:47], a[212:215], v[164:167], a[32:47]
    v_exp_f32 v77, v229
    v_add_f32 v28, v28, v75
    v_cvt_pk_bf16_f32 v145, v74, v75
    v_exp_f32 v78, v230
    v_add_f32 v27, v27, v76
    v_mfma_f32_32x32x16_bf16 a[48:63], a[220:223], v[164:167], a[48:63]
    v_exp_f32 v79, v231
    v_add_f32 v28, v28, v77
    v_cvt_pk_bf16_f32 v146, v76, v77
    v_exp_f32 v72, v232
    v_add_f32 v27, v27, v78
    s_waitcnt lgkmcnt(1)
    v_mfma_f32_32x32x16_bf16 a[0:15], a[224:227], v[168:171], a[0:15]
    s_cmp_eq_u32 s3, 2
    s_cbranch_scc1 L_fb7b
L_fbr7b:
    s_getpc_b64 s[12:13]
    s_cmp_ge_u32 s69, 63
    s_cbranch_scc0 L_crefresh
    ds_read_b64_tr_b16 a[192:193], v60 offset:16384
    ds_read_b64_tr_b16 a[194:195], v60 offset:18432
    v_mfma_f32_32x32x16_bf16 a[16:31], a[232:235], v[168:171], a[16:31]
    ds_read_b64_tr_b16 a[196:197], v60 offset:20480
    ds_read_b64_tr_b16 a[198:199], v60 offset:22528
    ds_read_b64_tr_b16 a[200:201], v61 offset:16384
    v_exp_f32 v73, v233
    v_add_f32 v28, v28, v79
    v_cvt_pk_bf16_f32 v147, v78, v79
    v_mfma_f32_32x32x16_bf16 a[32:47], a[240:243], v[168:171], a[32:47]
    ds_read_b64_tr_b16 a[202:203], v61 offset:18432
    ds_read_b64_tr_b16 a[204:205], v61 offset:20480
    ds_read_b64_tr_b16 a[206:207], v61 offset:22528
    v_exp_f32 v74, v234
    v_add_f32 v27, v27, v72
    v_mfma_f32_32x32x16_bf16 a[48:63], a[248:251], v[168:171], a[48:63]
    ds_read_b64_tr_b16 a[208:209], v62 offset:16384
    ds_read_b64_tr_b16 a[210:211], v62 offset:18432
    ds_read_b64_tr_b16 a[212:213], v62 offset:20480
    ds_read_b64_tr_b16 a[214:215], v62 offset:22528
    v_exp_f32 v75, v235
    v_add_f32 v28, v28, v73
    v_mfma_f32_32x32x16_bf16 a[0:15], a[228:231], v[172:175], a[0:15]
    ds_read_b64_tr_b16 a[216:217], v63 offset:16384
    ds_read_b64_tr_b16 a[218:219], v63 offset:18432
    ds_read_b64_tr_b16 a[220:221], v63 offset:20480
    v_cvt_pk_bf16_f32 v148, v72, v73
    v_exp_f32 v76, v236
    v_add_f32 v27, v27, v74
    v_mfma_f32_32x32x16_bf16 a[16:31], a[236:239], v[172:175], a[16:31]
    ds_read_b64_tr_b16 a[222:223], v63 offset:22528
    v_mov_b32 v31, 36
    ds_write_b32 v25, v31
    v_exp_f32 v77, v237
    v_add_f32 v28, v28, v75
    v_cvt_pk_bf16_f32 v149, v74, v75
    v_mfma_f32_32x32x16_bf16 a[32:47], a[244:247], v[172:175], a[32:47]
    v_exp_f32 v78, v238
    v_add_f32 v27, v27, v76
    v_exp_f32 v79, v239
    v_add_f32 v28, v28, v77
    v_cvt_pk_bf16_f32 v150, v76, v77
    v_mfma_f32_32x32x16_bf16 a[48:63], a[252:255], v[172:175], a[48:63]
    v_exp_f32 v72, v240
    v_add_f32 v27, v27, v78
    v_exp_f32 v73, v241
    v_add_f32 v28, v28, v79
    v_cvt_pk_bf16_f32 v151, v78, v79
    s_waitcnt lgkmcnt(1)
    v_mfma_f32_32x32x16_bf16 a[0:15], a[192:195], v[176:179], a[0:15]
    s_getpc_b64 s[12:13]
    s_cmp_ge_u32 s69, 64
    s_cbranch_scc0 L_crefresh
    ds_read_b64_tr_b16 a[224:225], v60 offset:32768
    ds_read_b64_tr_b16 a[226:227], v60 offset:34816
    ds_read_b64_tr_b16 a[228:229], v60 offset:36864
    v_exp_f32 v74, v242
    v_mfma_f32_32x32x16_bf16 a[16:31], a[200:203], v[176:179], a[16:31]
    ds_read_b64_tr_b16 a[230:231], v60 offset:38912
    ds_read_b64_tr_b16 a[232:233], v61 offset:32768
    ds_read_b64_tr_b16 a[234:235], v61 offset:34816
    v_add_f32 v27, v27, v72
    v_exp_f32 v75, v243
    v_add_f32 v28, v28, v73
    v_mfma_f32_32x32x16_bf16 a[32:47], a[208:211], v[176:179], a[32:47]
    ds_read_b64_tr_b16 a[236:237], v61 offset:36864
    ds_read_b64_tr_b16 a[238:239], v61 offset:38912
    ds_read_b64_tr_b16 a[240:241], v62 offset:32768
    v_cvt_pk_bf16_f32 v152, v72, v73
    v_exp_f32 v76, v244
    v_add_f32 v27, v27, v74
    v_mfma_f32_32x32x16_bf16 a[48:63], a[216:219], v[176:179], a[48:63]
    ds_read_b64_tr_b16 a[242:243], v62 offset:34816
    ds_read_b64_tr_b16 a[244:245], v62 offset:36864
    ds_read_b64_tr_b16 a[246:247], v62 offset:38912
    v_exp_f32 v77, v245
    v_add_f32 v28, v28, v75
    v_cvt_pk_bf16_f32 v153, v74, v75
    v_mfma_f32_32x32x16_bf16 a[0:15], a[196:199], v[180:183], a[0:15]
    ds_read_b64_tr_b16 a[248:249], v63 offset:32768
    ds_read_b64_tr_b16 a[250:251], v63 offset:34816
    ds_read_b64_tr_b16 a[252:253], v63 offset:36864
    v_exp_f32 v78, v246
    v_add_f32 v27, v27, v76
    v_mfma_f32_32x32x16_bf16 a[16:31], a[204:207], v[180:183], a[16:31]
    ds_read_b64_tr_b16 a[254:255], v63 offset:38912
    v_mov_b32 v31, 37
    ds_write_b32 v25, v31
    v_exp_f32 v79, v247
    v_add_f32 v28, v28, v77
    v_cvt_pk_bf16_f32 v154, v76, v77
    v_mfma_f32_32x32x16_bf16 a[32:47], a[212:215], v[180:183], a[32:47]
    v_exp_f32 v72, v248
    v_add_f32 v27, v27, v78
    v_exp_f32 v73, v249
    v_add_f32 v28, v28, v79
    v_cvt_pk_bf16_f32 v155, v78, v79
    v_mfma_f32_32x32x16_bf16 a[48:63], a[220:223], v[180:183], a[48:63]
    v_exp_f32 v74, v250
    v_add_f32 v27, v27, v72
    v_exp_f32 v75, v251
    v_add_f32 v28, v28, v73
    v_cvt_pk_bf16_f32 v156, v72, v73
    s_waitcnt lgkmcnt(1)
    v_mfma_f32_32x32x16_bf16 a[0:15], a[224:227], v[184:187], a[0:15]
    s_getpc_b64 s[12:13]
    s_cmp_ge_u32 s69, 65
    s_cbranch_scc0 L_crefresh
    ds_read_b128 a[64:67], v40 offset:49152
    v_exp_f32 v76, v252
    v_add_f32 v27, v27, v74
    v_mfma_f32_32x32x16_bf16 a[16:31], a[232:235], v[184:187], a[16:31]
    ds_read_b128 a[68:71], v41 offset:49152
    ds_read_b128 a[72:75], v42 offset:49152
    v_exp_f32 v77, v253
    v_add_f32 v28, v28, v75
    v_cvt_pk_bf16_f32 v157, v74, v75
    v_mfma_f32_32x32x16_bf16 a[32:47], a[240:243], v[184:187], a[32:47]
    ds_read_b128 a[76:79], v43 offset:49152
    ds_read_b128 a[80:83], v44 offset:49152
    v_exp_f32 v78, v254
    v_add_f32 v27, v27, v76
    v_exp_f32 v79, v255
    v_mfma_f32_32x32x16_bf16 a[48:63], a[248:251], v[184:187], a[48:63]
    ds_read_b128 a[84:87], v45 offset:49152
    ds_read_b128 a[88:91], v46 offset:49152
    v_add_f32 v28, v28, v77
    v_cvt_pk_bf16_f32 v158, v76, v77
    v_add_f32 v27, v27, v78
    v_add_f32 v28, v28, v79
    v_cvt_pk_bf16_f32 v159, v78, v79
    v_mfma_f32_32x32x16_bf16 a[0:15], a[228:231], v[188:191], a[0:15]
    ds_read_b128 a[92:95], v47 offset:49152
    v_mov_b32 v31, 38
    v_mfma_f32_32x32x16_bf16 a[16:31], a[236:239], v[188:191], a[16:31]
    ds_write_b32 v25, v31
    s_cmp_eq_u32 s3, 1
    s_cbranch_scc1 L_fb8a
L_fbr8a:
    v_mfma_f32_32x32x16_bf16 a[32:47], a[244:247], v[188:191], a[32:47]
    v_mfma_f32_32x32x16_bf16 a[48:63], a[252:255], v[188:191], a[48:63]
    v_add_f32 v27, v27, v28
    v_cmp_lt_f32 vcc, s11, v27
    s_cbranch_vccnz L_rs6
L_skip6:
    v_add_f32 v29, v29, v27
    s_waitcnt lgkmcnt(5)
    v_mfma_f32_32x32x16_bf16 v[192:207], a[64:67], v[96:99], v[80:95]
    s_getpc_b64 s[12:13]
    s_cmp_ge_u32 s69, 66
    s_cbranch_scc0 L_crefresh
    ds_read_b128 a[96:99], v32 offset:40960
    v_mfma_f32_32x32x16_bf16 v[192:207], a[68:71], v[100:103], v[192:207]
    ds_read_b128 a[100:103], v33 offset:40960
    ds_read_b128 a[104:107], v34 offset:40960
    v_mfma_f32_32x32x16_bf16 v[192:207], a[72:75], v[104:107], v[192:207]
    ds_read_b128 a[108:111], v35 offset:40960
    ds_read_b128 a[112:115], v36 offset:40960
    v_mfma_f32_32x32x16_bf16 v[192:207], a[76:79], v[108:111], v[192:207]
    ds_read_b128 a[116:119], v37 offset:40960
    ds_read_b128 a[120:123], v38 offset:40960
    s_waitcnt lgkmcnt(8)
    v_mfma_f32_32x32x16_bf16 v[192:207], a[80:83], v[112:115], v[192:207]
    ds_read_b128 a[124:127], v39 offset:40960
    v_mov_b32 v31, 39
    v_mfma_f32_32x32x16_bf16 v[192:207], a[84:87], v[116:119], v[192:207]
    ds_write_b32 v25, v31
    v_mfma_f32_32x32x16_bf16 v[192:207], a[88:91], v[120:123], v[192:207]
    v_mfma_f32_32x32x16_bf16 v[192:207], a[92:95], v[124:127], v[192:207]
    s_waitcnt lgkmcnt(5)
    v_mfma_f32_32x32x16_bf16 v[208:223], a[96:99], v[96:99], v[80:95]
    s_cmp_eq_u32 s3, 1
    s_cbranch_scc1 L_fb8b
L_fbr8b:
    s_getpc_b64 s[12:13]
    s_cmp_ge_u32 s69, 67
    s_cbranch_scc0 L_crefresh
    v_mfma_f32_32x32x16_bf16 v[208:223], a[100:103], v[100:103], v[208:223]
    ds_read_b128 a[128:131], v40 offset:57344
    ds_read_b128 a[132:135], v41 offset:57344
    v_mfma_f32_32x32x16_bf16 v[208:223], a[104:107], v[104:107], v[208:223]
    ds_read_b128 a[136:139], v42 offset:57344
    ds_read_b128 a[140:143], v43 offset:57344
    v_exp_f32 v72, v192
    v_exp_f32 v73, v193
    v_mfma_f32_32x32x16_bf16 v[208:223], a[108:111], v[108:111], v[208:223]
    ds_read_b128 a[144:147], v44 offset:57344
    ds_read_b128 a[148:151], v45 offset:57344
    v_exp_f32 v74, v194
    v_exp_f32 v75, v195
    v_cvt_pk_bf16_f32 v160, v72, v73
    s_waitcnt lgkmcnt(7)
    v_mfma_f32_32x32x16_bf16 v[208:223], a[112:115], v[112:115], v[208:223]
    ds_read_b128 a[152:155], v46 offset:57344
    ds_read_b128 a[156:159], v47 offset:57344
    v_exp_f32 v76, v196
    v_add_f32 v27, v72, v74
    v_exp_f32 v77, v197
    v_mfma_f32_32x32x16_bf16 v[208:223], a[116:119], v[116:119], v[208:223]
    v_mov_b32 v31, 40
    ds_write_b32 v25, v31
    v_add_f32 v28, v73, v75
    v_cvt_pk_bf16_f32 v161, v74, v75
    v_exp_f32 v78, v198
    v_add_f32 v27, v27, v76
    v_mfma_f32_32x32x16_bf16 v[208:223], a[120:123], v[120:123], v[208:223]
    v_exp_f32 v79, v199
    v_add_f32 v28, v28, v77
    v_cvt_pk_bf16_f32 v162, v76, v77
    v_exp_f32 v72, v200
    v_add_f32 v27, v27, v78
    v_mfma_f32_32x32x16_bf16 v[208:223], a[124:127], v[124:127], v[208:223]
    v_exp_f32 v73, v201
    v_add_f32 v28, v28, v79
    v_cvt_pk_bf16_f32 v163, v78, v79
    v_exp_f32 v74, v202
    v_add_f32 v27, v27, v72
    s_waitcnt lgkmcnt(5)
    v_mfma_f32_32x32x16_bf16 v[224:239], a[128:131], v[96:99], v[80:95]
    s_getpc_b64 s[12:13]
    s_cmp_ge_u32 s69, 68
    s_cbranch_scc0 L_crefresh
    ds_read_b128 a[160:163], v32 offset:57344
    v_exp_f32 v75, v203
    v_add_f32 v28, v28, v73
    v_cvt_pk_bf16_f32 v164, v72, v73
    v_mfma_f32_32x32x16_bf16 v[224:239], a[132:135], v[100:103], v[224:239]
    ds_read_b128 a[164:167], v33 offset:57344
    ds_read_b128 a[168:171], v34 offset:57344
    v_exp_f32 v76, v204
    v_add_f32 v27, v27, v74
    v_exp_f32 v77, v205
    v_mfma_f32_32x32x16_bf16 v[224:239], a[136:139], v[104:107], v[224:239]
    ds_read_b128 a[172:175], v35 offset:57344
    ds_read_b128 a[176:179], v36 offset:57344
    v_add_f32 v28, v28, v75
    v_cvt_pk_bf16_f32 v165, v74, v75
    v_exp_f32 v78, v206
    v_add_f32 v27, v27, v76
    v_mfma_f32_32x32x16_bf16 v[224:239], a[140:143], v[108:111], v[224:239]
    ds_read_b128 a[180:183], v37 offset:57344
    ds_read_b128 a[184:187], v38 offset:57344
    v_exp_f32 v79, v207
    v_add_f32 v28, v28, v77
    v_cvt_pk_bf16_f32 v166, v76, v77
    s_waitcnt lgkmcnt(8)
    v_mfma_f32_32x32x16_bf16 v[224:239], a[144:147], v[112:115], v[224:239]
    ds_read_b128 a[188:191], v39 offset:57344
    v_mov_b32 v31, 41
    v_exp_f32 v72, v208
    v_add_f32 v27, v27, v78
    v_exp_f32 v73, v209
    v_mfma_f32_32x32x16_bf16 v[224:239], a[148:151], v[116:119], v[224:239]
    ds_write_b32 v25, v31
    v_add_f32 v28, v28, v79
    v_cvt_pk_bf16_f32 v167, v78, v79
    v_exp_f32 v74, v210
    v_add_f32 v27, v27, v72
    v_mfma_f32_32x32x16_bf16 v[224:239], a[152:155], v[120:123], v[224:239]
    v_exp_f32 v75, v211
    v_add_f32 v28, v28, v73
    v_cvt_pk_bf16_f32 v168, v72, v73
    v_exp_f32 v76, v212
    v_add_f32 v27, v27, v74
    v_mfma_f32_32x32x16_bf16 v[224:239], a[156:159], v[124:127], v[224:239]
    v_exp_f32 v77, v213
    v_add_f32 v28, v28, v75
    v_cvt_pk_bf16_f32 v169, v74, v75
    v_exp_f32 v78, v214
    v_add_f32 v27, v27, v76
    s_waitcnt lgkmcnt(5)
    v_mfma_f32_32x32x16_bf16 v[240:255], a[160:163], v[96:99], v[80:95]
    s_waitcnt vmcnt(0)
    v_readfirstlane_b32 s9, v71
    s_nop 0
    s_bitcmp0_b32 s9, 5
    s_cbranch_scc1 L_initslow
L_initdone:
    s_lshr_b32 s78, s9, 24
    s_bfe_u32 s14, s9, 0x80008
    s_cmp_gt_u32 s14, 8
    s_cselect_b32 s14, 0x0f, 0
    s_xor_b32 s78, s78, s14
    s_bfe_u32 s14, s9, 0x80010
    s_cmp_gt_u32 s14, 8
    s_cselect_b32 s14, 0xf0, 0
    s_xor_b32 s78, s78, s14
    s_getpc_b64 s[12:13]
    s_cmp_ge_u32 s69, 69
    s_cbranch_scc0 L_crefresh
    ds_read_b64_tr_b16 a[192:193], v56 offset:8192
    ds_read_b64_tr_b16 a[194:195], v56 offset:10240
    v_mfma_f32_32x32x16_bf16 v[240:255], a[164:167], v[100:103], v[240:255]
    ds_read_b64_tr_b16 a[196:197], v56 offset:12288
    ds_read_b64_tr_b16 a[198:199], v56 offset:14336
    ds_read_b64_tr_b16 a[200:201], v57 offset:8192
    v_exp_f32 v79, v215
    v_add_f32 v28, v28, v77
    v_cvt_pk_bf16_f32 v170, v76, v77
    v_mfma_f32_32x32x16_bf16 v[240:255], a[168:171], v[104:107], v[240:255]
    ds_read_b64_tr_b16 a[202:203], v57 offset:10240
    ds_read_b64_tr_b16 a[204:205], v57 offset:12288
    ds_read_b64_tr_b16 a[206:207], v57 offset:14336
    ds_read_b64_tr_b16 a[208:209], v58 offset:8192
    v_exp_f32 v72, v216
    v_add_f32 v27, v27, v78
    v_mfma_f32_32x32x16_bf16 v[240:255], a[172:175], v[108:111], v[240:255]
    ds_read_b64_tr_b16 a[210:211], v58 offset:10240
    ds_read_b64_tr_b16 a[212:213], v58 offset:12288
    ds_read_b64_tr_b16 a[214:215], v58 offset:14336
    v_exp_f32 v73, v217
    v_add_f32 v28, v28, v79
    v_cvt_pk_bf16_f32 v171, v78, v79
    s_waitcnt lgkmcnt(13)
    v_mfma_f32_32x32x16_bf16 v[240:255], a[176:179], v[112:115], v[240:255]
    ds_read_b64_tr_b16 a[216:217], v59 offset:8192
    ds_read_b64_tr_b16 a[218:219], v59 offset:10240
    ds_read_b64_tr_b16 a[220:221], v59 offset:12288
    ds_read_b64_tr_b16 a[222:223], v59 offset:14336
    v_exp_f32 v74, v218
    v_add_f32 v27, v27, v72
    v_mfma_f32_32x32x16_bf16 v[240:255], a[180:183], v[116:119], v[240:255]
    v_mov_b32 v31, 42
    ds_write_b32 v25, v31
    s_cmp_eq_u32 s3, 2
    s_cbranch_scc1 L_fb9a
L_fbr9a:
    v_exp_f32 v75, v219
    v_add_f32 v28, v28, v73
    v_mfma_f32_32x32x16_bf16 v[240:255], a[184:187], v[120:123], v[240:255]
    v_cvt_pk_bf16_f32 v172, v72, v73
    v_exp_f32 v76, v220
    v_add_f32 v27, v27, v74
    v_exp_f32 v77, v221
    v_add_f32 v28, v28, v75
    v_mfma_f32_32x32x16_bf16 v[240:255], a[188:191], v[124:127], v[240:255]
    v_cvt_pk_bf16_f32 v173, v74, v75
    v_exp_f32 v78, v222
    v_add_f32 v27, v27, v76
    v_exp_f32 v79, v223
    v_add_f32 v28, v28, v77
    s_waitcnt lgkmcnt(1)
    v_mfma_f32_32x32x16_bf16 a[0:15], a[192:195], v[128:131], a[0:15]
    s_getpc_b64 s[12:13]
    s_cmp_ge_u32 s69, 70
    s_cbranch_scc0 L_crefresh
    ds_read_b64_tr_b16 a[224:225], v60 offset:0
    ds_read_b64_tr_b16 a[226:227], v60 offset:2048
    ds_read_b64_tr_b16 a[228:229], v60 offset:4096
    v_cvt_pk_bf16_f32 v174, v76, v77
    v_mfma_f32_32x32x16_bf16 a[16:31], a[200:203], v[128:131], a[16:31]
    ds_read_b64_tr_b16 a[230:231], v60 offset:6144
    ds_read_b64_tr_b16 a[232:233], v61 offset:0
    ds_read_b64_tr_b16 a[234:235], v61 offset:2048
    v_exp_f32 v72, v224
    v_add_f32 v27, v27, v78
    v_mfma_f32_32x32x16_bf16 a[32:47], a[208:211], v[128:131], a[32:47]
    ds_read_b64_tr_b16 a[236:237], v61 offset:4096
    ds_read_b64_tr_b16 a[238:239], v61 offset:6144
    ds_read_b64_tr_b16 a[240:241], v62 offset:0
    v_exp_f32 v73, v225
    v_add_f32 v28, v28, v79
    v_cvt_pk_bf16_f32 v175, v78, v79
    v_mfma_f32_32x32x16_bf16 a[48:63], a[216:219], v[128:131], a[48:63]
    ds_read_b64_tr_b16 a[242:243], v62 offset:2048
    ds_read_b64_tr_b16 a[244:245], v62 offset:4096
    ds_read_b64_tr_b16 a[246:247], v62 offset:6144
    v_exp_f32 v74, v226
    v_add_f32 v27, v27, v72
    v_mfma_f32_32x32x16_bf16 a[0:15], a[196:199], v[132:135], a[0:15]
    ds_read_b64_tr_b16 a[248:249], v63 offset:0
    ds_read_b64_tr_b16 a[250:251], v63 offset:2048
    ds_read_b64_tr_b16 a[252:253], v63 offset:4096
    v_exp_f32 v75, v227
    v_add_f32 v28, v28, v73
    v_cvt_pk_bf16_f32 v176, v72, v73
    v_mfma_f32_32x32x16_bf16 a[16:31], a[204:207], v[132:135], a[16:31]
    ds_read_b64_tr_b16 a[254:255], v63 offset:6144
    v_mov_b32 v31, 43
    ds_write_b32 v25, v31
    v_exp_f32 v76, v228
    v_add_f32 v27, v27, v74
    v_mfma_f32_32x32x16_bf16 a[32:47], a[212:215], v[132:135], a[32:47]
    v_exp_f32 v77, v229
    v_add_f32 v28, v28, v75
    v_cvt_pk_bf16_f32 v177, v74, v75
    v_exp_f32 v78, v230
    v_add_f32 v27, v27, v76
    v_mfma_f32_32x32x16_bf16 a[48:63], a[220:223], v[132:135], a[48:63]
    v_exp_f32 v79, v231
    v_add_f32 v28, v28, v77
    v_cvt_pk_bf16_f32 v178, v76, v77
    v_exp_f32 v72, v232
    v_add_f32 v27, v27, v78
    s_waitcnt lgkmcnt(1)
    v_mfma_f32_32x32x16_bf16 a[0:15], a[224:227], v[136:139], a[0:15]
    s_cmp_eq_u32 s3, 2
    s_cbranch_scc1 L_fb9b
L_fbr9b:
    s_getpc_b64 s[12:13]
    s_cmp_ge_u32 s69, 71
    s_cbranch_scc0 L_crefresh
    ds_read_b64_tr_b16 a[192:193], v64 offset:0
    ds_read_b64_tr_b16 a[194:195], v64 offset:2048
    v_mfma_f32_32x32x16_bf16 a[16:31], a[232:235], v[136:139], a[16:31]
    ds_read_b64_tr_b16 a[196:197], v64 offset:4096
    ds_read_b64_tr_b16 a[198:199], v64 offset:6144
    ds_read_b64_tr_b16 a[200:201], v65 offset:0
    v_exp_f32 v73, v233
    v_add_f32 v28, v28, v79
    v_cvt_pk_bf16_f32 v179, v78, v79
    v_mfma_f32_32x32x16_bf16 a[32:47], a[240:243], v[136:139], a[32:47]
    ds_read_b64_tr_b16 a[202:203], v65 offset:2048
    ds_read_b64_tr_b16 a[204:205], v65 offset:4096
    ds_read_b64_tr_b16 a[206:207], v65 offset:6144
    v_exp_f32 v74, v234
    v_add_f32 v27, v27, v72
    v_mfma_f32_32x32x16_bf16 a[48:63], a[248:251], v[136:139], a[48:63]
    ds_read_b64_tr_b16 a[208:209], v66 offset:0
    ds_read_b64_tr_b16 a[210:211], v66 offset:2048
    ds_read_b64_tr_b16 a[212:213], v66 offset:4096
    ds_read_b64_tr_b16 a[214:215], v66 offset:6144
    v_exp_f32 v75, v235
    v_add_f32 v28, v28, v73
    v_mfma_f32_32x32x16_bf16 a[0:15], a[228:231], v[140:143], a[0:15]
    ds_read_b64_tr_b16 a[216:217], v67 offset:0
    ds_read_b64_tr_b16 a[218:219], v67 offset:2048
    ds_read_b64_tr_b16 a[220:221], v67 offset:4096
    v_cvt_pk_bf16_f32 v180, v72, v73
    v_exp_f32 v76, v236
    v_add_f32 v27, v27, v74
    v_mfma_f32_32x32x16_bf16 a[16:31], a[236:239], v[140:143], a[16:31]
    ds_read_b64_tr_b16 a[222:223], v67 offset:6144
    v_mov_b32 v31, 44
    ds_write_b32 v25, v31
    v_exp_f32 v77, v237
    v_add_f32 v28, v28, v75
    v_cvt_pk_bf16_f32 v181, v74, v75
    v_mfma_f32_32x32x16_bf16 a[32:47], a[244:247], v[140:143], a[32:47]
    v_exp_f32 v78, v238
    v_add_f32 v27, v27, v76
    v_exp_f32 v79, v239
    v_add_f32 v28, v28, v77
    v_cvt_pk_bf16_f32 v182, v76, v77
    v_mfma_f32_32x32x16_bf16 a[48:63], a[252:255], v[140:143], a[48:63]
    v_exp_f32 v72, v240
    v_add_f32 v27, v27, v78
    v_exp_f32 v73, v241
    v_add_f32 v28, v28, v79
    v_cvt_pk_bf16_f32 v183, v78, v79
    s_waitcnt lgkmcnt(1)
    v_mfma_f32_32x32x16_bf16 a[0:15], a[192:195], v[144:147], a[0:15]
    s_getpc_b64 s[12:13]
    s_cmp_ge_u32 s69, 72
    s_cbranch_scc0 L_crefresh
    ds_read_b64_tr_b16 a[224:225], v64 offset:8192
    ds_read_b64_tr_b16 a[226:227], v64 offset:10240
    ds_read_b64_tr_b16 a[228:229], v64 offset:12288
    v_exp_f32 v74, v242
    v_mfma_f32_32x32x16_bf16 a[16:31], a[200:203], v[144:147], a[16:31]
    ds_read_b64_tr_b16 a[230:231], v64 offset:14336
    ds_read_b64_tr_b16 a[232:233], v65 offset:8192
    ds_read_b64_tr_b16 a[234:235], v65 offset:10240
    v_add_f32 v27, v27, v72
    v_exp_f32 v75, v243
    v_add_f32 v28, v28, v73
    v_mfma_f32_32x32x16_bf16 a[32:47], a[208:211], v[144:147], a[32:47]
    ds_read_b64_tr_b16 a[236:237], v65 offset:12288
    ds_read_b64_tr_b16 a[238:239], v65 offset:14336
    ds_read_b64_tr_b16 a[240:241], v66 offset:8192
    v_cvt_pk_bf16_f32 v184, v72, v73
    v_exp_f32 v76, v244
    v_add_f32 v27, v27, v74
    v_mfma_f32_32x32x16_bf16 a[48:63], a[216:219], v[144:147], a[48:63]
    ds_read_b64_tr_b16 a[242:243], v66 offset:10240
    ds_read_b64_tr_b16 a[244:245], v66 offset:12288
    ds_read_b64_tr_b16 a[246:247], v66 offset:14336
    v_exp_f32 v77, v245
    v_add_f32 v28, v28, v75
    v_cvt_pk_bf16_f32 v185, v74, v75
    v_mfma_f32_32x32x16_bf16 a[0:15], a[196:199], v[148:151], a[0:15]
    ds_read_b64_tr_b16 a[248:249], v67 offset:8192
    ds_read_b64_tr_b16 a[250:251], v67 offset:10240
    ds_read_b64_tr_b16 a[252:253], v67 offset:12288
    v_exp_f32 v78, v246
    v_add_f32 v27, v27, v76
    v_mfma_f32_32x32x16_bf16 a[16:31], a[204:207], v[148:151], a[16:31]
    ds_read_b64_tr_b16 a[254:255], v67 offset:14336
    v_mov_b32 v31, 45
    ds_write_b32 v25, v31
    v_exp_f32 v79, v247
    v_add_f32 v28, v28, v77
    v_cvt_pk_bf16_f32 v186, v76, v77
    v_mfma_f32_32x32x16_bf16 a[32:47], a[212:215], v[148:151], a[32:47]
    v_exp_f32 v72, v248
    v_add_f32 v27, v27, v78
    v_exp_f32 v73, v249
    v_add_f32 v28, v28, v79
    v_cvt_pk_bf16_f32 v187, v78, v79
    v_mfma_f32_32x32x16_bf16 a[48:63], a[220:223], v[148:151], a[48:63]
    v_exp_f32 v74, v250
    v_add_f32 v27, v27, v72
    v_exp_f32 v75, v251
    v_add_f32 v28, v28, v73
    v_cvt_pk_bf16_f32 v188, v72, v73
    s_waitcnt lgkmcnt(1)
    v_mfma_f32_32x32x16_bf16 a[0:15], a[224:227], v[152:155], a[0:15]
    s_getpc_b64 s[12:13]
    s_cmp_ge_u32 s69, 73
    s_cbranch_scc0 L_crefresh
    ds_read_b64_tr_b16 a[192:193], v64 offset:16384
    ds_read_b64_tr_b16 a[194:195], v64 offset:18432
    ds_read_b64_tr_b16 a[196:197], v64 offset:20480
    v_exp_f32 v76, v252
    v_mfma_f32_32x32x16_bf16 a[16:31], a[232:235], v[152:155], a[16:31]
    ds_read_b64_tr_b16 a[198:199], v64 offset:22528
    ds_read_b64_tr_b16 a[200:201], v65 offset:16384
    ds_read_b64_tr_b16 a[202:203], v65 offset:18432
    v_add_f32 v27, v27, v74
    v_exp_f32 v77, v253
    v_add_f32 v28, v28, v75
    v_mfma_f32_32x32x16_bf16 a[32:47], a[240:243], v[152:155], a[32:47]
    ds_read_b64_tr_b16 a[204:205], v65 offset:20480
    ds_read_b64_tr_b16 a[206:207], v65 offset:22528
    ds_read_b64_tr_b16 a[208:209], v66 offset:16384
    v_cvt_pk_bf16_f32 v189, v74, v75
    v_exp_f32 v78, v254
    v_add_f32 v27, v27, v76
    v_mfma_f32_32x32x16_bf16 a[48:63], a[248:251], v[152:155], a[48:63]
    ds_read_b64_tr_b16 a[210:211], v66 offset:18432
    ds_read_b64_tr_b16 a[212:213], v66 offset:20480
    ds_read_b64_tr_b16 a[214:215], v66 offset:22528
    v_exp_f32 v79, v255
    v_add_f32 v28, v28, v77
    v_cvt_pk_bf16_f32 v190, v76, v77
    v_mfma_f32_32x32x16_bf16 a[0:15], a[228:231], v[156:159], a[0:15]
    ds_read_b64_tr_b16 a[216:217], v67 offset:16384
    ds_read_b64_tr_b16 a[218:219], v67 offset:18432
    ds_read_b64_tr_b16 a[220:221], v67 offset:20480
    v_add_f32 v27, v27, v78
    v_add_f32 v28, v28, v79
    v_cvt_pk_bf16_f32 v191, v78, v79
    v_mfma_f32_32x32x16_bf16 a[16:31], a[236:239], v[156:159], a[16:31]
    ds_read_b64_tr_b16 a[222:223], v67 offset:22528
    v_mov_b32 v31, 46
    ds_write_b32 v25, v31
    v_mfma_f32_32x32x16_bf16 a[32:47], a[244:247], v[156:159], a[32:47]
    v_mfma_f32_32x32x16_bf16 a[48:63], a[252:255], v[156:159], a[48:63]
    v_add_f32 v27, v27, v28
    v_cmp_lt_f32 vcc, s11, v27
    s_cbranch_vccnz L_rs7
L_skip7:
    v_add_f32 v29, v29, v27
    v_accvgpr_read_b32 v192, a0
    v_accvgpr_read_b32 v193, a1
    v_accvgpr_read_b32 v194, a2
    v_accvgpr_read_b32 v195, a3
    v_accvgpr_read_b32 v196, a4
    v_accvgpr_read_b32 v197, a5
    v_accvgpr_read_b32 v198, a6
    v_accvgpr_read_b32 v199, a7
    v_accvgpr_read_b32 v200, a8
    v_accvgpr_read_b32 v201, a9
    v_accvgpr_read_b32 v202, a10
    v_accvgpr_read_b32 v203, a11
    v_accvgpr_read_b32 v204, a12
    v_accvgpr_read_b32 v205, a13
    v_accvgpr_read_b32 v206, a14
    v_accvgpr_read_b32 v207, a15
    v_accvgpr_read_b32 v208, a16
    v_accvgpr_read_b32 v209, a17
    v_accvgpr_read_b32 v210, a18
    v_accvgpr_read_b32 v211, a19
    v_accvgpr_read_b32 v212, a20
    v_accvgpr_read_b32 v213, a21
    v_accvgpr_read_b32 v214, a22
    v_accvgpr_read_b32 v215, a23
    v_accvgpr_read_b32 v216, a24
    v_accvgpr_read_b32 v217, a25
    v_accvgpr_read_b32 v218, a26
    v_accvgpr_read_b32 v219, a27
    v_accvgpr_read_b32 v220, a28
    v_accvgpr_read_b32 v221, a29
    v_accvgpr_read_b32 v222, a30
    v_accvgpr_read_b32 v223, a31
    v_accvgpr_read_b32 v224, a32
    v_accvgpr_read_b32 v225, a33
    v_accvgpr_read_b32 v226, a34
    v_accvgpr_read_b32 v227, a35
    v_accvgpr_read_b32 v228, a36
    v_accvgpr_read_b32 v229, a37
    v_accvgpr_read_b32 v230, a38
    v_accvgpr_read_b32 v231, a39
    v_accvgpr_read_b32 v232, a40
    v_accvgpr_read_b32 v233, a41
    v_accvgpr_read_b32 v234, a42
    v_accvgpr_read_b32 v235, a43
    v_accvgpr_read_b32 v236, a44
    v_accvgpr_read_b32 v237, a45
    v_accvgpr_read_b32 v238, a46
    v_accvgpr_read_b32 v239, a47
    v_accvgpr_read_b32 v240, a48
    v_accvgpr_read_b32 v241, a49
    v_accvgpr_read_b32 v242, a50
    v_accvgpr_read_b32 v243, a51
    v_accvgpr_read_b32 v244, a52
    v_accvgpr_read_b32 v245, a53
    v_accvgpr_read_b32 v246, a54
    v_accvgpr_read_b32 v247, a55
    v_accvgpr_read_b32 v248, a56
    v_accvgpr_read_b32 v249, a57
    v_accvgpr_read_b32 v250, a58
    v_accvgpr_read_b32 v251, a59
    v_accvgpr_read_b32 v252, a60
    v_accvgpr_read_b32 v253, a61
    v_accvgpr_read_b32 v254, a62
    v_accvgpr_read_b32 v255, a63
    s_waitcnt lgkmcnt(1)
    v_mfma_f32_32x32x16_bf16 v[192:207], a[192:195], v[160:163], v[192:207]
    s_getpc_b64 s[12:13]
    s_cmp_ge_u32 s69, 74
    s_cbranch_scc0 L_crefresh
    ds_read_b64_tr_b16 a[224:225], v60 offset:32768
    ds_read_b64_tr_b16 a[226:227], v60 offset:34816
    ds_read_b64_tr_b16 a[228:229], v60 offset:36864
    v_mov_b32 v30, v29
    v_mfma_f32_32x32x16_bf16 v[192:207], a[196:199], v[164:167], v[192:207]
    ds_read_b64_tr_b16 a[230:231], v60 offset:38912
    ds_read_b64_tr_b16 a[232:233], v61 offset:32768
    ds_read_b64_tr_b16 a[234:235], v61 offset:34816
    v_mov_b32 v32, v69
    v_add_u32 v36, 0x10000, v69
    v_permlane32_swap_b32 v29, v30
    v_mfma_f32_32x32x16_bf16 v[208:223], a[200:203], v[160:163], v[208:223]
    ds_read_b64_tr_b16 a[236:237], v61 offset:36864
    ds_read_b64_tr_b16 a[238:239], v61 offset:38912
    ds_read_b64_tr_b16 a[240:241], v62 offset:32768
    v_add_f32 v29, v29, v30
    v_rcp_f32 v29, v29
    v_add_u32 v40, 0x20000, v69
    v_mfma_f32_32x32x16_bf16 v[208:223], a[204:207], v[164:167], v[208:223]
    ds_read_b64_tr_b16 a[242:243], v62 offset:34816
    ds_read_b64_tr_b16 a[244:245], v62 offset:36864
    ds_read_b64_tr_b16 a[246:247], v62 offset:38912
    v_xor_b32 v33, 64, v32
    v_xor_b32 v34, 128, v32
    v_xor_b32 v35, 192, v32
    v_mfma_f32_32x32x16_bf16 v[224:239], a[208:211], v[160:163], v[224:239]
    ds_read_b64_tr_b16 a[248:249], v63 offset:32768
    ds_read_b64_tr_b16 a[250:251], v63 offset:34816
    ds_read_b64_tr_b16 a[252:253], v63 offset:36864
    v_xor_b32 v37, 64, v36
    v_xor_b32 v38, 128, v36
    v_xor_b32 v39, 192, v36
    v_mfma_f32_32x32x16_bf16 v[224:239], a[212:215], v[164:167], v[224:239]
    ds_read_b64_tr_b16 a[254:255], v63 offset:38912
    v_mov_b32 v31, 47
    ds_write_b32 v25, v31
    v_xor_b32 v41, 64, v40
    v_xor_b32 v42, 128, v40
    v_xor_b32 v43, 192, v40
    v_mfma_f32_32x32x16_bf16 v[240:255], a[216:219], v[160:163], v[240:255]
    s_lshr_b32 s14, s78, s6
    s_and_b32 s14, s14, 1
    s_lshl_b32 s14, s14, 13
    s_add_u32 s73, s73, s14
    s_mul_i32 s70, s7, 49152
    s_add_u32 s70, s70, s73
    v_mfma_f32_32x32x16_bf16 v[240:255], a[220:223], v[164:167], v[240:255]
    s_add_u32 s71, s73, 0x40000
    s_add_u32 s71, s71, s77
    s_add_u32 s14, s14, s72
    s_add_u32 s56, s30, s14
    s_addc_u32 s57, s31, 0
    s_add_u32 s72, s76, s77
    s_waitcnt lgkmcnt(1)
    v_mfma_f32_32x32x16_bf16 v[192:207], a[224:227], v[168:171], v[192:207]
    s_getpc_b64 s[12:13]
    s_cmp_ge_u32 s69, 75
    s_cbranch_scc0 L_crefresh
    ds_read_b64_tr_b16 a[192:193], v60 offset:49152
    ds_read_b64_tr_b16 a[194:195], v60 offset:51200
    ds_read_b64_tr_b16 a[196:197], v60 offset:53248
    s_add_u32 s72, s72, 128
    v_mfma_f32_32x32x16_bf16 v[192:207], a[228:231], v[172:175], v[192:207]
    ds_read_b64_tr_b16 a[198:199], v60 offset:55296
    ds_read_b64_tr_b16 a[200:201], v61 offset:49152
    ds_read_b64_tr_b16 a[202:203], v61 offset:51200
    v_mov_b32 v15, s78
    v_lshrrev_b32 v15, v12, v15
    v_and_b32 v15, 1, v15
    v_mfma_f32_32x32x16_bf16 v[208:223], a[232:235], v[168:171], v[208:223]
    ds_read_b64_tr_b16 a[204:205], v61 offset:53248
    ds_read_b64_tr_b16 a[206:207], v61 offset:55296
    ds_read_b64_tr_b16 a[208:209], v62 offset:49152
    v_lshlrev_b32 v12, 19, v12
    v_lshl_or_b32 v12, v15, 13, v12
    v_lshl_add_u32 v12, v1, 2, v12
    v_mfma_f32_32x32x16_bf16 v[208:223], a[236:239], v[172:175], v[208:223]
    ds_read_b64_tr_b16 a[210:211], v62 offset:51200
    ds_read_b64_tr_b16 a[212:213], v62 offset:53248
    ds_read_b64_tr_b16 a[214:215], v62 offset:55296
    s_xor_b32 s9, s7, 1
    s_mul_i32 s9, s9, 49152
    s_add_u32 s42, s9, s73
    v_mfma_f32_32x32x16_bf16 v[224:239], a[240:243], v[168:171], v[224:239]
    ds_read_b64_tr_b16 a[216:217], v63 offset:49152
    ds_read_b64_tr_b16 a[218:219], v63 offset:51200
    ds_read_b64_tr_b16 a[220:221], v63 offset:53248
    s_xor_b32 s9, s7, 2
    s_mul_i32 s9, s9, 49152
    s_add_u32 s43, s9, s73
    v_mfma_f32_32x32x16_bf16 v[224:239], a[244:247], v[172:175], v[224:239]
    ds_read_b64_tr_b16 a[222:223], v63 offset:55296
    v_mov_b32 v31, 48
    ds_write_b32 v25, v31
    s_xor_b32 s9, s7, 3
    s_mul_i32 s9, s9, 49152
    s_add_u32 s45, s9, s73
    v_mfma_f32_32x32x16_bf16 v[240:255], a[248:251], v[168:171], v[240:255]
    s_mov_b32 s74, 0
    s_add_u32 s46, s70, 4096
    v_mov_b32 v20, v29
    v_mov_b32 v21, v29
    v_mfma_f32_32x32x16_bf16 v[240:255], a[252:255], v[172:175], v[240:255]
    s_waitcnt lgkmcnt(1)
    v_mfma_f32_32x32x16_bf16 v[192:207], a[192:195], v[176:179], v[192:207]
    v_mfma_f32_32x32x16_bf16 v[192:207], a[196:199], v[180:183], v[192:207]
    v_mfma_f32_32x32x16_bf16 v[208:223], a[200:203], v[176:179], v[208:223]
    v_mfma_f32_32x32x16_bf16 v[208:223], a[204:207], v[180:183], v[208:223]
    v_mfma_f32_32x32x16_bf16 v[224:239], a[208:211], v[176:179], v[224:239]
    v_mfma_f32_32x32x16_bf16 v[224:239], a[212:215], v[180:183], v[224:239]
    v_mfma_f32_32x32x16_bf16 v[240:255], a[216:219], v[176:179], v[240:255]
    v_mfma_f32_32x32x16_bf16 v[240:255], a[220:223], v[180:183], v[240:255]
    s_getpc_b64 s[12:13]
    s_cmp_ge_u32 s69, 76
    s_cbranch_scc0 L_crefresh
    ds_read_b64_tr_b16 a[224:225], v56 offset:40960
    ds_read_b64_tr_b16 a[226:227], v56 offset:43008
    ds_read_b64_tr_b16 a[228:229], v56 offset:45056
    ds_read_b64_tr_b16 a[230:231], v56 offset:47104
    ds_read_b64_tr_b16 a[232:233], v57 offset:40960
    ds_read_b64_tr_b16 a[234:235], v57 offset:43008
    ds_read_b64_tr_b16 a[236:237], v57 offset:45056
    ds_read_b64_tr_b16 a[238:239], v57 offset:47104
    ds_read_b64_tr_b16 a[240:241], v58 offset:40960
    ds_read_b64_tr_b16 a[242:243], v58 offset:43008
    ds_read_b64_tr_b16 a[244:245], v58 offset:45056
    ds_read_b64_tr_b16 a[246:247], v58 offset:47104
    ds_read_b64_tr_b16 a[248:249], v59 offset:40960
    ds_read_b64_tr_b16 a[250:251], v59 offset:43008
    ds_read_b64_tr_b16 a[252:253], v59 offset:45056
    ds_read_b64_tr_b16 a[254:255], v59 offset:47104
    s_waitcnt lgkmcnt(14)
    v_mfma_f32_32x32x16_bf16 v[192:207], a[224:227], v[184:187], v[192:207]
    s_waitcnt lgkmcnt(12)
    v_mfma_f32_32x32x16_bf16 v[192:207], a[228:231], v[188:191], v[192:207]
    s_waitcnt lgkmcnt(10)
    v_mfma_f32_32x32x16_bf16 v[208:223], a[232:235], v[184:187], v[208:223]
    s_waitcnt lgkmcnt(8)
    v_mfma_f32_32x32x16_bf16 v[208:223], a[236:239], v[188:191], v[208:223]
    s_waitcnt lgkmcnt(6)
    v_mfma_f32_32x32x16_bf16 v[224:239], a[240:243], v[184:187], v[224:239]
    s_waitcnt lgkmcnt(4)
    v_mfma_f32_32x32x16_bf16 v[224:239], a[244:247], v[188:191], v[224:239]
    s_nop 3
    v_mul_f32 v192, v192, v29
    v_mul_f32 v193, v193, v29
    v_mul_f32 v194, v194, v29
    v_mul_f32 v195, v195, v29
    v_mul_f32 v196, v196, v29
    v_mul_f32 v197, v197, v29
    v_mul_f32 v198, v198, v29
    v_mul_f32 v199, v199, v29
    v_cvt_pk_bf16_f32 v96, v192, v193
    v_cvt_pk_bf16_f32 v97, v194, v195
    v_cvt_pk_bf16_f32 v98, v196, v197
    v_cvt_pk_bf16_f32 v99, v198, v199
    buffer_store_dwordx4 v[96:99], v68, s[60:63], s70 offen sc1
    v_mul_f32 v200, v200, v29
    v_mul_f32 v201, v201, v29
    v_mul_f32 v202, v202, v29
    v_mul_f32 v203, v203, v29
    v_mul_f32 v204, v204, v29
    v_mul_f32 v205, v205, v29
    v_mul_f32 v206, v206, v29
    v_mul_f32 v207, v207, v29
    v_cvt_pk_bf16_f32 v100, v200, v201
    v_cvt_pk_bf16_f32 v101, v202, v203
    v_cvt_pk_bf16_f32 v102, v204, v205
    v_cvt_pk_bf16_f32 v103, v206, v207
    buffer_store_dwordx4 v[100:103], v68, s[60:63], s70 offen offset:1024 sc1
    s_waitcnt lgkmcnt(2)
    v_mfma_f32_32x32x16_bf16 v[240:255], a[248:251], v[184:187], v[240:255]
    s_waitcnt lgkmcnt(0)
    v_mfma_f32_32x32x16_bf16 v[240:255], a[252:255], v[188:191], v[240:255]
    v_mul_f32 v208, v208, v29
    v_mul_f32 v209, v209, v29
    v_mul_f32 v210, v210, v29
    v_mul_f32 v211, v211, v29
    v_mul_f32 v212, v212, v29
    v_mul_f32 v213, v213, v29
    v_mul_f32 v214, v214, v29
    v_mul_f32 v215, v215, v29
    v_cvt_pk_bf16_f32 v104, v208, v209
    v_cvt_pk_bf16_f32 v105, v210, v211
    v_cvt_pk_bf16_f32 v106, v212, v213
    v_cvt_pk_bf16_f32 v107, v214, v215
    buffer_store_dwordx4 v[104:107], v68, s[60:63], s70 offen offset:2048 sc1
    v_mul_f32 v216, v216, v29
    v_mul_f32 v217, v217, v29
    v_mul_f32 v218, v218, v29
    v_mul_f32 v219, v219, v29
    v_mul_f32 v220, v220, v29
    v_mul_f32 v221, v221, v29
    v_mul_f32 v222, v222, v29
    v_mul_f32 v223, v223, v29
    v_cvt_pk_bf16_f32 v108, v216, v217
    v_cvt_pk_bf16_f32 v109, v218, v219
    v_cvt_pk_bf16_f32 v110, v220, v221
    v_cvt_pk_bf16_f32 v111, v222, v223
    buffer_store_dwordx4 v[108:111], v68, s[60:63], s70 offen offset:3072 sc1
    v_mul_f32 v224, v224, v29
    v_mul_f32 v225, v225, v29
    v_mul_f32 v226, v226, v29
    v_mul_f32 v227, v227, v29
    v_mul_f32 v228, v228, v29
    v_mul_f32 v229, v229, v29
    v_mul_f32 v230, v230, v29
    v_mul_f32 v231, v231, v29
    v_cvt_pk_bf16_f32 v112, v224, v225
    v_cvt_pk_bf16_f32 v113, v226, v227
    v_cvt_pk_bf16_f32 v114, v228, v229
    v_cvt_pk_bf16_f32 v115, v230, v231
    buffer_store_dwordx4 v[112:115], v68, s[60:63], s46 offen sc1
    v_mul_f32 v232, v232, v29
    v_mul_f32 v233, v233, v29
    v_mul_f32 v234, v234, v29
    v_mul_f32 v235, v235, v29
    v_mul_f32 v236, v236, v29
    v_mul_f32 v237, v237, v29
    v_mul_f32 v238, v238, v29
    v_mul_f32 v239, v239, v29
    v_cvt_pk_bf16_f32 v116, v232, v233
    v_cvt_pk_bf16_f32 v117, v234, v235
    v_cvt_pk_bf16_f32 v118, v236, v237
    v_cvt_pk_bf16_f32 v119, v238, v239
    buffer_store_dwordx4 v[116:119], v68, s[60:63], s46 offen offset:1024 sc1
    v_mul_f32 v240, v240, v29
    v_mul_f32 v241, v241, v29
    v_mul_f32 v242, v242, v29
    v_mul_f32 v243, v243, v29
    v_mul_f32 v244, v244, v29
    v_mul_f32 v245, v245, v29
    v_mul_f32 v246, v246, v29
    v_mul_f32 v247, v247, v29
    v_cvt_pk_bf16_f32 v120, v240, v241
    v_cvt_pk_bf16_f32 v121, v242, v243
    v_cvt_pk_bf16_f32 v122, v244, v245
    v_cvt_pk_bf16_f32 v123, v246, v247
    buffer_store_dwordx4 v[120:123], v68, s[60:63], s46 offen offset:2048 sc1
    v_mul_f32 v248, v248, v29
    v_mul_f32 v249, v249, v29
    v_mul_f32 v250, v250, v29
    v_mul_f32 v251, v251, v29
    v_mul_f32 v252, v252, v29
    v_mul_f32 v253, v253, v29
    v_mul_f32 v254, v254, v29
    v_mul_f32 v255, v255, v29
    v_cvt_pk_bf16_f32 v124, v248, v249
    v_cvt_pk_bf16_f32 v125, v250, v251
    v_cvt_pk_bf16_f32 v126, v252, v253
    v_cvt_pk_bf16_f32 v127, v254, v255
    buffer_store_dwordx4 v[124:127], v68, s[60:63], s46 offen offset:3072 sc1
    ds_read_b64_tr_b16 v[192:193], v36 offset:24576
    ds_read_b64_tr_b16 v[194:195], v36 offset:25600
    ds_read_b64_tr_b16 v[196:197], v37 offset:24576
    ds_read_b64_tr_b16 v[198:199], v37 offset:25600
    ds_read_b64_tr_b16 v[200:201], v38 offset:24576
    ds_read_b64_tr_b16 v[202:203], v38 offset:25600
    ds_read_b64_tr_b16 v[204:205], v39 offset:24576
    ds_read_b64_tr_b16 v[206:207], v39 offset:25600
    ds_read_b64_tr_b16 v[208:209], v36 offset:28672
    ds_read_b64_tr_b16 v[210:211], v36 offset:29696
    ds_read_b64_tr_b16 v[212:213], v37 offset:28672
    ds_read_b64_tr_b16 v[214:215], v37 offset:29696
    s_waitcnt lgkmcnt(8)
    v_mfma_f32_32x32x16_bf16 v[128:143], v[192:195], v[96:99], 0
    ds_read_b64_tr_b16 v[216:217], v38 offset:28672
    ds_read_b64_tr_b16 v[218:219], v38 offset:29696
    v_mfma_f32_32x32x16_bf16 v[144:159], v[196:199], v[96:99], 0
    ds_read_b64_tr_b16 v[220:221], v39 offset:28672
    ds_read_b64_tr_b16 v[222:223], v39 offset:29696
    s_waitcnt lgkmcnt(8)
    v_mfma_f32_32x32x16_bf16 v[160:175], v[200:203], v[96:99], 0
    ds_read_b64_tr_b16 v[224:225], v32 offset:32768
    ds_read_b64_tr_b16 v[226:227], v32 offset:33792
    v_mfma_f32_32x32x16_bf16 v[176:191], v[204:207], v[96:99], 0
    ds_read_b64_tr_b16 v[228:229], v33 offset:32768
    ds_read_b64_tr_b16 v[230:231], v33 offset:33792
    s_waitcnt vmcnt(4)
    s_mov_b64 exec, 0xe
    buffer_store_dword v14, v13, s[60:63], s71 offen sc1
    s_mov_b64 exec, -1
    s_waitcnt lgkmcnt(8)
    v_mfma_f32_32x32x16_bf16 v[128:143], v[208:211], v[100:103], v[128:143]
    ds_read_b64_tr_b16 v[232:233], v34 offset:32768
    ds_read_b64_tr_b16 v[234:235], v34 offset:33792
    v_mfma_f32_32x32x16_bf16 v[144:159], v[212:215], v[100:103], v[144:159]
    ds_read_b64_tr_b16 v[236:237], v35 offset:32768
    ds_read_b64_tr_b16 v[238:239], v35 offset:33792
    s_waitcnt lgkmcnt(8)
    v_mfma_f32_32x32x16_bf16 v[160:175], v[216:219], v[100:103], v[160:175]
    ds_read_b64_tr_b16 v[240:241], v32 offset:36864
    ds_read_b64_tr_b16 v[242:243], v32 offset:37888
    v_mfma_f32_32x32x16_bf16 v[176:191], v[220:223], v[100:103], v[176:191]
    ds_read_b64_tr_b16 v[244:245], v33 offset:36864
    ds_read_b64_tr_b16 v[246:247], v33 offset:37888
    s_waitcnt lgkmcnt(8)
    v_mfma_f32_32x32x16_bf16 v[128:143], v[224:227], v[104:107], v[128:143]
    ds_read_b64_tr_b16 v[248:249], v34 offset:36864
    ds_read_b64_tr_b16 v[250:251], v34 offset:37888
    v_mfma_f32_32x32x16_bf16 v[144:159], v[228:231], v[104:107], v[144:159]
    ds_read_b64_tr_b16 v[252:253], v35 offset:36864
    ds_read_b64_tr_b16 v[254:255], v35 offset:37888
    s_waitcnt lgkmcnt(8)
    v_mfma_f32_32x32x16_bf16 v[160:175], v[232:235], v[104:107], v[160:175]
    ds_read_b64_tr_b16 v[192:193], v32 offset:0
    ds_read_b64_tr_b16 v[194:195], v32 offset:1024
    v_mfma_f32_32x32x16_bf16 v[176:191], v[236:239], v[104:107], v[176:191]
    ds_read_b64_tr_b16 v[196:197], v33 offset:0
    ds_read_b64_tr_b16 v[198:199], v33 offset:1024
    s_waitcnt lgkmcnt(8)
    v_mfma_f32_32x32x16_bf16 v[128:143], v[240:243], v[108:111], v[128:143]
    ds_read_b64_tr_b16 v[200:201], v34 offset:0
    ds_read_b64_tr_b16 v[202:203], v34 offset:1024
    v_mfma_f32_32x32x16_bf16 v[144:159], v[244:247], v[108:111], v[144:159]
    ds_read_b64_tr_b16 v[204:205], v35 offset:0
    ds_read_b64_tr_b16 v[206:207], v35 offset:1024
    s_waitcnt lgkmcnt(8)
    v_mfma_f32_32x32x16_bf16 v[160:175], v[248:251], v[108:111], v[160:175]
    ds_read_b64_tr_b16 v[208:209], v32 offset:4096
    ds_read_b64_tr_b16 v[210:211], v32 offset:5120
    v_mfma_f32_32x32x16_bf16 v[176:191], v[252:255], v[108:111], v[176:191]
    ds_read_b64_tr_b16 v[212:213], v33 offset:4096
    ds_read_b64_tr_b16 v[214:215], v33 offset:5120
    s_waitcnt lgkmcnt(8)
    v_mfma_f32_32x32x16_bf16 v[128:143], v[192:195], v[112:115], v[128:143]
    ds_read_b64_tr_b16 v[216:217], v34 offset:4096
    ds_read_b64_tr_b16 v[218:219], v34 offset:5120
    v_mfma_f32_32x32x16_bf16 v[144:159], v[196:199], v[112:115], v[144:159]
    ds_read_b64_tr_b16 v[220:221], v35 offset:4096
    ds_read_b64_tr_b16 v[222:223], v35 offset:5120
    s_waitcnt lgkmcnt(8)
    v_mfma_f32_32x32x16_bf16 v[160:175], v[200:203], v[112:115], v[160:175]
    ds_read_b64_tr_b16 v[224:225], v32 offset:16384
    ds_read_b64_tr_b16 v[226:227], v32 offset:17408
    v_mfma_f32_32x32x16_bf16 v[176:191], v[204:207], v[112:115], v[176:191]
    ds_read_b64_tr_b16 v[228:229], v33 offset:16384
    ds_read_b64_tr_b16 v[230:231], v33 offset:17408
    s_mov_b32 s26, 1
    s_load_dwordx4 s[32:35], s[56:57], 0x0 glc
    s_waitcnt vmcnt(1)
    s_mov_b64 exec, 0xe
    buffer_store_dword v14, v13, s[60:63], s71 offen offset:16 sc1
    s_mov_b64 exec, -1
    s_branch L_poll1w
L_poll1:
    s_load_dwordx4 s[32:35], s[56:57], 0x0 glc
    s_add_u32 s74, s74, 1
L_poll1w:
    s_waitcnt lgkmcnt(0)
    s_cmp_ge_u32 s74, 0x10000
    s_cbranch_scc1 L_var0
    s_add_u32 s32, s33, s34
    s_add_u32 s32, s32, s35
    s_cmp_ge_u32 s32, 3
    s_cbranch_scc0 L_poll1
L_choose:
L_var0:
    buffer_load_dwordx4 a[0:3], v68, s[60:63], s42 offen sc1
    buffer_load_dwordx4 a[4:7], v68, s[60:63], s42 offen offset:1024 sc1
    buffer_load_dwordx4 a[8:11], v68, s[60:63], s42 offen offset:2048 sc1
    buffer_load_dwordx4 a[12:15], v68, s[60:63], s42 offen offset:3072 sc1
    buffer_load_dwordx4 a[32:35], v68, s[60:63], s43 offen sc1
    buffer_load_dwordx4 a[36:39], v68, s[60:63], s43 offen offset:1024 sc1
    buffer_load_dwordx4 a[40:43], v68, s[60:63], s43 offen offset:2048 sc1
    buffer_load_dwordx4 a[44:47], v68, s[60:63], s43 offen offset:3072 sc1
    buffer_load_dwordx4 a[64:67], v68, s[60:63], s45 offen sc1
    buffer_load_dwordx4 a[68:71], v68, s[60:63], s45 offen offset:1024 sc1
    buffer_load_dwordx4 a[72:75], v68, s[60:63], s45 offen offset:2048 sc1
    buffer_load_dwordx4 a[76:79], v68, s[60:63], s45 offen offset:3072 sc1
    s_load_dwordx4 s[32:35], s[56:57], 0x10 glc
    v_mfma_f32_32x32x16_bf16 v[128:143], v[208:211], v[116:119], v[128:143]
    ds_read_b64_tr_b16 v[232:233], v34 offset:16384
    ds_read_b64_tr_b16 v[234:235], v34 offset:17408
    s_and_b32 s14, s6, 6
    s_xor_b32 s9, s14, 0
    v_mfma_f32_32x32x16_bf16 v[144:159], v[212:215], v[116:119], v[144:159]
    ds_read_b64_tr_b16 v[236:237], v35 offset:16384
    ds_read_b64_tr_b16 v[238:239], v35 offset:17408
    s_xor_b32 s15, s9, s6
    s_lshr_b32 s27, s78, s9
    v_mfma_f32_32x32x16_bf16 v[160:175], v[216:219], v[116:119], v[160:175]
    ds_read_b64_tr_b16 v[240:241], v32 offset:20480
    ds_read_b64_tr_b16 v[242:243], v32 offset:21504
    s_and_b32 s27, s27, 1
    s_lshl_b32 s9, s9, 6
    v_mfma_f32_32x32x16_bf16 v[176:191], v[220:223], v[116:119], v[176:191]
    ds_read_b64_tr_b16 v[244:245], v33 offset:20480
    ds_read_b64_tr_b16 v[246:247], v33 offset:21504
    s_add_u32 s9, s9, s27
    s_lshl_b32 s9, s9, 3
    v_mfma_f32_32x32x16_bf16 v[128:143], v[224:227], v[120:123], v[128:143]
    ds_read_b64_tr_b16 v[248:249], v34 offset:20480
    ds_read_b64_tr_b16 v[250:251], v34 offset:21504
    s_add_u32 s9, s9, s15
    s_lshl_b32 s9, s9, 10
    v_mfma_f32_32x32x16_bf16 v[144:159], v[228:231], v[120:123], v[144:159]
    ds_read_b64_tr_b16 v[252:253], v35 offset:20480
    ds_read_b64_tr_b16 v[254:255], v35 offset:21504
    s_add_u32 s16, s9, s76
    s_cmp_eq_u32 s15, 0
    s_cselect_b32 s16, 0x40000000, s16
    s_waitcnt lgkmcnt(8)
    v_mfma_f32_32x32x16_bf16 v[160:175], v[232:235], v[120:123], v[160:175]
    ds_read_b64_tr_b16 v[192:193], v39 offset:8192
    ds_read_b64_tr_b16 v[194:195], v39 offset:9216
    s_xor_b32 s9, s14, 1
    s_xor_b32 s15, s9, s6
    v_mfma_f32_32x32x16_bf16 v[176:191], v[236:239], v[120:123], v[176:191]
    ds_read_b64_tr_b16 v[196:197], v38 offset:8192
    ds_read_b64_tr_b16 v[198:199], v38 offset:9216
    s_lshr_b32 s27, s78, s9
    s_and_b32 s27, s27, 1
    s_waitcnt lgkmcnt(8)
    v_mfma_f32_32x32x16_bf16 v[128:143], v[240:243], v[124:127], v[128:143]
    ds_read_b64_tr_b16 v[200:201], v39 offset:12288
    ds_read_b64_tr_b16 v[202:203], v39 offset:13312
    s_lshl_b32 s9, s9, 6
    s_add_u32 s9, s9, s27
    v_mfma_f32_32x32x16_bf16 v[144:159], v[244:247], v[124:127], v[144:159]
    ds_read_b64_tr_b16 v[204:205], v38 offset:12288
    ds_read_b64_tr_b16 v[206:207], v38 offset:13312
    s_lshl_b32 s9, s9, 3
    s_add_u32 s9, s9, s15
    s_waitcnt lgkmcnt(8)
    v_mfma_f32_32x32x16_bf16 v[160:175], v[248:251], v[124:127], v[160:175]
    ds_read_b64_tr_b16 v[208:209], v39 offset:40960
    ds_read_b64_tr_b16 v[210:211], v39 offset:41984
    s_lshl_b32 s9, s9, 10
    s_add_u32 s17, s9, s76
    v_mfma_f32_32x32x16_bf16 v[176:191], v[252:255], v[124:127], v[176:191]
    ds_read_b64_tr_b16 v[212:213], v38 offset:40960
    ds_read_b64_tr_b16 v[214:215], v38 offset:41984
    s_cmp_eq_u32 s15, 0
    s_cselect_b32 s17, 0x40000000, s17
    s_xor_b32 s9, s14, 2
L_pb:
    s_waitcnt lgkmcnt(0)
    s_and_b64 s[32:33], s[32:33], s[34:35]
    s_and_b32 s32, s32, s33
    s_cbranch_scc0 L_pbr
L_pbd:
    s_add_u32 s42, s42, 4096
    buffer_load_dwordx4 a[16:19], v68, s[60:63], s42 offen sc1
    buffer_load_dwordx4 a[20:23], v68, s[60:63], s42 offen offset:1024 sc1
    buffer_load_dwordx4 a[24:27], v68, s[60:63], s42 offen offset:2048 sc1
    buffer_load_dwordx4 a[28:31], v68, s[60:63], s42 offen offset:3072 sc1
    s_add_u32 s43, s43, 4096
    buffer_load_dwordx4 a[48:51], v68, s[60:63], s43 offen sc1
    buffer_load_dwordx4 a[52:55], v68, s[60:63], s43 offen offset:1024 sc1
    buffer_load_dwordx4 a[56:59], v68, s[60:63], s43 offen offset:2048 sc1
    buffer_load_dwordx4 a[60:63], v68, s[60:63], s43 offen offset:3072 sc1
    s_add_u32 s45, s45, 4096
    buffer_load_dwordx4 a[80:83], v68, s[60:63], s45 offen sc1
    buffer_load_dwordx4 a[84:87], v68, s[60:63], s45 offen offset:1024 sc1
    buffer_load_dwordx4 a[88:91], v68, s[60:63], s45 offen offset:2048 sc1
    buffer_load_dwordx4 a[92:95], v68, s[60:63], s45 offen offset:3072 sc1
    s_waitcnt vmcnt(23)
    v_mfma_f32_32x32x16_bf16 v[176:191], v[192:195], a[0:3], v[176:191]
    ds_read_b64_tr_b16 v[216:217], v39 offset:45056
    ds_read_b64_tr_b16 v[218:219], v39 offset:46080
    s_xor_b32 s15, s9, s6
    s_lshr_b32 s27, s78, s9
    v_mfma_f32_32x32x16_bf16 v[160:175], v[196:199], a[0:3], v[160:175]
    ds_read_b64_tr_b16 v[220:221], v38 offset:45056
    ds_read_b64_tr_b16 v[222:223], v38 offset:46080
    s_and_b32 s27, s27, 1
    s_lshl_b32 s9, s9, 6
    s_waitcnt vmcnt(22)
    v_mfma_f32_32x32x16_bf16 v[176:191], v[200:203], a[4:7], v[176:191]
    ds_read_b64_tr_b16 v[224:225], v39 offset:16384
    ds_read_b64_tr_b16 v[226:227], v39 offset:17408
    s_add_u32 s9, s9, s27
    s_lshl_b32 s9, s9, 3
    v_mfma_f32_32x32x16_bf16 v[160:175], v[204:207], a[4:7], v[160:175]
    ds_read_b64_tr_b16 v[228:229], v38 offset:16384
    ds_read_b64_tr_b16 v[230:231], v38 offset:17408
    s_add_u32 s9, s9, s15
    s_lshl_b32 s9, s9, 10
    s_waitcnt vmcnt(21)
    v_mfma_f32_32x32x16_bf16 v[176:191], v[208:211], a[8:11], v[176:191]
    ds_read_b64_tr_b16 v[232:233], v39 offset:20480
    ds_read_b64_tr_b16 v[234:235], v39 offset:21504
    s_add_u32 s18, s9, s76
    s_xor_b32 s9, s14, 3
    v_mfma_f32_32x32x16_bf16 v[160:175], v[212:215], a[8:11], v[160:175]
    ds_read_b64_tr_b16 v[236:237], v38 offset:20480
    ds_read_b64_tr_b16 v[238:239], v38 offset:21504
    s_xor_b32 s15, s9, s6
    s_lshr_b32 s27, s78, s9
    s_waitcnt lgkmcnt(8)
    s_waitcnt vmcnt(20)
    v_mfma_f32_32x32x16_bf16 v[176:191], v[216:219], a[12:15], v[176:191]
    s_getpc_b64 s[12:13]
    s_cmp_ge_u32 s69, 77
    s_cbranch_scc0 L_crefresh
    ds_read_b64_tr_b16 v[240:241], v39 offset:57344
    ds_read_b64_tr_b16 v[242:243], v39 offset:58368
    s_and_b32 s27, s27, 1
    s_lshl_b32 s9, s9, 6
    v_mfma_f32_32x32x16_bf16 v[160:175], v[220:223], a[12:15], v[160:175]
    ds_read_b64_tr_b16 v[244:245], v38 offset:57344
    ds_read_b64_tr_b16 v[246:247], v38 offset:58368
    s_add_u32 s9, s9, s27
    s_lshl_b32 s9, s9, 3
    s_waitcnt lgkmcnt(8)
    s_waitcnt vmcnt(19)
    v_mfma_f32_32x32x16_bf16 v[176:191], v[224:227], a[32:35], v[176:191]
    ds_read_b64_tr_b16 v[248:249], v39 offset:61440
    ds_read_b64_tr_b16 v[250:251], v39 offset:62464
    s_add_u32 s9, s9, s15
    s_lshl_b32 s9, s9, 10
    v_mfma_f32_32x32x16_bf16 v[160:175], v[228:231], a[32:35], v[160:175]
    ds_read_b64_tr_b16 v[252:253], v38 offset:61440
    ds_read_b64_tr_b16 v[254:255], v38 offset:62464
    s_add_u32 s19, s9, s76
    s_xor_b32 s9, s14, 4
    s_waitcnt lgkmcnt(8)
    s_waitcnt vmcnt(18)
    v_mfma_f32_32x32x16_bf16 v[176:191], v[232:235], a[36:39], v[176:191]
    ds_read_b64_tr_b16 v[192:193], v39 offset:0
    ds_read_b64_tr_b16 v[194:195], v39 offset:1024
    s_xor_b32 s15, s9, s6
    s_lshr_b32 s27, s78, s9
    v_mfma_f32_32x32x16_bf16 v[160:175], v[236:239], a[36:39], v[160:175]
    ds_read_b64_tr_b16 v[196:197], v38 offset:0
    ds_read_b64_tr_b16 v[198:199], v38 offset:1024
    s_and_b32 s27, s27, 1
    s_lshl_b32 s9, s9, 6
    s_waitcnt lgkmcnt(8)
    s_waitcnt vmcnt(17)
    v_mfma_f32_32x32x16_bf16 v[176:191], v[240:243], a[40:43], v[176:191]
    ds_read_b64_tr_b16 v[200:201], v39 offset:4096
    ds_read_b64_tr_b16 v[202:203], v39 offset:5120
    s_add_u32 s9, s9, s27
    s_lshl_b32 s9, s9, 3
    v_mfma_f32_32x32x16_bf16 v[160:175], v[244:247], a[40:43], v[160:175]
    ds_read_b64_tr_b16 v[204:205], v38 offset:4096
    ds_read_b64_tr_b16 v[206:207], v38 offset:5120
    s_add_u32 s9, s9, s15
    s_lshl_b32 s9, s9, 10
    s_waitcnt lgkmcnt(8)
    s_waitcnt vmcnt(16)
    v_mfma_f32_32x32x16_bf16 v[176:191], v[248:251], a[44:47], v[176:191]
    ds_read_b64_tr_b16 v[208:209], v43 offset:0
    ds_read_b64_tr_b16 v[210:211], v43 offset:1024
    s_add_u32 s20, s9, s76
    s_xor_b32 s9, s14, 5
    v_mfma_f32_32x32x16_bf16 v[160:175], v[252:255], a[44:47], v[160:175]
    ds_read_b64_tr_b16 v[212:213], v42 offset:0
    ds_read_b64_tr_b16 v[214:215], v42 offset:1024
    s_xor_b32 s15, s9, s6
    s_lshr_b32 s27, s78, s9
    s_waitcnt lgkmcnt(8)
    s_waitcnt vmcnt(15)
    v_mfma_f32_32x32x16_bf16 v[176:191], v[192:195], a[64:67], v[176:191]
    ds_read_b64_tr_b16 v[216:217], v43 offset:4096
    ds_read_b64_tr_b16 v[218:219], v43 offset:5120
    s_and_b32 s27, s27, 1
    s_lshl_b32 s9, s9, 6
    v_mfma_f32_32x32x16_bf16 v[160:175], v[196:199], a[64:67], v[160:175]
    ds_read_b64_tr_b16 v[220:221], v42 offset:4096
    ds_read_b64_tr_b16 v[222:223], v42 offset:5120
    s_add_u32 s9, s9, s27
    s_lshl_b32 s9, s9, 3
    s_waitcnt lgkmcnt(8)
    s_waitcnt vmcnt(14)
    v_mfma_f32_32x32x16_bf16 v[176:191], v[200:203], a[68:71], v[176:191]
    ds_read_b64_tr_b16 v[224:225], v35 offset:49152
    ds_read_b64_tr_b16 v[226:227], v35 offset:50176
    s_add_u32 s9, s9, s15
    s_lshl_b32 s9, s9, 10
    v_mfma_f32_32x32x16_bf16 v[160:175], v[204:207], a[68:71], v[160:175]
    ds_read_b64_tr_b16 v[228:229], v34 offset:49152
    ds_read_b64_tr_b16 v[230:231], v34 offset:50176
    s_add_u32 s21, s9, s76
    s_xor_b32 s9, s14, 6
    s_waitcnt lgkmcnt(8)
    s_waitcnt vmcnt(13)
    v_mfma_f32_32x32x16_bf16 v[176:191], v[208:211], a[72:75], v[176:191]
    ds_read_b64_tr_b16 v[232:233], v35 offset:53248
    ds_read_b64_tr_b16 v[234:235], v35 offset:54272
    s_xor_b32 s15, s9, s6
    s_lshr_b32 s27, s78, s9
    v_mfma_f32_32x32x16_bf16 v[160:175], v[212:215], a[72:75], v[160:175]
    ds_read_b64_tr_b16 v[236:237], v34 offset:53248
    ds_read_b64_tr_b16 v[238:239], v34 offset:54272
    s_and_b32 s27, s27, 1
    s_lshl_b32 s9, s9, 6
    s_waitcnt lgkmcnt(8)
    s_waitcnt vmcnt(12)
    v_mfma_f32_32x32x16_bf16 v[176:191], v[216:219], a[76:79], v[176:191]
    ds_read_b64_tr_b16 v[240:241], v35 offset:24576
    ds_read_b64_tr_b16 v[242:243], v35 offset:25600
    s_add_u32 s9, s9, s27
    s_lshl_b32 s9, s9, 3
    v_mfma_f32_32x32x16_bf16 v[160:175], v[220:223], a[76:79], v[160:175]
    ds_read_b64_tr_b16 v[244:245], v34 offset:24576
    ds_read_b64_tr_b16 v[246:247], v34 offset:25600
    s_add_u32 s9, s9, s15
    s_lshl_b32 s9, s9, 10
    s_waitcnt lgkmcnt(8)
    s_waitcnt vmcnt(11)
    v_mfma_f32_32x32x16_bf16 v[176:191], v[224:227], a[16:19], v[176:191]
    ds_read_b64_tr_b16 v[248:249], v35 offset:28672
    ds_read_b64_tr_b16 v[250:251], v35 offset:29696
    s_add_u32 s22, s9, s76
    s_xor_b32 s9, s14, 7
    v_mfma_f32_32x32x16_bf16 v[160:175], v[228:231], a[16:19], v[160:175]
    ds_read_b64_tr_b16 v[252:253], v34 offset:28672
    ds_read_b64_tr_b16 v[254:255], v34 offset:29696
    s_xor_b32 s15, s9, s6
    s_lshr_b32 s27, s78, s9
    s_waitcnt lgkmcnt(8)
    s_waitcnt vmcnt(10)
    v_mfma_f32_32x32x16_bf16 v[176:191], v[232:235], a[20:23], v[176:191]
    ds_read_b64_tr_b16 v[192:193], v35 offset:57344
    ds_read_b64_tr_b16 v[194:195], v35 offset:58368
    s_and_b32 s27, s27, 1
    s_lshl_b32 s9, s9, 6
    v_mfma_f32_32x32x16_bf16 v[160:175], v[236:239], a[20:23], v[160:175]
    ds_read_b64_tr_b16 v[196:197], v34 offset:57344
    ds_read_b64_tr_b16 v[198:199], v34 offset:58368
    s_add_u32 s9, s9, s27
    s_lshl_b32 s9, s9, 3
    s_waitcnt lgkmcnt(8)
    s_waitcnt vmcnt(9)
    v_mfma_f32_32x32x16_bf16 v[176:191], v[240:243], a[24:27], v[176:191]
    ds_read_b64_tr_b16 v[200:201], v35 offset:61440
    ds_read_b64_tr_b16 v[202:203], v35 offset:62464
    s_add_u32 s9, s9, s15
    s_lshl_b32 s9, s9, 10
    v_mfma_f32_32x32x16_bf16 v[160:175], v[244:247], a[24:27], v[160:175]
    ds_read_b64_tr_b16 v[204:205], v34 offset:61440
    ds_read_b64_tr_b16 v[206:207], v34 offset:62464
    s_add_u32 s23, s9, s76
    s_add_u32 s24, s70, 0x40000
    s_waitcnt lgkmcnt(8)
    s_waitcnt vmcnt(8)
    v_mfma_f32_32x32x16_bf16 v[176:191], v[248:251], a[28:31], v[176:191]
    ds_read_b64_tr_b16 v[208:209], v35 offset:8192
    ds_read_b64_tr_b16 v[210:211], v35 offset:9216
    s_add_u32 s25, s24, 4096
    v_mfma_f32_32x32x16_bf16 v[160:175], v[252:255], a[28:31], v[160:175]
    ds_read_b64_tr_b16 v[212:213], v34 offset:8192
    ds_read_b64_tr_b16 v[214:215], v34 offset:9216
    s_waitcnt lgkmcnt(8)
    s_waitcnt vmcnt(7)
    v_mfma_f32_32x32x16_bf16 v[176:191], v[192:195], a[48:51], v[176:191]
    ds_read_b64_tr_b16 v[216:217], v35 offset:12288
    ds_read_b64_tr_b16 v[218:219], v35 offset:13312
    v_mfma_f32_32x32x16_bf16 v[160:175], v[196:199], a[48:51], v[160:175]
    ds_read_b64_tr_b16 v[220:221], v34 offset:12288
    ds_read_b64_tr_b16 v[222:223], v34 offset:13312
    s_waitcnt lgkmcnt(8)
    s_waitcnt vmcnt(6)
    v_mfma_f32_32x32x16_bf16 v[176:191], v[200:203], a[52:55], v[176:191]
    ds_read_b64_tr_b16 v[224:225], v43 offset:8192
    ds_read_b64_tr_b16 v[226:227], v43 offset:9216
    v_mfma_f32_32x32x16_bf16 v[160:175], v[204:207], a[52:55], v[160:175]
    ds_read_b64_tr_b16 v[228:229], v42 offset:8192
    ds_read_b64_tr_b16 v[230:231], v42 offset:9216
    s_waitcnt lgkmcnt(8)
    s_waitcnt vmcnt(5)
    v_mfma_f32_32x32x16_bf16 v[176:191], v[208:211], a[56:59], v[176:191]
    ds_read_b64_tr_b16 v[232:233], v43 offset:12288
    ds_read_b64_tr_b16 v[234:235], v43 offset:13312
    v_mfma_f32_32x32x16_bf16 v[160:175], v[212:215], a[56:59], v[160:175]
    ds_read_b64_tr_b16 v[236:237], v42 offset:12288
    ds_read_b64_tr_b16 v[238:239], v42 offset:13312
    s_waitcnt lgkmcnt(8)
    s_waitcnt vmcnt(4)
    v_mfma_f32_32x32x16_bf16 v[176:191], v[216:219], a[60:63], v[176:191]
    ds_read_b64_tr_b16 v[240:241], v43 offset:16384
    ds_read_b64_tr_b16 v[242:243], v43 offset:17408
    v_mfma_f32_32x32x16_bf16 v[160:175], v[220:223], a[60:63], v[160:175]
    ds_read_b64_tr_b16 v[244:245], v42 offset:16384
    ds_read_b64_tr_b16 v[246:247], v42 offset:17408
    s_waitcnt lgkmcnt(8)
    s_waitcnt vmcnt(3)
    v_mfma_f32_32x32x16_bf16 v[176:191], v[224:227], a[80:83], v[176:191]
    ds_read_b64_tr_b16 v[248:249], v43 offset:20480
    ds_read_b64_tr_b16 v[250:251], v43 offset:21504
    v_mfma_f32_32x32x16_bf16 v[160:175], v[228:231], a[80:83], v[160:175]
    ds_read_b64_tr_b16 v[252:253], v42 offset:20480
    ds_read_b64_tr_b16 v[254:255], v42 offset:21504
    s_waitcnt lgkmcnt(8)
    s_waitcnt vmcnt(2)
    v_mfma_f32_32x32x16_bf16 v[176:191], v[232:235], a[84:87], v[176:191]
    ds_read_b64_tr_b16 v[192:193], v37 offset:8192
    ds_read_b64_tr_b16 v[194:195], v37 offset:9216
    v_mfma_f32_32x32x16_bf16 v[160:175], v[236:239], a[84:87], v[160:175]
    ds_read_b64_tr_b16 v[196:197], v37 offset:12288
    ds_read_b64_tr_b16 v[198:199], v37 offset:13312
    s_waitcnt lgkmcnt(8)
    s_waitcnt vmcnt(1)
    v_mfma_f32_32x32x16_bf16 v[176:191], v[240:243], a[88:91], v[176:191]
    ds_read_b64_tr_b16 v[200:201], v37 offset:40960
    ds_read_b64_tr_b16 v[202:203], v37 offset:41984
    v_mfma_f32_32x32x16_bf16 v[160:175], v[244:247], a[88:91], v[160:175]
    ds_read_b64_tr_b16 v[204:205], v37 offset:45056
    ds_read_b64_tr_b16 v[206:207], v37 offset:46080
    s_waitcnt lgkmcnt(8)
    s_waitcnt vmcnt(0)
    v_mfma_f32_32x32x16_bf16 v[176:191], v[248:251], a[92:95], v[176:191]
    ds_read_b64_tr_b16 v[208:209], v33 offset:49152
    ds_read_b64_tr_b16 v[210:211], v33 offset:50176
    v_mfma_f32_32x32x16_bf16 v[160:175], v[252:255], a[92:95], v[160:175]
    ds_read_b64_tr_b16 v[212:213], v33 offset:53248
    ds_read_b64_tr_b16 v[214:215], v33 offset:54272
    s_waitcnt lgkmcnt(8)
    v_mfma_f32_32x32x16_bf16 v[144:159], v[192:195], a[0:3], v[144:159]
    ds_read_b64_tr_b16 v[216:217], v33 offset:24576
    ds_read_b64_tr_b16 v[218:219], v33 offset:25600
    v_mfma_f32_32x32x16_bf16 v[144:159], v[196:199], a[4:7], v[144:159]
    ds_read_b64_tr_b16 v[220:221], v33 offset:28672
    ds_read_b64_tr_b16 v[222:223], v33 offset:29696
    s_waitcnt lgkmcnt(8)
    v_mfma_f32_32x32x16_bf16 v[144:159], v[200:203], a[8:11], v[144:159]
    ds_read_b64_tr_b16 v[224:225], v37 offset:16384
    ds_read_b64_tr_b16 v[226:227], v37 offset:17408
    v_mfma_f32_32x32x16_bf16 v[144:159], v[204:207], a[12:15], v[144:159]
    ds_read_b64_tr_b16 v[228:229], v37 offset:20480
    ds_read_b64_tr_b16 v[230:231], v37 offset:21504
    v_cvt_pk_bf16_f32 v88, v176, v177
    v_cvt_pk_bf16_f32 v92, v184, v185
    s_waitcnt lgkmcnt(8)
    v_mfma_f32_32x32x16_bf16 v[144:159], v[208:211], a[16:19], v[144:159]
    ds_read_b64_tr_b16 v[232:233], v37 offset:57344
    ds_read_b64_tr_b16 v[234:235], v37 offset:58368
    v_cvt_pk_bf16_f32 v89, v178, v179
    v_cvt_pk_bf16_f32 v93, v186, v187
    v_mfma_f32_32x32x16_bf16 v[144:159], v[212:215], a[20:23], v[144:159]
    ds_read_b64_tr_b16 v[236:237], v37 offset:61440
    ds_read_b64_tr_b16 v[238:239], v37 offset:62464
    v_cvt_pk_bf16_f32 v90, v180, v181
    v_cvt_pk_bf16_f32 v94, v188, v189
    s_waitcnt lgkmcnt(8)
    v_mfma_f32_32x32x16_bf16 v[144:159], v[216:219], a[24:27], v[144:159]
    ds_read_b64_tr_b16 v[240:241], v33 offset:57344
    ds_read_b64_tr_b16 v[242:243], v33 offset:58368
    v_cvt_pk_bf16_f32 v91, v182, v183
    v_cvt_pk_bf16_f32 v95, v190, v191
    v_mfma_f32_32x32x16_bf16 v[144:159], v[220:223], a[28:31], v[144:159]
    ds_read_b64_tr_b16 v[244:245], v33 offset:61440
    ds_read_b64_tr_b16 v[246:247], v33 offset:62464
    v_permlane16_swap_b32 v88, v92
    v_permlane16_swap_b32 v89, v93
    s_waitcnt lgkmcnt(8)
    v_mfma_f32_32x32x16_bf16 v[144:159], v[224:227], a[32:35], v[144:159]
    ds_read_b64_tr_b16 v[248:249], v33 offset:8192
    ds_read_b64_tr_b16 v[250:251], v33 offset:9216
    v_permlane16_swap_b32 v90, v94
    v_permlane16_swap_b32 v91, v95
    v_mfma_f32_32x32x16_bf16 v[144:159], v[228:231], a[36:39], v[144:159]
    ds_read_b64_tr_b16 v[252:253], v33 offset:12288
    ds_read_b64_tr_b16 v[254:255], v33 offset:13312
    buffer_store_dwordx4 v[88:91], v68, s[60:63], s22 offen sc1
    buffer_store_dwordx4 v[92:95], v68, s[60:63], s23 offen sc1
    s_waitcnt lgkmcnt(8)
    v_mfma_f32_32x32x16_bf16 v[144:159], v[232:235], a[40:43], v[144:159]
    ds_read_b64_tr_b16 v[192:193], v37 offset:0
    ds_read_b64_tr_b16 v[194:195], v37 offset:1024
    v_cvt_pk_bf16_f32 v80, v160, v161
    v_cvt_pk_bf16_f32 v84, v168, v169
    v_mfma_f32_32x32x16_bf16 v[144:159], v[236:239], a[44:47], v[144:159]
    ds_read_b64_tr_b16 v[196:197], v37 offset:4096
    ds_read_b64_tr_b16 v[198:199], v37 offset:5120
    v_cvt_pk_bf16_f32 v81, v162, v163
    v_cvt_pk_bf16_f32 v85, v170, v171
    s_waitcnt lgkmcnt(8)
    v_mfma_f32_32x32x16_bf16 v[144:159], v[240:243], a[48:51], v[144:159]
    ds_read_b64_tr_b16 v[200:201], v41 offset:0
    ds_read_b64_tr_b16 v[202:203], v41 offset:1024
    v_cvt_pk_bf16_f32 v82, v164, v165
    v_cvt_pk_bf16_f32 v86, v172, v173
    v_mfma_f32_32x32x16_bf16 v[144:159], v[244:247], a[52:55], v[144:159]
    ds_read_b64_tr_b16 v[204:205], v41 offset:4096
    ds_read_b64_tr_b16 v[206:207], v41 offset:5120
    v_cvt_pk_bf16_f32 v83, v166, v167
    v_cvt_pk_bf16_f32 v87, v174, v175
    s_waitcnt lgkmcnt(8)
    v_mfma_f32_32x32x16_bf16 v[144:159], v[248:251], a[56:59], v[144:159]
    ds_read_b64_tr_b16 v[208:209], v41 offset:8192
    ds_read_b64_tr_b16 v[210:211], v41 offset:9216
    v_permlane16_swap_b32 v80, v84
    v_permlane16_swap_b32 v81, v85
    v_mfma_f32_32x32x16_bf16 v[144:159], v[252:255], a[60:63], v[144:159]
    ds_read_b64_tr_b16 v[212:213], v41 offset:12288
    ds_read_b64_tr_b16 v[214:215], v41 offset:13312
    v_permlane16_swap_b32 v82, v86
    v_permlane16_swap_b32 v83, v87
    s_waitcnt lgkmcnt(8)
    v_mfma_f32_32x32x16_bf16 v[144:159], v[192:195], a[64:67], v[144:159]
    ds_read_b64_tr_b16 v[216:217], v41 offset:16384
    ds_read_b64_tr_b16 v[218:219], v41 offset:17408
    buffer_store_dwordx4 v[80:83], v68, s[60:63], s20 offen sc1
    buffer_store_dwordx4 v[84:87], v68, s[60:63], s21 offen sc1
    v_mfma_f32_32x32x16_bf16 v[144:159], v[196:199], a[68:71], v[144:159]
    ds_read_b64_tr_b16 v[220:221], v41 offset:20480
    ds_read_b64_tr_b16 v[222:223], v41 offset:21504
    s_waitcnt lgkmcnt(8)
    v_mfma_f32_32x32x16_bf16 v[144:159], v[200:203], a[72:75], v[144:159]
    ds_read_b64_tr_b16 v[224:225], v36 offset:8192
    ds_read_b64_tr_b16 v[226:227], v36 offset:9216
    v_mfma_f32_32x32x16_bf16 v[144:159], v[204:207], a[76:79], v[144:159]
    ds_read_b64_tr_b16 v[228:229], v36 offset:12288
    ds_read_b64_tr_b16 v[230:231], v36 offset:13312
    s_waitcnt lgkmcnt(8)
    v_mfma_f32_32x32x16_bf16 v[144:159], v[208:211], a[80:83], v[144:159]
    ds_read_b64_tr_b16 v[232:233], v36 offset:40960
    ds_read_b64_tr_b16 v[234:235], v36 offset:41984
    v_mfma_f32_32x32x16_bf16 v[144:159], v[212:215], a[84:87], v[144:159]
    ds_read_b64_tr_b16 v[236:237], v36 offset:45056
    ds_read_b64_tr_b16 v[238:239], v36 offset:46080
    s_waitcnt lgkmcnt(8)
    v_mfma_f32_32x32x16_bf16 v[144:159], v[216:219], a[88:91], v[144:159]
    ds_read_b64_tr_b16 v[240:241], v32 offset:49152
    ds_read_b64_tr_b16 v[242:243], v32 offset:50176
    v_mfma_f32_32x32x16_bf16 v[144:159], v[220:223], a[92:95], v[144:159]
    ds_read_b64_tr_b16 v[244:245], v32 offset:53248
    ds_read_b64_tr_b16 v[246:247], v32 offset:54272
    s_waitcnt lgkmcnt(8)
    v_mfma_f32_32x32x16_bf16 v[128:143], v[224:227], a[0:3], v[128:143]
    ds_read_b64_tr_b16 v[248:249], v32 offset:24576
    ds_read_b64_tr_b16 v[250:251], v32 offset:25600
    v_mfma_f32_32x32x16_bf16 v[128:143], v[228:231], a[4:7], v[128:143]
    ds_read_b64_tr_b16 v[252:253], v32 offset:28672
    ds_read_b64_tr_b16 v[254:255], v32 offset:29696
    s_waitcnt lgkmcnt(8)
    v_mfma_f32_32x32x16_bf16 v[128:143], v[232:235], a[8:11], v[128:143]
    ds_read_b64_tr_b16 v[192:193], v36 offset:16384
    ds_read_b64_tr_b16 v[194:195], v36 offset:17408
    v_mfma_f32_32x32x16_bf16 v[128:143], v[236:239], a[12:15], v[128:143]
    ds_read_b64_tr_b16 v[196:197], v36 offset:20480
    ds_read_b64_tr_b16 v[198:199], v36 offset:21504
    v_cvt_pk_bf16_f32 v88, v144, v145
    v_cvt_pk_bf16_f32 v92, v152, v153
    s_waitcnt lgkmcnt(8)
    v_mfma_f32_32x32x16_bf16 v[128:143], v[240:243], a[16:19], v[128:143]
    ds_read_b64_tr_b16 v[200:201], v36 offset:57344
    ds_read_b64_tr_b16 v[202:203], v36 offset:58368
    v_cvt_pk_bf16_f32 v89, v146, v147
    v_cvt_pk_bf16_f32 v93, v154, v155
    v_mfma_f32_32x32x16_bf16 v[128:143], v[244:247], a[20:23], v[128:143]
    ds_read_b64_tr_b16 v[204:205], v36 offset:61440
    ds_read_b64_tr_b16 v[206:207], v36 offset:62464
    v_cvt_pk_bf16_f32 v90, v148, v149
    v_cvt_pk_bf16_f32 v94, v156, v157
    s_waitcnt lgkmcnt(8)
    v_mfma_f32_32x32x16_bf16 v[128:143], v[248:251], a[24:27], v[128:143]
    ds_read_b64_tr_b16 v[208:209], v32 offset:57344
    ds_read_b64_tr_b16 v[210:211], v32 offset:58368
    v_cvt_pk_bf16_f32 v91, v150, v151
    v_cvt_pk_bf16_f32 v95, v158, v159
    v_mfma_f32_32x32x16_bf16 v[128:143], v[252:255], a[28:31], v[128:143]
    ds_read_b64_tr_b16 v[212:213], v32 offset:61440
    ds_read_b64_tr_b16 v[214:215], v32 offset:62464
    v_permlane16_swap_b32 v88, v92
    v_permlane16_swap_b32 v89, v93
    s_waitcnt lgkmcnt(8)
    v_mfma_f32_32x32x16_bf16 v[128:143], v[192:195], a[32:35], v[128:143]
    ds_read_b64_tr_b16 v[216:217], v32 offset:8192
    ds_read_b64_tr_b16 v[218:219], v32 offset:9216
    v_permlane16_swap_b32 v90, v94
    v_permlane16_swap_b32 v91, v95
    v_mfma_f32_32x32x16_bf16 v[128:143], v[196:199], a[36:39], v[128:143]
    ds_read_b64_tr_b16 v[220:221], v32 offset:12288
    ds_read_b64_tr_b16 v[222:223], v32 offset:13312
    buffer_store_dwordx4 v[88:91], v68, s[60:63], s18 offen sc1
    buffer_store_dwordx4 v[92:95], v68, s[60:63], s19 offen sc1
    s_waitcnt lgkmcnt(8)
    v_mfma_f32_32x32x16_bf16 v[128:143], v[200:203], a[40:43], v[128:143]
    ds_read_b64_tr_b16 v[224:225], v36 offset:0
    ds_read_b64_tr_b16 v[226:227], v36 offset:1024
    v_mfma_f32_32x32x16_bf16 v[128:143], v[204:207], a[44:47], v[128:143]
    ds_read_b64_tr_b16 v[228:229], v36 offset:4096
    ds_read_b64_tr_b16 v[230:231], v36 offset:5120
    s_waitcnt lgkmcnt(8)
    v_mfma_f32_32x32x16_bf16 v[128:143], v[208:211], a[48:51], v[128:143]
    ds_read_b64_tr_b16 v[232:233], v40 offset:0
    ds_read_b64_tr_b16 v[234:235], v40 offset:1024
    v_mfma_f32_32x32x16_bf16 v[128:143], v[212:215], a[52:55], v[128:143]
    ds_read_b64_tr_b16 v[236:237], v40 offset:4096
    ds_read_b64_tr_b16 v[238:239], v40 offset:5120
    s_waitcnt lgkmcnt(8)
    v_mfma_f32_32x32x16_bf16 v[128:143], v[216:219], a[56:59], v[128:143]
    ds_read_b64_tr_b16 v[240:241], v40 offset:8192
    ds_read_b64_tr_b16 v[242:243], v40 offset:9216
    v_mfma_f32_32x32x16_bf16 v[128:143], v[220:223], a[60:63], v[128:143]
    ds_read_b64_tr_b16 v[244:245], v40 offset:12288
    ds_read_b64_tr_b16 v[246:247], v40 offset:13312
    s_waitcnt lgkmcnt(8)
    v_mfma_f32_32x32x16_bf16 v[128:143], v[224:227], a[64:67], v[128:143]
    ds_read_b64_tr_b16 v[248:249], v40 offset:16384
    ds_read_b64_tr_b16 v[250:251], v40 offset:17408
    s_waitcnt vmcnt(2)
    s_mov_b64 exec, 0xf0
    buffer_store_dword v14, v12, s[60:63], s72 offen sc1
    s_mov_b64 exec, -1
    v_mfma_f32_32x32x16_bf16 v[128:143], v[228:231], a[68:71], v[128:143]
    ds_read_b64_tr_b16 v[252:253], v40 offset:20480
    ds_read_b64_tr_b16 v[254:255], v40 offset:21504
    s_waitcnt lgkmcnt(8)
    v_mfma_f32_32x32x16_bf16 v[128:143], v[232:235], a[72:75], v[128:143]
    v_mfma_f32_32x32x16_bf16 v[128:143], v[236:239], a[76:79], v[128:143]
    s_waitcnt lgkmcnt(4)
    v_mfma_f32_32x32x16_bf16 v[128:143], v[240:243], a[80:83], v[128:143]
    v_mfma_f32_32x32x16_bf16 v[128:143], v[244:247], a[84:87], v[128:143]
    s_waitcnt lgkmcnt(0)
    v_mfma_f32_32x32x16_bf16 v[128:143], v[248:251], a[88:91], v[128:143]
    v_mfma_f32_32x32x16_bf16 v[128:143], v[252:255], a[92:95], v[128:143]
L_varend:
    s_mov_b32 s74, 0
    s_nop 10
    v_cvt_pk_bf16_f32 v80, v128, v129
    v_cvt_pk_bf16_f32 v84, v136, v137
    v_cvt_pk_bf16_f32 v81, v130, v131
    v_cvt_pk_bf16_f32 v85, v138, v139
    v_cvt_pk_bf16_f32 v82, v132, v133
    v_cvt_pk_bf16_f32 v86, v140, v141
    v_cvt_pk_bf16_f32 v83, v134, v135
    v_cvt_pk_bf16_f32 v87, v142, v143
    v_permlane16_swap_b32 v80, v84
    v_permlane16_swap_b32 v81, v85
    v_permlane16_swap_b32 v82, v86
    v_permlane16_swap_b32 v83, v87
    buffer_store_dwordx4 v[80:83], v68, s[60:63], s16 offen sc1
    buffer_store_dwordx4 v[84:87], v68, s[60:63], s17 offen sc1
    v_permlane16_swap_b32 v128, v136
    v_permlane16_swap_b32 v129, v137
    v_permlane16_swap_b32 v130, v138
    v_permlane16_swap_b32 v131, v139
    v_permlane16_swap_b32 v132, v140
    v_permlane16_swap_b32 v133, v141
    v_permlane16_swap_b32 v134, v142
    v_permlane16_swap_b32 v135, v143
    s_bitcmp1_b32 s6, 0
    s_cbranch_scc0 L_q0
    v_mov_b32 v128, v136
    v_mov_b32 v129, v137
    v_mov_b32 v130, v138
    v_mov_b32 v131, v139
    v_mov_b32 v132, v140
    v_mov_b32 v133, v141
    v_mov_b32 v134, v142
    v_mov_b32 v135, v143
L_q0:
    s_waitcnt vmcnt(3)
    s_mov_b64 exec, 0xc
    buffer_store_dword v14, v12, s[60:63], s72 offen sc1
    s_mov_b64 exec, -1
    s_load_dwordx8 s[32:39], s[56:57], 0x80 glc
    s_waitcnt vmcnt(1)
    s_mov_b64 exec, 0x2
    buffer_store_dword v14, v12, s[60:63], s72 offen sc1
    s_mov_b64 exec, -1
    s_waitcnt lgkmcnt(0)
L_e1:
    s_and_b64 s[40:41], s[36:37], s[38:39]
    s_and_b32 s40, s40, s41
    s_cbranch_scc0 L_e1r
L_e1d:
    buffer_load_dwordx4 v[220:223], v68, s[60:63], s25 offen offset:3072 sc1
    buffer_load_dwordx4 v[216:219], v68, s[60:63], s25 offen offset:2048 sc1
    buffer_load_dwordx4 v[212:215], v68, s[60:63], s25 offen offset:1024 sc1
    buffer_load_dwordx4 v[208:211], v68, s[60:63], s25 offen sc1
L_e2:
    s_and_b32 s40, s34, s35
    s_cbranch_scc0 L_e2r
L_e2d:
    buffer_load_dwordx4 v[204:207], v68, s[60:63], s24 offen offset:3072 sc1
    buffer_load_dwordx4 v[200:203], v68, s[60:63], s24 offen offset:2048 sc1
L_e3:
    s_and_b32 s40, s33, s33
    s_cbranch_scc0 L_e3r
L_e3d:
    buffer_load_dwordx4 v[196:199], v68, s[60:63], s24 offen offset:1024 sc1
    s_waitcnt vmcnt(6)
    v_mfma_f32_32x32x16_bf16 v[128:143], v[8:11], v[220:223], v[128:143]
    s_waitcnt vmcnt(5)
    v_mfma_f32_32x32x16_bf16 v[128:143], v[8:11], v[216:219], v[128:143]
    s_waitcnt vmcnt(4)
    v_mfma_f32_32x32x16_bf16 v[128:143], v[8:11], v[212:215], v[128:143]
    s_waitcnt vmcnt(3)
    v_mfma_f32_32x32x16_bf16 v[128:143], v[8:11], v[208:211], v[128:143]
    s_waitcnt vmcnt(2)
    v_mfma_f32_32x32x16_bf16 v[128:143], v[8:11], v[204:207], v[128:143]
    s_waitcnt vmcnt(1)
    v_mfma_f32_32x32x16_bf16 v[128:143], v[8:11], v[200:203], v[128:143]
    s_waitcnt vmcnt(0)
    v_mfma_f32_32x32x16_bf16 v[128:143], v[8:11], v[196:199], v[128:143]
    s_nop 11
    v_cvt_pk_bf16_f32 v16, v128, v129
    v_cvt_pk_bf16_f32 v17, v130, v131
    v_cvt_pk_bf16_f32 v18, v132, v133
    v_cvt_pk_bf16_f32 v19, v134, v135
    buffer_store_dwordx4 v[16:19], v70, s[52:55], 0 offen
L_fin:
L_end:
    s_endpgm
L_pbr:
    s_add_u32 s74, s74, 1
    s_cmp_ge_u32 s74, 0x10000
    s_cbranch_scc1 L_pbd
    s_load_dwordx4 s[32:35], s[56:57], 0x10 glc
    s_branch L_pb
L_e1r:
    s_load_dwordx8 s[32:39], s[56:57], 0x80 glc
    s_add_u32 s74, s74, 1
    s_waitcnt lgkmcnt(0)
    s_cmp_lt_u32 s74, 0x10000
    s_cbranch_scc1 L_e1
    s_branch L_e1d
L_e2r:
    s_load_dwordx8 s[32:39], s[56:57], 0x80 glc
    s_add_u32 s74, s74, 1
    s_waitcnt lgkmcnt(0)
    s_cmp_lt_u32 s74, 0x10000
    s_cbranch_scc1 L_e2
    s_branch L_e2d
L_e3r:
    s_load_dwordx8 s[32:39], s[56:57], 0x80 glc
    s_add_u32 s74, s74, 1
    s_waitcnt lgkmcnt(0)
    s_cmp_lt_u32 s74, 0x10000
    s_cbranch_scc1 L_e3
    s_branch L_e3d
L_rs0:
    s_call_b64 s[12:13], L_rescale0
    s_branch L_skip0
L_as0:
    s_call_b64 s[66:67], L_vote
    s_branch L_na0
L_vote:
    s_waitcnt lgkmcnt(0)
    s_load_dword s58, s[56:57], 0x0 glc
    s_load_dword s59, s[56:57], 0x2000 glc
    s_waitcnt lgkmcnt(1)
    s_xor_b32 s74, s82, 1
    s_nop 3
    s_getreg_b32 s68, hwreg(HW_REG_IB_STS, 8, 1)
    s_waitcnt lgkmcnt(0)
    s_xor_b32 s68, s68, s74
    s_lshl_b32 s68, s68, s75
    s_add_u32 s83, s83, s68
    s_atomic_add s83, s[28:29], s80 glc
    s_waitcnt lgkmcnt(0)
    s_setpc_b64 s[66:67]
L_as1:
    s_call_b64 s[66:67], L_vote
    s_branch L_na1
L_fb0a:
    s_mov_b32 s101, 1
    s_atomic_add s101, s[44:45], 0x0 glc
    s_branch L_fbr0a
L_rs1:
    s_call_b64 s[12:13], L_rescale1
    s_branch L_skip1
L_fb0b:
    s_mov_b32 s34, 0x32211000
    s_mov_b32 s35, 0xd9755443
    v_mov_b32 v30, 160768
    s_waitcnt lgkmcnt(0)
    s_min_u32 s32, s101, 31
    s_lshr_b32 s32, s32, 1
    s_lshl_b32 s32, s32, 2
    s_lshr_b64 s[34:35], s[34:35], s32
    s_and_b32 s34, s34, 15
    s_sub_u32 s34, s34, 4
    v_mov_b32 v31, s34
    ds_write_b32 v30, v31
    s_waitcnt lgkmcnt(0)
    s_branch L_fbr0b
L_as2:
    s_call_b64 s[66:67], L_vote
    s_branch L_na2
L_as3:
    s_call_b64 s[66:67], L_vote
    s_branch L_na3
L_fb1a:
    s_mov_b32 s101, 1
    s_atomic_add s101, s[44:45], 0x1100 glc
    s_branch L_fbr1a
L_rs2:
    s_call_b64 s[12:13], L_rescale0
    s_branch L_skip2
L_fb1b:
    s_mov_b32 s34, 0x32211000
    s_mov_b32 s35, 0xd9755443
    v_mov_b32 v30, 160768
    s_waitcnt lgkmcnt(0)
    s_min_u32 s32, s101, 31
    s_lshr_b32 s32, s32, 1
    s_lshl_b32 s32, s32, 2
    s_lshr_b64 s[34:35], s[34:35], s32
    s_and_b32 s34, s34, 15
    s_sub_u32 s34, s34, 4
    v_mov_b32 v31, s34
    ds_write_b32 v30, v31
    s_waitcnt lgkmcnt(0)
    s_branch L_fbr1b
L_as4:
    s_call_b64 s[66:67], L_vote
    s_branch L_na4
L_as5:
    s_call_b64 s[66:67], L_vote
    s_branch L_na5
L_fb2a:
    s_mov_b32 s101, 1
    s_atomic_add s101, s[44:45], 0x2200 glc
    s_branch L_fbr2a
L_rs3:
    s_call_b64 s[12:13], L_rescale1
    s_branch L_skip3
L_fb2b:
    s_mov_b32 s34, 0x32211000
    s_mov_b32 s35, 0xd9755443
    v_mov_b32 v30, 160768
    s_waitcnt lgkmcnt(0)
    s_min_u32 s32, s101, 31
    s_lshr_b32 s32, s32, 1
    s_lshl_b32 s32, s32, 2
    s_lshr_b64 s[34:35], s[34:35], s32
    s_and_b32 s34, s34, 15
    s_sub_u32 s34, s34, 4
    v_mov_b32 v31, s34
    ds_write_b32 v30, v31
    s_waitcnt lgkmcnt(0)
    s_branch L_fbr2b
L_as6:
    s_call_b64 s[66:67], L_vote
    s_branch L_na6
L_fb3a:
    s_mov_b32 s101, 1
    s_atomic_add s101, s[44:45], 0x3300 glc
    s_branch L_fbr3a
L_fb3b:
    s_mov_b32 s34, 0x32211000
    s_mov_b32 s35, 0xd9755443
    v_mov_b32 v30, 160768
    s_waitcnt lgkmcnt(0)
    s_min_u32 s32, s101, 31
    s_lshr_b32 s32, s32, 1
    s_lshl_b32 s32, s32, 2
    s_lshr_b64 s[34:35], s[34:35], s32
    s_and_b32 s34, s34, 15
    s_sub_u32 s34, s34, 4
    v_mov_b32 v31, s34
    ds_write_b32 v30, v31
    s_waitcnt lgkmcnt(0)
    s_branch L_fbr3b
L_as7:
    s_call_b64 s[66:67], L_vote
    s_branch L_na7
L_fb4a:
    s_mov_b32 s101, 1
    s_atomic_add s101, s[44:45], 0x4400 glc
    s_branch L_fbr4a
L_rs4:
    s_call_b64 s[12:13], L_rescale0
    s_branch L_skip4
L_fb4b:
    s_mov_b32 s34, 0x32211000
    s_mov_b32 s35, 0xd9755443
    v_mov_b32 v30, 160768
    s_waitcnt lgkmcnt(0)
    s_min_u32 s32, s101, 31
    s_lshr_b32 s32, s32, 1
    s_lshl_b32 s32, s32, 2
    s_lshr_b64 s[34:35], s[34:35], s32
    s_and_b32 s34, s34, 15
    s_sub_u32 s34, s34, 4
    v_mov_b32 v31, s34
    ds_write_b32 v30, v31
    s_waitcnt lgkmcnt(0)
    s_branch L_fbr4b
L_fb5a:
    s_mov_b32 s101, 1
    s_atomic_add s101, s[44:45], 0x5500 glc
    s_branch L_fbr5a
L_fb5b:
    s_mov_b32 s34, 0x32211000
    s_mov_b32 s35, 0xd9755443
    v_mov_b32 v30, 160768
    s_waitcnt lgkmcnt(0)
    s_min_u32 s32, s101, 31
    s_lshr_b32 s32, s32, 1
    s_lshl_b32 s32, s32, 2
    s_lshr_b64 s[34:35], s[34:35], s32
    s_and_b32 s34, s34, 15
    s_sub_u32 s34, s34, 4
    v_mov_b32 v31, s34
    ds_write_b32 v30, v31
    s_waitcnt lgkmcnt(0)
    s_branch L_fbr5b
L_fb6a:
    s_mov_b32 s101, 1
    s_atomic_add s101, s[44:45], 0x6600 glc
    s_branch L_fbr6a
L_rs5:
    s_call_b64 s[12:13], L_rescale1
    s_branch L_skip5
L_fb6b:
    s_mov_b32 s34, 0x32211000
    s_mov_b32 s35, 0xd9755443
    v_mov_b32 v30, 160768
    s_waitcnt lgkmcnt(0)
    s_min_u32 s32, s101, 31
    s_lshr_b32 s32, s32, 1
    s_lshl_b32 s32, s32, 2
    s_lshr_b64 s[34:35], s[34:35], s32
    s_and_b32 s34, s34, 15
    s_sub_u32 s34, s34, 4
    v_mov_b32 v31, s34
    ds_write_b32 v30, v31
    s_waitcnt lgkmcnt(0)
    s_branch L_fbr6b
L_fb7a:
    s_mov_b32 s101, 1
    s_atomic_add s101, s[44:45], 0x7700 glc
    s_branch L_fbr7a
L_fb7b:
    s_mov_b32 s34, 0x32211000
    s_mov_b32 s35, 0xd9755443
    v_mov_b32 v30, 160768
    s_waitcnt lgkmcnt(0)
    s_min_u32 s32, s101, 31
    s_lshr_b32 s32, s32, 1
    s_lshl_b32 s32, s32, 2
    s_lshr_b64 s[34:35], s[34:35], s32
    s_and_b32 s34, s34, 15
    s_sub_u32 s34, s34, 4
    v_mov_b32 v31, s34
    ds_write_b32 v30, v31
    s_waitcnt lgkmcnt(0)
    s_branch L_fbr7b
L_fb8a:
    s_mov_b32 s101, 1
    s_atomic_add s101, s[44:45], 0x8800 glc
    s_branch L_fbr8a
L_rs6:
    s_call_b64 s[12:13], L_rescale0
    s_branch L_skip6
L_fb8b:
    s_mov_b32 s34, 0x32211000
    s_mov_b32 s35, 0xd9755443
    v_mov_b32 v30, 160768
    s_waitcnt lgkmcnt(0)
    s_min_u32 s32, s101, 31
    s_lshr_b32 s32, s32, 1
    s_lshl_b32 s32, s32, 2
    s_lshr_b64 s[34:35], s[34:35], s32
    s_and_b32 s34, s34, 15
    s_sub_u32 s34, s34, 4
    v_mov_b32 v31, s34
    ds_write_b32 v30, v31
    s_waitcnt lgkmcnt(0)
    s_branch L_fbr8b
L_initslow:
    s_mov_b32 s74, 0
    L_initpoll:
    buffer_load_dword v71, off, s[48:51], s80 sc1
    s_add_u32 s74, s74, 1
    s_waitcnt vmcnt(0)
    v_readfirstlane_b32 s9, v71
    s_cmp_ge_u32 s74, 0x10000
    s_cbranch_scc1 L_initdone
    s_bitcmp0_b32 s9, 5
    s_cbranch_scc1 L_initpoll
    s_branch L_initdone
L_fb9a:
    s_mov_b32 s101, 1
    s_atomic_add s101, s[44:45], 0x9900 glc
    s_branch L_fbr9a
L_fb9b:
    s_mov_b32 s34, 0x32211000
    s_mov_b32 s35, 0xd9755443
    v_mov_b32 v30, 160768
    s_waitcnt lgkmcnt(0)
    s_min_u32 s32, s101, 31
    s_lshr_b32 s32, s32, 1
    s_lshl_b32 s32, s32, 2
    s_lshr_b64 s[34:35], s[34:35], s32
    s_and_b32 s34, s34, 15
    s_sub_u32 s34, s34, 4
    v_mov_b32 v31, s34
    ds_write_b32 v30, v31
    s_waitcnt lgkmcnt(0)
    s_branch L_fbr9b
L_rs7:
    s_call_b64 s[12:13], L_rescale1
    s_branch L_skip7
L_rescale0:
    s_nop 11
    v_max3_f32 v30, v192, v193, 0
    v_max3_f32 v30, v30, v194, v195
    v_max3_f32 v30, v30, v196, v197
    v_max3_f32 v30, v30, v198, v199
    v_max3_f32 v30, v30, v200, v201
    v_max3_f32 v30, v30, v202, v203
    v_max3_f32 v30, v30, v204, v205
    v_max3_f32 v30, v30, v206, v207
    v_max3_f32 v30, v30, v208, v209
    v_max3_f32 v30, v30, v210, v211
    v_max3_f32 v30, v30, v212, v213
    v_max3_f32 v30, v30, v214, v215
    v_max3_f32 v30, v30, v216, v217
    v_max3_f32 v30, v30, v218, v219
    v_max3_f32 v30, v30, v220, v221
    v_max3_f32 v30, v30, v222, v223
    v_max3_f32 v30, v30, v224, v225
    v_max3_f32 v30, v30, v226, v227
    v_max3_f32 v30, v30, v228, v229
    v_max3_f32 v30, v30, v230, v231
    v_max3_f32 v30, v30, v232, v233
    v_max3_f32 v30, v30, v234, v235
    v_max3_f32 v30, v30, v236, v237
    v_max3_f32 v30, v30, v238, v239
    v_max3_f32 v30, v30, v240, v241
    v_max3_f32 v30, v30, v242, v243
    v_max3_f32 v30, v30, v244, v245
    v_max3_f32 v30, v30, v246, v247
    v_max3_f32 v30, v30, v248, v249
    v_max3_f32 v30, v30, v250, v251
    v_max3_f32 v30, v30, v252, v253
    v_max3_f32 v30, v30, v254, v255
    v_mov_b32 v28, v30
    s_nop 1
    v_permlane32_swap_b32 v30, v28
    v_max_f32 v30, v30, v28
    v_exp_f32 v28, -v30
    v_sub_f32 v80, v80, v30
    v_sub_f32 v81, v81, v30
    v_sub_f32 v82, v82, v30
    v_sub_f32 v83, v83, v30
    v_sub_f32 v84, v84, v30
    v_sub_f32 v85, v85, v30
    v_sub_f32 v86, v86, v30
    v_sub_f32 v87, v87, v30
    v_sub_f32 v88, v88, v30
    v_sub_f32 v89, v89, v30
    v_sub_f32 v90, v90, v30
    v_sub_f32 v91, v91, v30
    v_sub_f32 v92, v92, v30
    v_sub_f32 v93, v93, v30
    v_sub_f32 v94, v94, v30
    v_sub_f32 v95, v95, v30
    v_mul_f32 v29, v29, v28
    v_accvgpr_read_b32 v72, a0
    v_accvgpr_read_b32 v73, a1
    v_accvgpr_read_b32 v74, a2
    v_accvgpr_read_b32 v75, a3
    v_accvgpr_read_b32 v76, a4
    v_accvgpr_read_b32 v77, a5
    v_accvgpr_read_b32 v78, a6
    v_accvgpr_read_b32 v79, a7
    v_mul_f32 v72, v72, v28
    v_mul_f32 v73, v73, v28
    v_mul_f32 v74, v74, v28
    v_mul_f32 v75, v75, v28
    v_mul_f32 v76, v76, v28
    v_mul_f32 v77, v77, v28
    v_mul_f32 v78, v78, v28
    v_mul_f32 v79, v79, v28
    v_accvgpr_write_b32 a0, v72
    v_accvgpr_write_b32 a1, v73
    v_accvgpr_write_b32 a2, v74
    v_accvgpr_write_b32 a3, v75
    v_accvgpr_write_b32 a4, v76
    v_accvgpr_write_b32 a5, v77
    v_accvgpr_write_b32 a6, v78
    v_accvgpr_write_b32 a7, v79
    v_accvgpr_read_b32 v72, a8
    v_accvgpr_read_b32 v73, a9
    v_accvgpr_read_b32 v74, a10
    v_accvgpr_read_b32 v75, a11
    v_accvgpr_read_b32 v76, a12
    v_accvgpr_read_b32 v77, a13
    v_accvgpr_read_b32 v78, a14
    v_accvgpr_read_b32 v79, a15
    v_mul_f32 v72, v72, v28
    v_mul_f32 v73, v73, v28
    v_mul_f32 v74, v74, v28
    v_mul_f32 v75, v75, v28
    v_mul_f32 v76, v76, v28
    v_mul_f32 v77, v77, v28
    v_mul_f32 v78, v78, v28
    v_mul_f32 v79, v79, v28
    v_accvgpr_write_b32 a8, v72
    v_accvgpr_write_b32 a9, v73
    v_accvgpr_write_b32 a10, v74
    v_accvgpr_write_b32 a11, v75
    v_accvgpr_write_b32 a12, v76
    v_accvgpr_write_b32 a13, v77
    v_accvgpr_write_b32 a14, v78
    v_accvgpr_write_b32 a15, v79
    v_accvgpr_read_b32 v72, a16
    v_accvgpr_read_b32 v73, a17
    v_accvgpr_read_b32 v74, a18
    v_accvgpr_read_b32 v75, a19
    v_accvgpr_read_b32 v76, a20
    v_accvgpr_read_b32 v77, a21
    v_accvgpr_read_b32 v78, a22
    v_accvgpr_read_b32 v79, a23
    v_mul_f32 v72, v72, v28
    v_mul_f32 v73, v73, v28
    v_mul_f32 v74, v74, v28
    v_mul_f32 v75, v75, v28
    v_mul_f32 v76, v76, v28
    v_mul_f32 v77, v77, v28
    v_mul_f32 v78, v78, v28
    v_mul_f32 v79, v79, v28
    v_accvgpr_write_b32 a16, v72
    v_accvgpr_write_b32 a17, v73
    v_accvgpr_write_b32 a18, v74
    v_accvgpr_write_b32 a19, v75
    v_accvgpr_write_b32 a20, v76
    v_accvgpr_write_b32 a21, v77
    v_accvgpr_write_b32 a22, v78
    v_accvgpr_write_b32 a23, v79
    v_accvgpr_read_b32 v72, a24
    v_accvgpr_read_b32 v73, a25
    v_accvgpr_read_b32 v74, a26
    v_accvgpr_read_b32 v75, a27
    v_accvgpr_read_b32 v76, a28
    v_accvgpr_read_b32 v77, a29
    v_accvgpr_read_b32 v78, a30
    v_accvgpr_read_b32 v79, a31
    v_mul_f32 v72, v72, v28
    v_mul_f32 v73, v73, v28
    v_mul_f32 v74, v74, v28
    v_mul_f32 v75, v75, v28
    v_mul_f32 v76, v76, v28
    v_mul_f32 v77, v77, v28
    v_mul_f32 v78, v78, v28
    v_mul_f32 v79, v79, v28
    v_accvgpr_write_b32 a24, v72
    v_accvgpr_write_b32 a25, v73
    v_accvgpr_write_b32 a26, v74
    v_accvgpr_write_b32 a27, v75
    v_accvgpr_write_b32 a28, v76
    v_accvgpr_write_b32 a29, v77
    v_accvgpr_write_b32 a30, v78
    v_accvgpr_write_b32 a31, v79
    v_accvgpr_read_b32 v72, a32
    v_accvgpr_read_b32 v73, a33
    v_accvgpr_read_b32 v74, a34
    v_accvgpr_read_b32 v75, a35
    v_accvgpr_read_b32 v76, a36
    v_accvgpr_read_b32 v77, a37
    v_accvgpr_read_b32 v78, a38
    v_accvgpr_read_b32 v79, a39
    v_mul_f32 v72, v72, v28
    v_mul_f32 v73, v73, v28
    v_mul_f32 v74, v74, v28
    v_mul_f32 v75, v75, v28
    v_mul_f32 v76, v76, v28
    v_mul_f32 v77, v77, v28
    v_mul_f32 v78, v78, v28
    v_mul_f32 v79, v79, v28
    v_accvgpr_write_b32 a32, v72
    v_accvgpr_write_b32 a33, v73
    v_accvgpr_write_b32 a34, v74
    v_accvgpr_write_b32 a35, v75
    v_accvgpr_write_b32 a36, v76
    v_accvgpr_write_b32 a37, v77
    v_accvgpr_write_b32 a38, v78
    v_accvgpr_write_b32 a39, v79
    v_accvgpr_read_b32 v72, a40
    v_accvgpr_read_b32 v73, a41
    v_accvgpr_read_b32 v74, a42
    v_accvgpr_read_b32 v75, a43
    v_accvgpr_read_b32 v76, a44
    v_accvgpr_read_b32 v77, a45
    v_accvgpr_read_b32 v78, a46
    v_accvgpr_read_b32 v79, a47
    v_mul_f32 v72, v72, v28
    v_mul_f32 v73, v73, v28
    v_mul_f32 v74, v74, v28
    v_mul_f32 v75, v75, v28
    v_mul_f32 v76, v76, v28
    v_mul_f32 v77, v77, v28
    v_mul_f32 v78, v78, v28
    v_mul_f32 v79, v79, v28
    v_accvgpr_write_b32 a40, v72
    v_accvgpr_write_b32 a41, v73
    v_accvgpr_write_b32 a42, v74
    v_accvgpr_write_b32 a43, v75
    v_accvgpr_write_b32 a44, v76
    v_accvgpr_write_b32 a45, v77
    v_accvgpr_write_b32 a46, v78
    v_accvgpr_write_b32 a47, v79
    v_accvgpr_read_b32 v72, a48
    v_accvgpr_read_b32 v73, a49
    v_accvgpr_read_b32 v74, a50
    v_accvgpr_read_b32 v75, a51
    v_accvgpr_read_b32 v76, a52
    v_accvgpr_read_b32 v77, a53
    v_accvgpr_read_b32 v78, a54
    v_accvgpr_read_b32 v79, a55
    v_mul_f32 v72, v72, v28
    v_mul_f32 v73, v73, v28
    v_mul_f32 v74, v74, v28
    v_mul_f32 v75, v75, v28
    v_mul_f32 v76, v76, v28
    v_mul_f32 v77, v77, v28
    v_mul_f32 v78, v78, v28
    v_mul_f32 v79, v79, v28
    v_accvgpr_write_b32 a48, v72
    v_accvgpr_write_b32 a49, v73
    v_accvgpr_write_b32 a50, v74
    v_accvgpr_write_b32 a51, v75
    v_accvgpr_write_b32 a52, v76
    v_accvgpr_write_b32 a53, v77
    v_accvgpr_write_b32 a54, v78
    v_accvgpr_write_b32 a55, v79
    v_accvgpr_read_b32 v72, a56
    v_accvgpr_read_b32 v73, a57
    v_accvgpr_read_b32 v74, a58
    v_accvgpr_read_b32 v75, a59
    v_accvgpr_read_b32 v76, a60
    v_accvgpr_read_b32 v77, a61
    v_accvgpr_read_b32 v78, a62
    v_accvgpr_read_b32 v79, a63
    v_mul_f32 v72, v72, v28
    v_mul_f32 v73, v73, v28
    v_mul_f32 v74, v74, v28
    v_mul_f32 v75, v75, v28
    v_mul_f32 v76, v76, v28
    v_mul_f32 v77, v77, v28
    v_mul_f32 v78, v78, v28
    v_mul_f32 v79, v79, v28
    v_accvgpr_write_b32 a56, v72
    v_accvgpr_write_b32 a57, v73
    v_accvgpr_write_b32 a58, v74
    v_accvgpr_write_b32 a59, v75
    v_accvgpr_write_b32 a60, v76
    v_accvgpr_write_b32 a61, v77
    v_accvgpr_write_b32 a62, v78
    v_accvgpr_write_b32 a63, v79
    v_sub_f32 v192, v192, v30
    v_exp_f32 v72, v192
    v_sub_f32 v193, v193, v30
    v_exp_f32 v73, v193
    v_sub_f32 v194, v194, v30
    v_exp_f32 v74, v194
    v_sub_f32 v195, v195, v30
    v_exp_f32 v75, v195
    v_cvt_pk_bf16_f32 v128, v72, v73
    v_sub_f32 v196, v196, v30
    v_exp_f32 v76, v196
    v_add_f32 v27, v72, v74
    v_sub_f32 v197, v197, v30
    v_exp_f32 v77, v197
    v_add_f32 v28, v73, v75
    v_cvt_pk_bf16_f32 v129, v74, v75
    v_sub_f32 v198, v198, v30
    v_exp_f32 v78, v198
    v_add_f32 v27, v27, v76
    v_sub_f32 v199, v199, v30
    v_exp_f32 v79, v199
    v_add_f32 v28, v28, v77
    v_cvt_pk_bf16_f32 v130, v76, v77
    v_sub_f32 v200, v200, v30
    v_exp_f32 v72, v200
    v_add_f32 v27, v27, v78
    v_sub_f32 v201, v201, v30
    v_exp_f32 v73, v201
    v_add_f32 v28, v28, v79
    v_cvt_pk_bf16_f32 v131, v78, v79
    v_sub_f32 v202, v202, v30
    v_exp_f32 v74, v202
    v_add_f32 v27, v27, v72
    v_sub_f32 v203, v203, v30
    v_exp_f32 v75, v203
    v_add_f32 v28, v28, v73
    v_cvt_pk_bf16_f32 v132, v72, v73
    v_sub_f32 v204, v204, v30
    v_exp_f32 v76, v204
    v_add_f32 v27, v27, v74
    v_sub_f32 v205, v205, v30
    v_exp_f32 v77, v205
    v_add_f32 v28, v28, v75
    v_cvt_pk_bf16_f32 v133, v74, v75
    v_sub_f32 v206, v206, v30
    v_exp_f32 v78, v206
    v_add_f32 v27, v27, v76
    v_sub_f32 v207, v207, v30
    v_exp_f32 v79, v207
    v_add_f32 v28, v28, v77
    v_cvt_pk_bf16_f32 v134, v76, v77
    v_sub_f32 v208, v208, v30
    v_exp_f32 v72, v208
    v_add_f32 v27, v27, v78
    v_sub_f32 v209, v209, v30
    v_exp_f32 v73, v209
    v_add_f32 v28, v28, v79
    v_cvt_pk_bf16_f32 v135, v78, v79
    v_sub_f32 v210, v210, v30
    v_exp_f32 v74, v210
    v_add_f32 v27, v27, v72
    v_sub_f32 v211, v211, v30
    v_exp_f32 v75, v211
    v_add_f32 v28, v28, v73
    v_cvt_pk_bf16_f32 v136, v72, v73
    v_sub_f32 v212, v212, v30
    v_exp_f32 v76, v212
    v_add_f32 v27, v27, v74
    v_sub_f32 v213, v213, v30
    v_exp_f32 v77, v213
    v_add_f32 v28, v28, v75
    v_cvt_pk_bf16_f32 v137, v74, v75
    v_sub_f32 v214, v214, v30
    v_exp_f32 v78, v214
    v_add_f32 v27, v27, v76
    v_sub_f32 v215, v215, v30
    v_exp_f32 v79, v215
    v_add_f32 v28, v28, v77
    v_cvt_pk_bf16_f32 v138, v76, v77
    v_sub_f32 v216, v216, v30
    v_exp_f32 v72, v216
    v_add_f32 v27, v27, v78
    v_sub_f32 v217, v217, v30
    v_exp_f32 v73, v217
    v_add_f32 v28, v28, v79
    v_cvt_pk_bf16_f32 v139, v78, v79
    v_sub_f32 v218, v218, v30
    v_exp_f32 v74, v218
    v_add_f32 v27, v27, v72
    v_sub_f32 v219, v219, v30
    v_exp_f32 v75, v219
    v_add_f32 v28, v28, v73
    v_cvt_pk_bf16_f32 v140, v72, v73
    v_sub_f32 v220, v220, v30
    v_exp_f32 v76, v220
    v_add_f32 v27, v27, v74
    v_sub_f32 v221, v221, v30
    v_exp_f32 v77, v221
    v_add_f32 v28, v28, v75
    v_cvt_pk_bf16_f32 v141, v74, v75
    v_sub_f32 v222, v222, v30
    v_exp_f32 v78, v222
    v_add_f32 v27, v27, v76
    v_sub_f32 v223, v223, v30
    v_exp_f32 v79, v223
    v_add_f32 v28, v28, v77
    v_cvt_pk_bf16_f32 v142, v76, v77
    v_sub_f32 v224, v224, v30
    v_exp_f32 v72, v224
    v_add_f32 v27, v27, v78
    v_sub_f32 v225, v225, v30
    v_exp_f32 v73, v225
    v_add_f32 v28, v28, v79
    v_cvt_pk_bf16_f32 v143, v78, v79
    v_sub_f32 v226, v226, v30
    v_exp_f32 v74, v226
    v_add_f32 v27, v27, v72
    v_sub_f32 v227, v227, v30
    v_exp_f32 v75, v227
    v_add_f32 v28, v28, v73
    v_cvt_pk_bf16_f32 v144, v72, v73
    v_sub_f32 v228, v228, v30
    v_exp_f32 v76, v228
    v_add_f32 v27, v27, v74
    v_sub_f32 v229, v229, v30
    v_exp_f32 v77, v229
    v_add_f32 v28, v28, v75
    v_cvt_pk_bf16_f32 v145, v74, v75
    v_sub_f32 v230, v230, v30
    v_exp_f32 v78, v230
    v_add_f32 v27, v27, v76
    v_sub_f32 v231, v231, v30
    v_exp_f32 v79, v231
    v_add_f32 v28, v28, v77
    v_cvt_pk_bf16_f32 v146, v76, v77
    v_sub_f32 v232, v232, v30
    v_exp_f32 v72, v232
    v_add_f32 v27, v27, v78
    v_sub_f32 v233, v233, v30
    v_exp_f32 v73, v233
    v_add_f32 v28, v28, v79
    v_cvt_pk_bf16_f32 v147, v78, v79
    v_sub_f32 v234, v234, v30
    v_exp_f32 v74, v234
    v_add_f32 v27, v27, v72
    v_sub_f32 v235, v235, v30
    v_exp_f32 v75, v235
    v_add_f32 v28, v28, v73
    v_cvt_pk_bf16_f32 v148, v72, v73
    v_sub_f32 v236, v236, v30
    v_exp_f32 v76, v236
    v_add_f32 v27, v27, v74
    v_sub_f32 v237, v237, v30
    v_exp_f32 v77, v237
    v_add_f32 v28, v28, v75
    v_cvt_pk_bf16_f32 v149, v74, v75
    v_sub_f32 v238, v238, v30
    v_exp_f32 v78, v238
    v_add_f32 v27, v27, v76
    v_sub_f32 v239, v239, v30
    v_exp_f32 v79, v239
    v_add_f32 v28, v28, v77
    v_cvt_pk_bf16_f32 v150, v76, v77
    v_sub_f32 v240, v240, v30
    v_exp_f32 v72, v240
    v_add_f32 v27, v27, v78
    v_sub_f32 v241, v241, v30
    v_exp_f32 v73, v241
    v_add_f32 v28, v28, v79
    v_cvt_pk_bf16_f32 v151, v78, v79
    v_sub_f32 v242, v242, v30
    v_exp_f32 v74, v242
    v_add_f32 v27, v27, v72
    v_sub_f32 v243, v243, v30
    v_exp_f32 v75, v243
    v_add_f32 v28, v28, v73
    v_cvt_pk_bf16_f32 v152, v72, v73
    v_sub_f32 v244, v244, v30
    v_exp_f32 v76, v244
    v_add_f32 v27, v27, v74
    v_sub_f32 v245, v245, v30
    v_exp_f32 v77, v245
    v_add_f32 v28, v28, v75
    v_cvt_pk_bf16_f32 v153, v74, v75
    v_sub_f32 v246, v246, v30
    v_exp_f32 v78, v246
    v_add_f32 v27, v27, v76
    v_sub_f32 v247, v247, v30
    v_exp_f32 v79, v247
    v_add_f32 v28, v28, v77
    v_cvt_pk_bf16_f32 v154, v76, v77
    v_sub_f32 v248, v248, v30
    v_exp_f32 v72, v248
    v_add_f32 v27, v27, v78
    v_sub_f32 v249, v249, v30
    v_exp_f32 v73, v249
    v_add_f32 v28, v28, v79
    v_cvt_pk_bf16_f32 v155, v78, v79
    v_sub_f32 v250, v250, v30
    v_exp_f32 v74, v250
    v_add_f32 v27, v27, v72
    v_sub_f32 v251, v251, v30
    v_exp_f32 v75, v251
    v_add_f32 v28, v28, v73
    v_cvt_pk_bf16_f32 v156, v72, v73
    v_sub_f32 v252, v252, v30
    v_exp_f32 v76, v252
    v_add_f32 v27, v27, v74
    v_sub_f32 v253, v253, v30
    v_exp_f32 v77, v253
    v_add_f32 v28, v28, v75
    v_cvt_pk_bf16_f32 v157, v74, v75
    v_sub_f32 v254, v254, v30
    v_exp_f32 v78, v254
    v_add_f32 v27, v27, v76
    v_sub_f32 v255, v255, v30
    v_exp_f32 v79, v255
    v_add_f32 v28, v28, v77
    v_cvt_pk_bf16_f32 v158, v76, v77
    v_add_f32 v27, v27, v78
    v_add_f32 v28, v28, v79
    v_cvt_pk_bf16_f32 v159, v78, v79
    v_add_f32 v27, v27, v28
    s_nop 1
    s_setpc_b64 s[12:13]
L_rescale1:
    s_nop 11
    v_max3_f32 v30, v192, v193, 0
    v_max3_f32 v30, v30, v194, v195
    v_max3_f32 v30, v30, v196, v197
    v_max3_f32 v30, v30, v198, v199
    v_max3_f32 v30, v30, v200, v201
    v_max3_f32 v30, v30, v202, v203
    v_max3_f32 v30, v30, v204, v205
    v_max3_f32 v30, v30, v206, v207
    v_max3_f32 v30, v30, v208, v209
    v_max3_f32 v30, v30, v210, v211
    v_max3_f32 v30, v30, v212, v213
    v_max3_f32 v30, v30, v214, v215
    v_max3_f32 v30, v30, v216, v217
    v_max3_f32 v30, v30, v218, v219
    v_max3_f32 v30, v30, v220, v221
    v_max3_f32 v30, v30, v222, v223
    v_max3_f32 v30, v30, v224, v225
    v_max3_f32 v30, v30, v226, v227
    v_max3_f32 v30, v30, v228, v229
    v_max3_f32 v30, v30, v230, v231
    v_max3_f32 v30, v30, v232, v233
    v_max3_f32 v30, v30, v234, v235
    v_max3_f32 v30, v30, v236, v237
    v_max3_f32 v30, v30, v238, v239
    v_max3_f32 v30, v30, v240, v241
    v_max3_f32 v30, v30, v242, v243
    v_max3_f32 v30, v30, v244, v245
    v_max3_f32 v30, v30, v246, v247
    v_max3_f32 v30, v30, v248, v249
    v_max3_f32 v30, v30, v250, v251
    v_max3_f32 v30, v30, v252, v253
    v_max3_f32 v30, v30, v254, v255
    v_mov_b32 v28, v30
    s_nop 1
    v_permlane32_swap_b32 v30, v28
    v_max_f32 v30, v30, v28
    v_exp_f32 v28, -v30
    v_sub_f32 v80, v80, v30
    v_sub_f32 v81, v81, v30
    v_sub_f32 v82, v82, v30
    v_sub_f32 v83, v83, v30
    v_sub_f32 v84, v84, v30
    v_sub_f32 v85, v85, v30
    v_sub_f32 v86, v86, v30
    v_sub_f32 v87, v87, v30
    v_sub_f32 v88, v88, v30
    v_sub_f32 v89, v89, v30
    v_sub_f32 v90, v90, v30
    v_sub_f32 v91, v91, v30
    v_sub_f32 v92, v92, v30
    v_sub_f32 v93, v93, v30
    v_sub_f32 v94, v94, v30
    v_sub_f32 v95, v95, v30
    v_mul_f32 v29, v29, v28
    v_accvgpr_read_b32 v72, a0
    v_accvgpr_read_b32 v73, a1
    v_accvgpr_read_b32 v74, a2
    v_accvgpr_read_b32 v75, a3
    v_accvgpr_read_b32 v76, a4
    v_accvgpr_read_b32 v77, a5
    v_accvgpr_read_b32 v78, a6
    v_accvgpr_read_b32 v79, a7
    v_mul_f32 v72, v72, v28
    v_mul_f32 v73, v73, v28
    v_mul_f32 v74, v74, v28
    v_mul_f32 v75, v75, v28
    v_mul_f32 v76, v76, v28
    v_mul_f32 v77, v77, v28
    v_mul_f32 v78, v78, v28
    v_mul_f32 v79, v79, v28
    v_accvgpr_write_b32 a0, v72
    v_accvgpr_write_b32 a1, v73
    v_accvgpr_write_b32 a2, v74
    v_accvgpr_write_b32 a3, v75
    v_accvgpr_write_b32 a4, v76
    v_accvgpr_write_b32 a5, v77
    v_accvgpr_write_b32 a6, v78
    v_accvgpr_write_b32 a7, v79
    v_accvgpr_read_b32 v72, a8
    v_accvgpr_read_b32 v73, a9
    v_accvgpr_read_b32 v74, a10
    v_accvgpr_read_b32 v75, a11
    v_accvgpr_read_b32 v76, a12
    v_accvgpr_read_b32 v77, a13
    v_accvgpr_read_b32 v78, a14
    v_accvgpr_read_b32 v79, a15
    v_mul_f32 v72, v72, v28
    v_mul_f32 v73, v73, v28
    v_mul_f32 v74, v74, v28
    v_mul_f32 v75, v75, v28
    v_mul_f32 v76, v76, v28
    v_mul_f32 v77, v77, v28
    v_mul_f32 v78, v78, v28
    v_mul_f32 v79, v79, v28
    v_accvgpr_write_b32 a8, v72
    v_accvgpr_write_b32 a9, v73
    v_accvgpr_write_b32 a10, v74
    v_accvgpr_write_b32 a11, v75
    v_accvgpr_write_b32 a12, v76
    v_accvgpr_write_b32 a13, v77
    v_accvgpr_write_b32 a14, v78
    v_accvgpr_write_b32 a15, v79
    v_accvgpr_read_b32 v72, a16
    v_accvgpr_read_b32 v73, a17
    v_accvgpr_read_b32 v74, a18
    v_accvgpr_read_b32 v75, a19
    v_accvgpr_read_b32 v76, a20
    v_accvgpr_read_b32 v77, a21
    v_accvgpr_read_b32 v78, a22
    v_accvgpr_read_b32 v79, a23
    v_mul_f32 v72, v72, v28
    v_mul_f32 v73, v73, v28
    v_mul_f32 v74, v74, v28
    v_mul_f32 v75, v75, v28
    v_mul_f32 v76, v76, v28
    v_mul_f32 v77, v77, v28
    v_mul_f32 v78, v78, v28
    v_mul_f32 v79, v79, v28
    v_accvgpr_write_b32 a16, v72
    v_accvgpr_write_b32 a17, v73
    v_accvgpr_write_b32 a18, v74
    v_accvgpr_write_b32 a19, v75
    v_accvgpr_write_b32 a20, v76
    v_accvgpr_write_b32 a21, v77
    v_accvgpr_write_b32 a22, v78
    v_accvgpr_write_b32 a23, v79
    v_accvgpr_read_b32 v72, a24
    v_accvgpr_read_b32 v73, a25
    v_accvgpr_read_b32 v74, a26
    v_accvgpr_read_b32 v75, a27
    v_accvgpr_read_b32 v76, a28
    v_accvgpr_read_b32 v77, a29
    v_accvgpr_read_b32 v78, a30
    v_accvgpr_read_b32 v79, a31
    v_mul_f32 v72, v72, v28
    v_mul_f32 v73, v73, v28
    v_mul_f32 v74, v74, v28
    v_mul_f32 v75, v75, v28
    v_mul_f32 v76, v76, v28
    v_mul_f32 v77, v77, v28
    v_mul_f32 v78, v78, v28
    v_mul_f32 v79, v79, v28
    v_accvgpr_write_b32 a24, v72
    v_accvgpr_write_b32 a25, v73
    v_accvgpr_write_b32 a26, v74
    v_accvgpr_write_b32 a27, v75
    v_accvgpr_write_b32 a28, v76
    v_accvgpr_write_b32 a29, v77
    v_accvgpr_write_b32 a30, v78
    v_accvgpr_write_b32 a31, v79
    v_accvgpr_read_b32 v72, a32
    v_accvgpr_read_b32 v73, a33
    v_accvgpr_read_b32 v74, a34
    v_accvgpr_read_b32 v75, a35
    v_accvgpr_read_b32 v76, a36
    v_accvgpr_read_b32 v77, a37
    v_accvgpr_read_b32 v78, a38
    v_accvgpr_read_b32 v79, a39
    v_mul_f32 v72, v72, v28
    v_mul_f32 v73, v73, v28
    v_mul_f32 v74, v74, v28
    v_mul_f32 v75, v75, v28
    v_mul_f32 v76, v76, v28
    v_mul_f32 v77, v77, v28
    v_mul_f32 v78, v78, v28
    v_mul_f32 v79, v79, v28
    v_accvgpr_write_b32 a32, v72
    v_accvgpr_write_b32 a33, v73
    v_accvgpr_write_b32 a34, v74
    v_accvgpr_write_b32 a35, v75
    v_accvgpr_write_b32 a36, v76
    v_accvgpr_write_b32 a37, v77
    v_accvgpr_write_b32 a38, v78
    v_accvgpr_write_b32 a39, v79
    v_accvgpr_read_b32 v72, a40
    v_accvgpr_read_b32 v73, a41
    v_accvgpr_read_b32 v74, a42
    v_accvgpr_read_b32 v75, a43
    v_accvgpr_read_b32 v76, a44
    v_accvgpr_read_b32 v77, a45
    v_accvgpr_read_b32 v78, a46
    v_accvgpr_read_b32 v79, a47
    v_mul_f32 v72, v72, v28
    v_mul_f32 v73, v73, v28
    v_mul_f32 v74, v74, v28
    v_mul_f32 v75, v75, v28
    v_mul_f32 v76, v76, v28
    v_mul_f32 v77, v77, v28
    v_mul_f32 v78, v78, v28
    v_mul_f32 v79, v79, v28
    v_accvgpr_write_b32 a40, v72
    v_accvgpr_write_b32 a41, v73
    v_accvgpr_write_b32 a42, v74
    v_accvgpr_write_b32 a43, v75
    v_accvgpr_write_b32 a44, v76
    v_accvgpr_write_b32 a45, v77
    v_accvgpr_write_b32 a46, v78
    v_accvgpr_write_b32 a47, v79
    v_accvgpr_read_b32 v72, a48
    v_accvgpr_read_b32 v73, a49
    v_accvgpr_read_b32 v74, a50
    v_accvgpr_read_b32 v75, a51
    v_accvgpr_read_b32 v76, a52
    v_accvgpr_read_b32 v77, a53
    v_accvgpr_read_b32 v78, a54
    v_accvgpr_read_b32 v79, a55
    v_mul_f32 v72, v72, v28
    v_mul_f32 v73, v73, v28
    v_mul_f32 v74, v74, v28
    v_mul_f32 v75, v75, v28
    v_mul_f32 v76, v76, v28
    v_mul_f32 v77, v77, v28
    v_mul_f32 v78, v78, v28
    v_mul_f32 v79, v79, v28
    v_accvgpr_write_b32 a48, v72
    v_accvgpr_write_b32 a49, v73
    v_accvgpr_write_b32 a50, v74
    v_accvgpr_write_b32 a51, v75
    v_accvgpr_write_b32 a52, v76
    v_accvgpr_write_b32 a53, v77
    v_accvgpr_write_b32 a54, v78
    v_accvgpr_write_b32 a55, v79
    v_accvgpr_read_b32 v72, a56
    v_accvgpr_read_b32 v73, a57
    v_accvgpr_read_b32 v74, a58
    v_accvgpr_read_b32 v75, a59
    v_accvgpr_read_b32 v76, a60
    v_accvgpr_read_b32 v77, a61
    v_accvgpr_read_b32 v78, a62
    v_accvgpr_read_b32 v79, a63
    v_mul_f32 v72, v72, v28
    v_mul_f32 v73, v73, v28
    v_mul_f32 v74, v74, v28
    v_mul_f32 v75, v75, v28
    v_mul_f32 v76, v76, v28
    v_mul_f32 v77, v77, v28
    v_mul_f32 v78, v78, v28
    v_mul_f32 v79, v79, v28
    v_accvgpr_write_b32 a56, v72
    v_accvgpr_write_b32 a57, v73
    v_accvgpr_write_b32 a58, v74
    v_accvgpr_write_b32 a59, v75
    v_accvgpr_write_b32 a60, v76
    v_accvgpr_write_b32 a61, v77
    v_accvgpr_write_b32 a62, v78
    v_accvgpr_write_b32 a63, v79
    v_sub_f32 v192, v192, v30
    v_exp_f32 v72, v192
    v_sub_f32 v193, v193, v30
    v_exp_f32 v73, v193
    v_sub_f32 v194, v194, v30
    v_exp_f32 v74, v194
    v_sub_f32 v195, v195, v30
    v_exp_f32 v75, v195
    v_cvt_pk_bf16_f32 v160, v72, v73
    v_sub_f32 v196, v196, v30
    v_exp_f32 v76, v196
    v_add_f32 v27, v72, v74
    v_sub_f32 v197, v197, v30
    v_exp_f32 v77, v197
    v_add_f32 v28, v73, v75
    v_cvt_pk_bf16_f32 v161, v74, v75
    v_sub_f32 v198, v198, v30
    v_exp_f32 v78, v198
    v_add_f32 v27, v27, v76
    v_sub_f32 v199, v199, v30
    v_exp_f32 v79, v199
    v_add_f32 v28, v28, v77
    v_cvt_pk_bf16_f32 v162, v76, v77
    v_sub_f32 v200, v200, v30
    v_exp_f32 v72, v200
    v_add_f32 v27, v27, v78
    v_sub_f32 v201, v201, v30
    v_exp_f32 v73, v201
    v_add_f32 v28, v28, v79
    v_cvt_pk_bf16_f32 v163, v78, v79
    v_sub_f32 v202, v202, v30
    v_exp_f32 v74, v202
    v_add_f32 v27, v27, v72
    v_sub_f32 v203, v203, v30
    v_exp_f32 v75, v203
    v_add_f32 v28, v28, v73
    v_cvt_pk_bf16_f32 v164, v72, v73
    v_sub_f32 v204, v204, v30
    v_exp_f32 v76, v204
    v_add_f32 v27, v27, v74
    v_sub_f32 v205, v205, v30
    v_exp_f32 v77, v205
    v_add_f32 v28, v28, v75
    v_cvt_pk_bf16_f32 v165, v74, v75
    v_sub_f32 v206, v206, v30
    v_exp_f32 v78, v206
    v_add_f32 v27, v27, v76
    v_sub_f32 v207, v207, v30
    v_exp_f32 v79, v207
    v_add_f32 v28, v28, v77
    v_cvt_pk_bf16_f32 v166, v76, v77
    v_sub_f32 v208, v208, v30
    v_exp_f32 v72, v208
    v_add_f32 v27, v27, v78
    v_sub_f32 v209, v209, v30
    v_exp_f32 v73, v209
    v_add_f32 v28, v28, v79
    v_cvt_pk_bf16_f32 v167, v78, v79
    v_sub_f32 v210, v210, v30
    v_exp_f32 v74, v210
    v_add_f32 v27, v27, v72
    v_sub_f32 v211, v211, v30
    v_exp_f32 v75, v211
    v_add_f32 v28, v28, v73
    v_cvt_pk_bf16_f32 v168, v72, v73
    v_sub_f32 v212, v212, v30
    v_exp_f32 v76, v212
    v_add_f32 v27, v27, v74
    v_sub_f32 v213, v213, v30
    v_exp_f32 v77, v213
    v_add_f32 v28, v28, v75
    v_cvt_pk_bf16_f32 v169, v74, v75
    v_sub_f32 v214, v214, v30
    v_exp_f32 v78, v214
    v_add_f32 v27, v27, v76
    v_sub_f32 v215, v215, v30
    v_exp_f32 v79, v215
    v_add_f32 v28, v28, v77
    v_cvt_pk_bf16_f32 v170, v76, v77
    v_sub_f32 v216, v216, v30
    v_exp_f32 v72, v216
    v_add_f32 v27, v27, v78
    v_sub_f32 v217, v217, v30
    v_exp_f32 v73, v217
    v_add_f32 v28, v28, v79
    v_cvt_pk_bf16_f32 v171, v78, v79
    v_sub_f32 v218, v218, v30
    v_exp_f32 v74, v218
    v_add_f32 v27, v27, v72
    v_sub_f32 v219, v219, v30
    v_exp_f32 v75, v219
    v_add_f32 v28, v28, v73
    v_cvt_pk_bf16_f32 v172, v72, v73
    v_sub_f32 v220, v220, v30
    v_exp_f32 v76, v220
    v_add_f32 v27, v27, v74
    v_sub_f32 v221, v221, v30
    v_exp_f32 v77, v221
    v_add_f32 v28, v28, v75
    v_cvt_pk_bf16_f32 v173, v74, v75
    v_sub_f32 v222, v222, v30
    v_exp_f32 v78, v222
    v_add_f32 v27, v27, v76
    v_sub_f32 v223, v223, v30
    v_exp_f32 v79, v223
    v_add_f32 v28, v28, v77
    v_cvt_pk_bf16_f32 v174, v76, v77
    v_sub_f32 v224, v224, v30
    v_exp_f32 v72, v224
    v_add_f32 v27, v27, v78
    v_sub_f32 v225, v225, v30
    v_exp_f32 v73, v225
    v_add_f32 v28, v28, v79
    v_cvt_pk_bf16_f32 v175, v78, v79
    v_sub_f32 v226, v226, v30
    v_exp_f32 v74, v226
    v_add_f32 v27, v27, v72
    v_sub_f32 v227, v227, v30
    v_exp_f32 v75, v227
    v_add_f32 v28, v28, v73
    v_cvt_pk_bf16_f32 v176, v72, v73
    v_sub_f32 v228, v228, v30
    v_exp_f32 v76, v228
    v_add_f32 v27, v27, v74
    v_sub_f32 v229, v229, v30
    v_exp_f32 v77, v229
    v_add_f32 v28, v28, v75
    v_cvt_pk_bf16_f32 v177, v74, v75
    v_sub_f32 v230, v230, v30
    v_exp_f32 v78, v230
    v_add_f32 v27, v27, v76
    v_sub_f32 v231, v231, v30
    v_exp_f32 v79, v231
    v_add_f32 v28, v28, v77
    v_cvt_pk_bf16_f32 v178, v76, v77
    v_sub_f32 v232, v232, v30
    v_exp_f32 v72, v232
    v_add_f32 v27, v27, v78
    v_sub_f32 v233, v233, v30
    v_exp_f32 v73, v233
    v_add_f32 v28, v28, v79
    v_cvt_pk_bf16_f32 v179, v78, v79
    v_sub_f32 v234, v234, v30
    v_exp_f32 v74, v234
    v_add_f32 v27, v27, v72
    v_sub_f32 v235, v235, v30
    v_exp_f32 v75, v235
    v_add_f32 v28, v28, v73
    v_cvt_pk_bf16_f32 v180, v72, v73
    v_sub_f32 v236, v236, v30
    v_exp_f32 v76, v236
    v_add_f32 v27, v27, v74
    v_sub_f32 v237, v237, v30
    v_exp_f32 v77, v237
    v_add_f32 v28, v28, v75
    v_cvt_pk_bf16_f32 v181, v74, v75
    v_sub_f32 v238, v238, v30
    v_exp_f32 v78, v238
    v_add_f32 v27, v27, v76
    v_sub_f32 v239, v239, v30
    v_exp_f32 v79, v239
    v_add_f32 v28, v28, v77
    v_cvt_pk_bf16_f32 v182, v76, v77
    v_sub_f32 v240, v240, v30
    v_exp_f32 v72, v240
    v_add_f32 v27, v27, v78
    v_sub_f32 v241, v241, v30
    v_exp_f32 v73, v241
    v_add_f32 v28, v28, v79
    v_cvt_pk_bf16_f32 v183, v78, v79
    v_sub_f32 v242, v242, v30
    v_exp_f32 v74, v242
    v_add_f32 v27, v27, v72
    v_sub_f32 v243, v243, v30
    v_exp_f32 v75, v243
    v_add_f32 v28, v28, v73
    v_cvt_pk_bf16_f32 v184, v72, v73
    v_sub_f32 v244, v244, v30
    v_exp_f32 v76, v244
    v_add_f32 v27, v27, v74
    v_sub_f32 v245, v245, v30
    v_exp_f32 v77, v245
    v_add_f32 v28, v28, v75
    v_cvt_pk_bf16_f32 v185, v74, v75
    v_sub_f32 v246, v246, v30
    v_exp_f32 v78, v246
    v_add_f32 v27, v27, v76
    v_sub_f32 v247, v247, v30
    v_exp_f32 v79, v247
    v_add_f32 v28, v28, v77
    v_cvt_pk_bf16_f32 v186, v76, v77
    v_sub_f32 v248, v248, v30
    v_exp_f32 v72, v248
    v_add_f32 v27, v27, v78
    v_sub_f32 v249, v249, v30
    v_exp_f32 v73, v249
    v_add_f32 v28, v28, v79
    v_cvt_pk_bf16_f32 v187, v78, v79
    v_sub_f32 v250, v250, v30
    v_exp_f32 v74, v250
    v_add_f32 v27, v27, v72
    v_sub_f32 v251, v251, v30
    v_exp_f32 v75, v251
    v_add_f32 v28, v28, v73
    v_cvt_pk_bf16_f32 v188, v72, v73
    v_sub_f32 v252, v252, v30
    v_exp_f32 v76, v252
    v_add_f32 v27, v27, v74
    v_sub_f32 v253, v253, v30
    v_exp_f32 v77, v253
    v_add_f32 v28, v28, v75
    v_cvt_pk_bf16_f32 v189, v74, v75
    v_sub_f32 v254, v254, v30
    v_exp_f32 v78, v254
    v_add_f32 v27, v27, v76
    v_sub_f32 v255, v255, v30
    v_exp_f32 v79, v255
    v_add_f32 v28, v28, v77
    v_cvt_pk_bf16_f32 v190, v76, v77
    v_add_f32 v27, v27, v78
    v_add_f32 v28, v28, v79
    v_cvt_pk_bf16_f32 v191, v78, v79
    v_add_f32 v27, v27, v28
    s_nop 1
    s_setpc_b64 s[12:13]
.p2align 7
.type L_table,@object
L_table:
    .long 0, 1, 2, 3, 4, 5, 6, 7
    .long 8, 9, 10, 11, 12, 13, 14, 15
    .long 16, 17, 18, 19, 20, 21, 22, 23
    .long 24, 25, 26, 27, 28, 29, 30, 31
    .long 32, 33, 34, 35, 36, 37, 38, 39
    .long 40, 41, 42, 43, 44, 45, 46, 47
    .long 48, 49, 50, 51, 52, 53, 54, 55
    .long 56, 57, 58, 59, 60, 61, 62, 63
    .long 64, 65, 66, 67, 68, 69, 70, 71
    .long 72, 73, 74, 75, 76, 77, 78, 79
    .long 80, 81, 82, 83, 84, 85, 86, 87
    .long 88, 89, 90, 91, 92, 93, 94, 95
    .long 96, 97, 98, 99, 100, 101, 102, 103
    .long 104, 105, 106, 107, 108, 109, 110, 111
    .long 112, 113, 114, 115, 116, 117, 118, 119
    .long 120, 121, 122, 123, 124, 125, 126, 127
.size L_table, 512
L_code_end:
.section .rodata,"a"
.p2align 6
.amdhsa_kernel standalone__mha_block_cached__near_ridge_kernel
  .amdhsa_next_free_vgpr 512
  .amdhsa_next_free_sgpr 102
  .amdhsa_accum_offset 256
  .amdhsa_group_segment_fixed_size 0
  .amdhsa_kernarg_size 64
  .amdhsa_user_sgpr_count 2
  .amdhsa_user_sgpr_kernarg_segment_ptr 1
  .amdhsa_system_sgpr_workgroup_id_x 1
.end_amdhsa_kernel
```
